```python
import torch

def _softmax(x, axis=-1):
    return torch.softmax(x, dim=axis)

def _gelu(x):
    return torch.nn.functional.gelu(x, approximate='tanh')

def _silu(x):
    return torch.nn.functional.silu(x)

def _sigmoid(x):
    return torch.sigmoid(x)

def _layernorm(x, axis=-1, eps=1e-05):
    m = x.mean(dim=axis, keepdim=True)
    v = x.var(dim=axis, keepdim=True, unbiased=False)
    return (x - m) / torch.sqrt(v + eps)

def _scatter_add(tgt, idx, src, axis=0):
    return tgt.clone().index_add_(axis, idx, src)

def _segment_sum(src, seg, n):
    out = torch.zeros((n,) + src.shape[1:], dtype=src.dtype)
    return out.index_add_(0, seg, src)

def _pad(x, pw):
    flat = tuple((v for pair in reversed(pw) for v in pair))
    return torch.nn.functional.pad(x, flat)
kernel_name = 'recurrent_scan__linear_attn_block__mixer_gmlp__prompt'

def setup_inputs():

    _w = lambda a: (lambda t: t.to(torch.bfloat16) if t.is_floating_point() else t)(torch.as_tensor(a))

    def _A_setup():
        B, S, D = (1, 2048, 1024)
        return {'x': _w((lambda *s: torch.randn(*s, dtype=torch.bfloat16) * 0.05)(B, S, D)), 'wqkv': _w((lambda *s: torch.randn(*s, dtype=torch.bfloat16) * 0.05)(D, 3 * D)), 'wo': _w((lambda *s: torch.randn(*s, dtype=torch.bfloat16) * 0.05)(D, D))}
    _A_in = _A_setup()

    def _B_setup():
        B, S, D, F = (1, 2048, 1024, 3584)
        Fh = F // 2
        return {'x': _w((lambda *s: torch.randn(*s, dtype=torch.bfloat16) * 0.05)(B, S, D)), 'w_in': _w((lambda *s: torch.randn(*s, dtype=torch.bfloat16) * 0.4)(D, 2 * Fh)), 'w_sp': _w(0.01 * (lambda *s: torch.randn(*s, dtype=torch.bfloat16) * 0.4)(S, S)), 'b_sp': _w(1.0 + 0.01 * (lambda *s: torch.randn(*s, dtype=torch.bfloat16) * 0.05)(S)), 'w_out': _w((lambda *s: torch.randn(*s, dtype=torch.bfloat16) * 0.05)(Fh, D))}
    _B_in = _B_setup()
    return {'A_x': _A_in['x'], 'A_wqkv': _A_in['wqkv'], 'A_wo': _A_in['wo'], 'B_x': _B_in['x'], 'B_w_in': _B_in['w_in'], 'B_w_sp': _B_in['w_sp'], 'B_b_sp': _B_in['b_sp'], 'B_w_out': _B_in['w_out']}

def reference(A_x, A_wqkv, A_wo, B_x, B_w_in, B_w_sp, B_b_sp, B_w_out):

    def _A_ref(x, wqkv, wo):
        B, S, D = x.shape
        H = 32
        Dh = D // H
        qkv = (lambda x, *d: x.permute(*d))((x @ wqkv).reshape(B, S, 3, H, Dh), 2, 0, 3, 1, 4)
        q, k, v = (qkv[0], qkv[1], qkv[2])
        phi = lambda t: torch.where(t > 0, t + 1, torch.exp(t)) + 1e-06
        pq, pk = (phi(q), phi(k))
        kv = torch.einsum('bhsd,bhse->bhde', pk, v)
        z = torch.einsum('bhsd->bhd', pk)
        num = torch.einsum('bhqd,bhde->bhqe', pq, kv)
        den = torch.einsum('bhqd,bhd->bhq', pq, z)[..., None] + 1e-06
        o = num / den
        return (lambda x, *d: x.permute(*d))(o, 0, 2, 1, 3).reshape(B, S, D) @ wo

    def _B_ref(x, w_in, w_sp, b_sp, w_out):
        B, S, D = x.shape
        F = w_in.shape[-1]
        Fh = F // 2
        z = _gelu(torch.einsum('bsd,df->bsf', x, w_in))
        z1 = z[..., :Fh].clone()
        z2 = _layernorm(z[..., Fh:], axis=-1)
        g = torch.einsum('ts,bsf->btf', w_sp, z2) + b_sp[None, :, None]
        return torch.einsum('bsf,fd->bsd', z1 * g, w_out)
    x = A_x
    xn = _layernorm(x, axis=-1)
    s = _A_ref(xn, A_wqkv, A_wo)
    g = _silu(_B_ref(xn, B_w_in, B_w_sp, B_b_sp, B_w_out))
    return x + s * g
```

```asm
; @launch grid=(256,1,1) block=(512,1,1) lds=163840
.amdgcn_target "amdgcn-amd-amdhsa--gfx950"
.text
.globl recurrent_scan__linear_attn_block__mixer_gmlp__prompt_kernel
.p2align 8
.type recurrent_scan__linear_attn_block__mixer_gmlp__prompt_kernel,@function
recurrent_scan__linear_attn_block__mixer_gmlp__prompt_kernel:
L_start:
s_cmp_ge_u32 s2, 256
s_cbranch_scc1 L_end
s_load_dwordx16 s[24:39], s[0:1], 0
s_load_dwordx4 s[40:43], s[0:1], 64
s_load_dwordx2 s[44:45], s[0:1], 80
v_lshrrev_b32 v1, 6, v0
v_and_b32 v12, 63, v0
v_readfirstlane_b32 s20, v1
v_and_b32 v13, 7, v12
v_lshrrev_b32 v14, 3, v12
v_bfe_u32 v15, v12, 2, 1
v_and_b32_e64 v16, 3, v12
v_lshl_add_u32 v15, v15, 3, v16
v_lshlrev_b32_e64 v64, 11, v15
v_lshl_add_u32 v64, v14, 4, v64
v_and_b32 v15, 3, v14
v_lshlrev_b32 v65, 4, v13
v_lshl_add_u32 v65, v15, 8, v65
v_lshrrev_b32_e64 v15, 2, v14
v_lshl_add_u32 v65, v15, 13, v65
v_lshlrev_b32_e64 v63, 6, v13
v_add_u32 v63, 151552, v63
v_lshl_add_u32 v62, v1, 3, v63
s_and_b32 s21, s2, 1
s_lshl_b32 s21, s21, 3
s_bfe_u32 s46, s2, 0x30003
s_add_u32 s21, s21, s46
s_bfe_u32 s22, s2, 0x20001
s_lshl_b32 s22, s22, 2
s_lshr_b32 s46, s2, 6
s_add_u32 s22, s22, s46
s_and_b32 s50, s2, 3
s_lshl_b32 s50, s50, 2
s_bfe_u32 s46, s2, 0x20003
s_add_u32 s50, s50, s46
s_bfe_u32 s51, s2, 0x10002
s_lshl_b32 s51, s51, 3
s_lshr_b32 s46, s2, 5
s_add_u32 s51, s51, s46
s_lshl_b32 s49, s22, 2
s_mov_b32 s46, 0xea62bf73
s_mov_b32 s47, 0xc840d951
s_lshr_b64 s[46:47], s[46:47], s49
s_and_b32 s100, s46, 15
s_mov_b32 s46, 0xbf37c840
s_mov_b32 s47, 0xd951ea62
s_lshr_b64 s[46:47], s[46:47], s49
s_and_b32 s101, s46, 15
s_and_b32 s23, s20, 1
v_lshlrev_b32 v11, 4, v12
s_lshl_b32 s46, s20, 11
v_add_u32 v2, s46, v11
v_lshrrev_b32 v13, 2, v12
s_lshl_b32 s46, s23, 4
v_add_u32 v13, s46, v13
v_bfe_u32 v14, v12, 5, 1
v_lshlrev_b32 v14, 1, v14
v_and_b32 v15, 3, v12
v_xor_b32 v14, v14, v15
v_lshrrev_b32 v16, 1, v14
v_lshlrev_b32_e64 v14, 4, v14
v_mul_u32_u24 v3, 6144, v13
v_add_u32_e64 v3, v3, v14
v_mul_u32_u24 v4, 7168, v13
v_add_u32 v4, v4, v14
s_lshl_b32 s46, s23, 12
v_add_u32_e64 v5, s46, v11
v_add_u32 v6, 69632, v5
v_lshrrev_b32_e64 v13, 5, v12
v_mul_u32_u24 v7, 13312, v13
v_bfe_u32 v13, v12, 4, 1
v_mul_u32_u24 v14, 544, v13
v_add_u32_e64 v7, v7, v14
v_bfe_u32 v14, v12, 2, 2
v_lshl_add_u32 v7, v14, 6, v7
v_lshl_add_u32 v7, v15, 3, v7
v_add_u32 v7, 8192, v7
v_xor_b32_e64 v8, 32, v7
v_add_u32 v9, 69632, v7
v_add_u32 v10, 69632, v8
s_and_b32 s46, s22, 1
s_cmp_eq_u32 s46, 0
s_cselect_b32 s47, 192, 0
s_lshl_b32 s46, s46, 5
v_mul_u32_u24 v15, 3552, v16
v_add_u32 v15, v15, v4
v_add_u32 v15, s47, v15
v_add_u32 v4, s46, v4
s_lshl_b32 s48, s21, 2
s_lshr_b32 s46, s22, 2
s_add_u32 s48, s48, s46
s_lshl_b32 s48, s48, 5
s_bfe_u32 s46, s22, 0x10001
s_lshl_b32 s46, s46, 2
s_add_u32 s48, s48, s46
s_and_b32 s46, s22, 1
s_lshl_b32 s46, s46, 4
s_add_u32 s48, s48, s46
s_lshl_b32 s48, s48, 11
s_lshl_b32 s46, s20, 8
s_add_u32 s48, s48, s46
s_waitcnt lgkmcnt(0)
s_mov_b32 s52, s24
s_and_b32 s53, s25, 0xffff
s_mov_b32 s54, 0x400000
s_mov_b32 s55, 0x00020000
buffer_load_dwordx4 v[16:19], v64, s[52:55], s48 offen offset:0
buffer_load_dwordx4 v[20:23], v64, s[52:55], s48 offen offset:128
s_mov_b32 s16, s44
s_and_b32 s17, s45, 0xffff
s_mov_b32 s18, 0x10000000
s_mov_b32 s19, 0x00020000
s_mov_b32 s8, s26
s_and_b32 s9, s27, 0xffff
s_mov_b32 s10, 0x600000
s_mov_b32 s11, 0x00020000
s_mov_b32 s12, s32
s_and_b32 s13, s33, 0xffff
s_mov_b32 s14, 0x700000
s_mov_b32 s15, 0x00020000
s_mov_b32 s4, s42
s_and_b32 s5, s43, 0xffff
s_mov_b32 s6, 0x100
s_mov_b32 s7, 0x00020000
s_mov_b32 s56, s34
s_and_b32 s57, s35, 0xffff
s_mov_b32 s58, 0x800000
s_mov_b32 s59, 0x00020000
s_mov_b32 s60, s36
s_and_b32 s61, s37, 0xffff
s_mov_b32 s62, 0x1000
s_mov_b32 s63, 0x00020000
s_mov_b32 s64, s28
s_and_b32 s65, s29, 0xffff
s_mov_b32 s66, 0x200000
s_mov_b32 s67, 0x00020000
s_mov_b32 s68, s38
s_and_b32 s69, s39, 0xffff
s_mov_b32 s70, 0x380000
s_mov_b32 s71, 0x00020000
s_mov_b32 s72, s40
s_and_b32 s73, s41, 0xffff
s_mov_b32 s74, 0x400000
s_mov_b32 s75, 0x00020000
s_lshr_b32 s46, s20, 1
s_cmp_eq_u32 s46, 1
s_cbranch_scc1 L_g1
s_cmp_eq_u32 s46, 2
s_cbranch_scc1 L_g2
s_cmp_eq_u32 s46, 3
s_cbranch_scc1 L_g3
L_g0:
s_lshl_b32 s24, s21, 18
s_lshl_b32 s25, s101, 7
s_mul_i32 s26, s22, 224
s_lshl_b32 s27, s20, 11
s_mul_i32 s28, s23, 13312
s_lshr_b32 s30, s22, 1
s_and_b32 s31, s22, 1
s_add_u32 m0, s28, 8192
s_nop 0
buffer_load_dwordx4 v3, s[8:11], s25 offen offset:0 lds
s_add_u32 m0, s28, 9152
s_nop 0
buffer_load_dwordx4 v3, s[8:11], s25 offen offset:64 lds
s_add_u32 s25, s25, 196608
s_add_u32 m0, s28, 43008
s_nop 0
buffer_load_dwordx4 v3, s[8:11], s25 offen offset:0 lds
s_add_u32 m0, s28, 43968
s_nop 0
buffer_load_dwordx4 v3, s[8:11], s25 offen offset:64 lds
s_add_u32 s25, s25, 196608
s_lshl_b32 s33, s21, 4
s_add_u32 s33, s33, s22
s_lshl_b32 s33, s33, 10
s_add_u32 s33, s33, 46235648
s_mul_i32 s34, s100, 6144
s_mul_i32 s35, s21, 384
s_add_u32 s34, s34, s35
s_add_u32 s34, s34, 46137344
s_cmp_eq_u32 s23, 0
s_cselect_b32 s33, s33, s34
s_cselect_b32 s34, 63, 23
v_min_u32 v68, s34, v12
v_lshlrev_b32 v68, 4, v68
v_mov_b32 v72, -1
v_mov_b32 v73, -1
v_mov_b32 v74, -1
v_mov_b32 v75, -1
buffer_store_dwordx4 v[72:75], v68, s[16:19], s33 offen sc1
s_lshl_b32 s32, s21, 18
s_lshl_b32 s33, s30, 10
s_add_u32 s32, s32, s33
s_lshl_b32 s33, s31, 7
s_add_u32 s32, s32, s33
s_lshl_b32 s33, s20, 15
s_add_u32 s32, s32, s33
s_add_u32 s33, s32, 16384
s_mov_b32 s36, 0xffff0000
s_waitcnt vmcnt(5)
v_lshlrev_b32 v32, 16, v16
v_and_b32 v33, s36, v16
v_lshlrev_b32 v34, 16, v17
v_and_b32 v35, s36, v17
v_lshlrev_b32 v36, 16, v18
v_and_b32 v37, s36, v18
v_lshlrev_b32 v38, 16, v19
v_and_b32 v39, s36, v19
v_lshlrev_b32 v40, 16, v20
v_and_b32 v41, s36, v20
v_lshlrev_b32 v42, 16, v21
v_and_b32 v43, s36, v21
v_lshlrev_b32 v44, 16, v22
v_and_b32 v45, s36, v22
v_lshlrev_b32 v46, 16, v23
v_and_b32 v47, s36, v23
v_pk_add_f32 v[66:67], v[32:33], v[34:35]
v_pk_mul_f32 v[68:69], v[32:33], v[32:33]
v_pk_fma_f32 v[68:69], v[34:35], v[34:35], v[68:69]
v_pk_add_f32 v[66:67], v[66:67], v[36:37]
v_pk_fma_f32 v[68:69], v[36:37], v[36:37], v[68:69]
v_pk_add_f32 v[66:67], v[66:67], v[38:39]
v_pk_fma_f32 v[68:69], v[38:39], v[38:39], v[68:69]
v_pk_add_f32 v[66:67], v[66:67], v[40:41]
v_pk_fma_f32 v[68:69], v[40:41], v[40:41], v[68:69]
v_pk_add_f32 v[66:67], v[66:67], v[42:43]
v_pk_fma_f32 v[68:69], v[42:43], v[42:43], v[68:69]
v_pk_add_f32 v[66:67], v[66:67], v[44:45]
v_pk_fma_f32 v[68:69], v[44:45], v[44:45], v[68:69]
v_pk_add_f32 v[66:67], v[66:67], v[46:47]
v_pk_fma_f32 v[68:69], v[46:47], v[46:47], v[68:69]
v_add_f32 v66, v66, v67
v_add_f32_e64 v67, v68, v69
s_nop 1
v_add_f32_dpp v66, v66, v66 row_ror:8 row_mask:0xf bank_mask:0xf
v_add_f32_dpp v67, v67, v67 row_ror:8 row_mask:0xf bank_mask:0xf
v_mov_b32 v68, v66
v_mov_b32 v69, v67
s_nop 1
v_permlane16_swap_b32 v68, v66
v_permlane16_swap_b32 v69, v67
s_nop 1
v_pk_add_f32 v[66:67], v[66:67], v[68:69]
v_mov_b32 v68, v66
v_mov_b32 v69, v67
s_nop 1
v_permlane32_swap_b32 v68, v66
v_permlane32_swap_b32 v69, v67
s_nop 1
v_pk_add_f32 v[66:67], v[66:67], v[68:69]
s_mov_b64 exec, 0xff
ds_write_b64 v62, v[66:67]
s_nop 0
s_mov_b64 exec, -1
s_waitcnt lgkmcnt(0)
s_barrier
ds_read_b128 v[16:19], v63 offset:0
ds_read_b128 v[20:23], v63 offset:16
ds_read_b128 v[24:27], v63 offset:32
ds_read_b128 v[28:31], v63 offset:48
s_nop 0
s_waitcnt lgkmcnt(0)
v_pk_add_f32 v[16:17], v[16:17], v[24:25]
v_pk_add_f32 v[18:19], v[18:19], v[26:27]
v_pk_add_f32 v[20:21], v[20:21], v[28:29]
v_pk_add_f32 v[22:23], v[22:23], v[30:31]
v_pk_add_f32 v[16:17], v[16:17], v[20:21]
v_pk_add_f32 v[18:19], v[18:19], v[22:23]
v_pk_add_f32 v[16:17], v[16:17], v[18:19]
v_mul_f32 v16, 0x3a800000, v16
v_mul_f32 v17, 0x3a800000, v17
v_fma_f32 v17, -v16, v16, v17
v_max_f32_e64 v17, 0, v17
v_add_f32 v17, 0x3727c5ac, v17
v_rsq_f32 v18, v17
v_mul_f32 v16, -1.0, v16
v_mov_b32 v17, v16
v_mov_b32 v19, v18
v_pk_add_f32 v[32:33], v[32:33], v[16:17]
v_pk_add_f32 v[34:35], v[34:35], v[16:17]
v_pk_add_f32 v[36:37], v[36:37], v[16:17]
v_pk_add_f32 v[38:39], v[38:39], v[16:17]
v_pk_add_f32 v[40:41], v[40:41], v[16:17]
v_pk_add_f32 v[42:43], v[42:43], v[16:17]
v_pk_add_f32 v[44:45], v[44:45], v[16:17]
v_pk_add_f32 v[46:47], v[46:47], v[16:17]
v_pk_mul_f32 v[32:33], v[32:33], v[18:19]
v_pk_mul_f32 v[34:35], v[34:35], v[18:19]
v_pk_mul_f32 v[36:37], v[36:37], v[18:19]
v_pk_mul_f32 v[38:39], v[38:39], v[18:19]
v_pk_mul_f32 v[40:41], v[40:41], v[18:19]
v_pk_mul_f32 v[42:43], v[42:43], v[18:19]
v_pk_mul_f32 v[44:45], v[44:45], v[18:19]
v_pk_mul_f32 v[46:47], v[46:47], v[18:19]
v_cvt_pk_bf16_f32 v20, v32, v33
v_cvt_pk_bf16_f32 v21, v34, v35
v_cvt_pk_bf16_f32 v22, v36, v37
v_cvt_pk_bf16_f32 v23, v38, v39
v_cvt_pk_bf16_f32 v24, v40, v41
v_cvt_pk_bf16_f32 v25, v42, v43
v_cvt_pk_bf16_f32 v26, v44, v45
v_cvt_pk_bf16_f32 v27, v46, v47
buffer_store_dwordx4 v[20:23], v65, s[16:19], s32 offen sc1
buffer_store_dwordx4 v[24:27], v65, s[16:19], s33 offen sc1
s_lshl_b32 s30, s21, 4
s_waitcnt vmcnt(0)
s_barrier
s_cmp_lg_u32 s20, 0
s_cbranch_scc1 L_noarr_1
v_mov_b32 v66, 1
v_mov_b32 v67, 0
s_mov_b64 exec, 1
buffer_atomic_add v66, v67, s[4:7], s30 offen sc1
s_mov_b64 exec, -1
L_noarr_1:
s_add_u32 m0, s28, 77824
s_nop 0
buffer_load_dwordx4 v3, s[8:11], s25 offen offset:0 lds
s_add_u32 m0, s28, 78784
s_nop 0
buffer_load_dwordx4 v3, s[8:11], s25 offen offset:64 lds
s_add_u32 s25, s25, 196608
s_add_u32 m0, s28, 112640
s_nop 0
buffer_load_dwordx4 v3, s[8:11], s25 offen offset:0 lds
s_add_u32 m0, s28, 113600
s_nop 0
buffer_load_dwordx4 v3, s[8:11], s25 offen offset:64 lds
s_add_u32 s25, s25, 196608
v_lshrrev_b32 v13, 3, v12
v_lshrrev_b32 v14, 5, v12
v_and_b32 v123, 3, v13
v_lshl_add_u32 v14, v14, 3, v123
v_lshlrev_b32 v14, 12, v14
v_lshrrev_b32 v13, 4, v12
v_and_b32 v123, 7, v12
v_xor_b32 v13, v13, v123
v_lshl_add_u32 v112, v13, 4, v14
v_xor_b32_e64 v113, 64, v112
v_add_u32 v114, 14336, v112
v_add_u32 v115, 78848, v113
v_add_u32 v113, 64512, v113
v_and_b32 v13, 15, v12
v_lshrrev_b32 v14, 1, v13
v_lshrrev_b32 v123, 4, v12
v_xor_b32 v14, v14, v123
v_lshlrev_b32_e64 v14, 4, v14
v_lshl_add_u32 v116, v13, 7, v14
s_and_b32 s36, s20, 3
s_lshl_b32 s36, s36, 12
v_add_u32 v116, s36, v116
v_xor_b32 v117, 64, v116
v_add_u32 v118, 61440, v116
v_add_u32 v119, 61440, v117
s_lshr_b32 s36, s20, 2
s_lshl_b32 s36, s36, 12
s_add_u32 s36, s36, 16384
v_add_u32_e64 v121, s36, v11
v_add_u32 v122, 61440, v121
v_bfe_u32 v13, v12, 2, 2
v_and_b32_e64 v14, 3, v12
v_lshl_add_u32 v13, v13, 3, v14
v_lshlrev_b32 v120, 1, v13
s_cmp_lg_u32 s20, 0
s_cbranch_scc1 L_nox_2
s_mov_b32 s36, 0
L_poll_3:
v_mov_b32 v67, 0
s_mov_b64 exec, 1
buffer_load_dword v66, v67, s[4:7], s30 offen sc1
s_mov_b64 exec, -1
s_waitcnt vmcnt(0)
L_pollc_5:
v_readfirstlane_b32 s37, v66
s_add_u32 s36, s36, 1
s_cmp_ge_u32 s37, 16
s_cbranch_scc1 L_pollx_4
s_cmp_lt_u32 s36, 6000
s_cbranch_scc1 L_poll_3
L_pollx_4:
L_nox_2:
s_barrier
s_add_u32 m0, s27, 0
s_nop 0
buffer_load_dwordx4 v2, s[16:19], s24 offen sc1 lds
buffer_load_dwordx4 v2, s[16:19], s24 offen offset:1024 sc1 lds
s_add_u32 s24, s24, 8192
s_add_u32 m0, s27, 34816
s_nop 0
s_nop 0
buffer_load_dwordx4 v2, s[16:19], s24 offen sc1 lds
buffer_load_dwordx4 v2, s[16:19], s24 offen offset:1024 sc1 lds
s_add_u32 s24, s24, 8192
s_add_u32 m0, s27, 69632
s_nop 0
s_nop 0
buffer_load_dwordx4 v2, s[16:19], s24 offen sc1 lds
buffer_load_dwordx4 v2, s[16:19], s24 offen offset:1024 sc1 lds
s_add_u32 s24, s24, 8192
s_add_u32 m0, s27, 104448
s_nop 0
buffer_load_dwordx4 v2, s[16:19], s24 offen sc1 lds
buffer_load_dwordx4 v2, s[16:19], s24 offen offset:1024 sc1 lds
s_add_u32 s24, s24, 8192
s_nop 0
s_waitcnt vmcnt(6)
s_barrier
ds_read_b128 v[16:19], v5 offset:0
ds_read_b128 v[20:23], v5 offset:1024
ds_read_b128 v[24:27], v5 offset:2048
ds_read_b128 v[28:31], v5 offset:3072
ds_read_b64_tr_b16 v[48:49], v7 offset:2048
ds_read_b64_tr_b16 v[50:51], v7 offset:2304
ds_read_b64_tr_b16 v[52:53], v8 offset:2048
ds_read_b64_tr_b16 v[54:55], v8 offset:2304
ds_read_b64_tr_b16 v[56:57], v7 offset:4096
ds_read_b64_tr_b16 v[58:59], v7 offset:4352
ds_read_b64_tr_b16 v[60:61], v8 offset:4096
ds_read_b64_tr_b16 v[62:63], v8 offset:4352
ds_read_b64_tr_b16 v[64:65], v7 offset:10240
ds_read_b64_tr_b16 v[66:67], v7 offset:10496
ds_read_b64_tr_b16 v[68:69], v8 offset:10240
ds_read_b64_tr_b16 v[70:71], v8 offset:10496
ds_read_b64_tr_b16 v[72:73], v7 offset:6144
ds_read_b64_tr_b16 v[74:75], v7 offset:6400
s_waitcnt vmcnt(4) lgkmcnt(0)
s_barrier
v_mfma_f32_16x16x32_bf16 v[128:131], v[16:19], v[48:51], 0
ds_read_b128 v[32:35], v5 offset:34816
v_mfma_f32_16x16x32_bf16 v[132:135], v[20:23], v[48:51], 0
ds_read_b128 v[36:39], v5 offset:35840
v_mfma_f32_16x16x32_bf16 v[136:139], v[24:27], v[48:51], 0
ds_read_b128 v[40:43], v5 offset:36864
s_nop 0
s_add_u32 m0, s27, 0
v_mfma_f32_16x16x32_bf16 v[140:143], v[28:31], v[48:51], 0
ds_read_b128 v[44:47], v5 offset:37888
buffer_load_dwordx4 v2, s[16:19], s24 offen sc1 lds
v_mfma_f32_16x16x32_bf16 v[144:147], v[16:19], v[52:55], 0
ds_read_b64_tr_b16 v[76:77], v7 offset:36864
v_mfma_f32_16x16x32_bf16 v[148:151], v[20:23], v[52:55], 0
ds_read_b64_tr_b16 v[78:79], v7 offset:37120
v_mfma_f32_16x16x32_bf16 v[152:155], v[24:27], v[52:55], 0
ds_read_b64_tr_b16 v[80:81], v8 offset:36864
v_mfma_f32_16x16x32_bf16 v[156:159], v[28:31], v[52:55], 0
ds_read_b64_tr_b16 v[82:83], v8 offset:37120
v_mfma_f32_16x16x32_bf16 v[160:163], v[16:19], v[56:59], 0
ds_read_b64_tr_b16 v[84:85], v7 offset:38912
buffer_load_dwordx4 v2, s[16:19], s24 offen offset:1024 sc1 lds
s_add_u32 s24, s24, 8192
v_mfma_f32_16x16x32_bf16 v[164:167], v[20:23], v[56:59], 0
ds_read_b64_tr_b16 v[86:87], v7 offset:39168
v_mfma_f32_16x16x32_bf16 v[168:171], v[24:27], v[56:59], 0
ds_read_b64_tr_b16 v[88:89], v8 offset:38912
v_mfma_f32_16x16x32_bf16 v[172:175], v[28:31], v[56:59], 0
ds_read_b64_tr_b16 v[90:91], v8 offset:39168
v_mfma_f32_16x16x32_bf16 v[176:179], v[16:19], v[60:63], 0
ds_read_b64_tr_b16 v[92:93], v7 offset:45056
s_add_u32 m0, s28, 8192
v_mfma_f32_16x16x32_bf16 v[180:183], v[20:23], v[60:63], 0
ds_read_b64_tr_b16 v[94:95], v7 offset:45312
buffer_load_dwordx4 v3, s[8:11], s25 offen offset:0 lds
v_mfma_f32_16x16x32_bf16 v[184:187], v[24:27], v[60:63], 0
ds_read_b64_tr_b16 v[96:97], v8 offset:45056
v_mfma_f32_16x16x32_bf16 v[188:191], v[28:31], v[60:63], 0
ds_read_b64_tr_b16 v[98:99], v8 offset:45312
v_mfma_f32_16x16x32_bf16 v[192:195], v[16:19], v[64:67], 0
ds_read_b64_tr_b16 v[100:101], v7 offset:40960
v_mfma_f32_16x16x32_bf16 v[196:199], v[20:23], v[64:67], 0
ds_read_b64_tr_b16 v[102:103], v7 offset:41216
s_add_u32 m0, s28, 9152
v_mfma_f32_16x16x32_bf16 v[200:203], v[24:27], v[64:67], 0
buffer_load_dwordx4 v3, s[8:11], s25 offen offset:64 lds
s_add_u32 s25, s25, 196608
v_mfma_f32_16x16x32_bf16 v[204:207], v[28:31], v[64:67], 0
v_mfma_f32_16x16x32_bf16 v[208:211], v[16:19], v[68:71], 0
v_mfma_f32_16x16x32_bf16 v[212:215], v[20:23], v[68:71], 0
v_mfma_f32_16x16x32_bf16 v[216:219], v[24:27], v[68:71], 0
v_mfma_f32_16x16x32_bf16 v[220:223], v[28:31], v[68:71], 0
v_mfma_f32_16x16x32_bf16 v[224:227], v[72:75], v[16:19], 0
v_mfma_f32_16x16x32_bf16 v[228:231], v[72:75], v[20:23], 0
v_mfma_f32_16x16x32_bf16 v[232:235], v[72:75], v[24:27], 0
v_mfma_f32_16x16x32_bf16 v[236:239], v[72:75], v[28:31], 0
s_waitcnt vmcnt(6) lgkmcnt(0)
s_barrier
v_mfma_f32_16x16x32_bf16 v[128:131], v[32:35], v[76:79], v[128:131]
ds_read_b128 v[16:19], v6 offset:0
v_mfma_f32_16x16x32_bf16 v[132:135], v[36:39], v[76:79], v[132:135]
ds_read_b128 v[20:23], v6 offset:1024
v_mfma_f32_16x16x32_bf16 v[136:139], v[40:43], v[76:79], v[136:139]
ds_read_b128 v[24:27], v6 offset:2048
s_add_u32 m0, s27, 34816
v_mfma_f32_16x16x32_bf16 v[140:143], v[44:47], v[76:79], v[140:143]
ds_read_b128 v[28:31], v6 offset:3072
buffer_load_dwordx4 v2, s[16:19], s24 offen sc1 lds
v_mfma_f32_16x16x32_bf16 v[144:147], v[32:35], v[80:83], v[144:147]
ds_read_b64_tr_b16 v[48:49], v9 offset:2048
v_mfma_f32_16x16x32_bf16 v[148:151], v[36:39], v[80:83], v[148:151]
ds_read_b64_tr_b16 v[50:51], v9 offset:2304
v_mfma_f32_16x16x32_bf16 v[152:155], v[40:43], v[80:83], v[152:155]
ds_read_b64_tr_b16 v[52:53], v10 offset:2048
v_mfma_f32_16x16x32_bf16 v[156:159], v[44:47], v[80:83], v[156:159]
ds_read_b64_tr_b16 v[54:55], v10 offset:2304
v_mfma_f32_16x16x32_bf16 v[160:163], v[32:35], v[84:87], v[160:163]
ds_read_b64_tr_b16 v[56:57], v9 offset:4096
buffer_load_dwordx4 v2, s[16:19], s24 offen offset:1024 sc1 lds
s_add_u32 s24, s24, 8192
v_mfma_f32_16x16x32_bf16 v[164:167], v[36:39], v[84:87], v[164:167]
ds_read_b64_tr_b16 v[58:59], v9 offset:4352
v_mfma_f32_16x16x32_bf16 v[168:171], v[40:43], v[84:87], v[168:171]
ds_read_b64_tr_b16 v[60:61], v10 offset:4096
v_mfma_f32_16x16x32_bf16 v[172:175], v[44:47], v[84:87], v[172:175]
ds_read_b64_tr_b16 v[62:63], v10 offset:4352
v_mfma_f32_16x16x32_bf16 v[176:179], v[32:35], v[88:91], v[176:179]
ds_read_b64_tr_b16 v[64:65], v9 offset:10240
s_add_u32 m0, s28, 43008
v_mfma_f32_16x16x32_bf16 v[180:183], v[36:39], v[88:91], v[180:183]
ds_read_b64_tr_b16 v[66:67], v9 offset:10496
buffer_load_dwordx4 v3, s[8:11], s25 offen offset:0 lds
v_mfma_f32_16x16x32_bf16 v[184:187], v[40:43], v[88:91], v[184:187]
ds_read_b64_tr_b16 v[68:69], v10 offset:10240
v_mfma_f32_16x16x32_bf16 v[188:191], v[44:47], v[88:91], v[188:191]
ds_read_b64_tr_b16 v[70:71], v10 offset:10496
v_mfma_f32_16x16x32_bf16 v[192:195], v[32:35], v[92:95], v[192:195]
ds_read_b64_tr_b16 v[72:73], v9 offset:6144
v_mfma_f32_16x16x32_bf16 v[196:199], v[36:39], v[92:95], v[196:199]
ds_read_b64_tr_b16 v[74:75], v9 offset:6400
s_add_u32 m0, s28, 43968
v_mfma_f32_16x16x32_bf16 v[200:203], v[40:43], v[92:95], v[200:203]
buffer_load_dwordx4 v3, s[8:11], s25 offen offset:64 lds
s_add_u32 s25, s25, 196608
v_mfma_f32_16x16x32_bf16 v[204:207], v[44:47], v[92:95], v[204:207]
v_mfma_f32_16x16x32_bf16 v[208:211], v[32:35], v[96:99], v[208:211]
v_mfma_f32_16x16x32_bf16 v[212:215], v[36:39], v[96:99], v[212:215]
v_mfma_f32_16x16x32_bf16 v[216:219], v[40:43], v[96:99], v[216:219]
v_mfma_f32_16x16x32_bf16 v[220:223], v[44:47], v[96:99], v[220:223]
v_mfma_f32_16x16x32_bf16 v[224:227], v[100:103], v[32:35], v[224:227]
v_mfma_f32_16x16x32_bf16 v[228:231], v[100:103], v[36:39], v[228:231]
v_mfma_f32_16x16x32_bf16 v[232:235], v[100:103], v[40:43], v[232:235]
v_mfma_f32_16x16x32_bf16 v[236:239], v[100:103], v[44:47], v[236:239]
s_waitcnt vmcnt(8) lgkmcnt(0)
s_barrier
v_mfma_f32_16x16x32_bf16 v[128:131], v[16:19], v[48:51], v[128:131]
ds_read_b128 v[32:35], v6 offset:34816
v_mfma_f32_16x16x32_bf16 v[132:135], v[20:23], v[48:51], v[132:135]
ds_read_b128 v[36:39], v6 offset:35840
v_mfma_f32_16x16x32_bf16 v[136:139], v[24:27], v[48:51], v[136:139]
ds_read_b128 v[40:43], v6 offset:36864
s_add_u32 m0, s27, 69632
v_mfma_f32_16x16x32_bf16 v[140:143], v[28:31], v[48:51], v[140:143]
ds_read_b128 v[44:47], v6 offset:37888
buffer_load_dwordx4 v2, s[16:19], s24 offen sc1 lds
v_mfma_f32_16x16x32_bf16 v[144:147], v[16:19], v[52:55], v[144:147]
ds_read_b64_tr_b16 v[76:77], v9 offset:36864
v_mfma_f32_16x16x32_bf16 v[148:151], v[20:23], v[52:55], v[148:151]
ds_read_b64_tr_b16 v[78:79], v9 offset:37120
v_mfma_f32_16x16x32_bf16 v[152:155], v[24:27], v[52:55], v[152:155]
ds_read_b64_tr_b16 v[80:81], v10 offset:36864
v_mfma_f32_16x16x32_bf16 v[156:159], v[28:31], v[52:55], v[156:159]
ds_read_b64_tr_b16 v[82:83], v10 offset:37120
v_mfma_f32_16x16x32_bf16 v[160:163], v[16:19], v[56:59], v[160:163]
ds_read_b64_tr_b16 v[84:85], v9 offset:38912
buffer_load_dwordx4 v2, s[16:19], s24 offen offset:1024 sc1 lds
s_add_u32 s24, s24, 8192
v_mfma_f32_16x16x32_bf16 v[164:167], v[20:23], v[56:59], v[164:167]
ds_read_b64_tr_b16 v[86:87], v9 offset:39168
v_mfma_f32_16x16x32_bf16 v[168:171], v[24:27], v[56:59], v[168:171]
ds_read_b64_tr_b16 v[88:89], v10 offset:38912
v_mfma_f32_16x16x32_bf16 v[172:175], v[28:31], v[56:59], v[172:175]
ds_read_b64_tr_b16 v[90:91], v10 offset:39168
v_mfma_f32_16x16x32_bf16 v[176:179], v[16:19], v[60:63], v[176:179]
ds_read_b64_tr_b16 v[92:93], v9 offset:45056
s_add_u32 m0, s28, 77824
v_mfma_f32_16x16x32_bf16 v[180:183], v[20:23], v[60:63], v[180:183]
ds_read_b64_tr_b16 v[94:95], v9 offset:45312
buffer_load_dwordx4 v3, s[8:11], s25 offen offset:0 lds
v_mfma_f32_16x16x32_bf16 v[184:187], v[24:27], v[60:63], v[184:187]
ds_read_b64_tr_b16 v[96:97], v10 offset:45056
v_mfma_f32_16x16x32_bf16 v[188:191], v[28:31], v[60:63], v[188:191]
ds_read_b64_tr_b16 v[98:99], v10 offset:45312
v_mfma_f32_16x16x32_bf16 v[192:195], v[16:19], v[64:67], v[192:195]
ds_read_b64_tr_b16 v[100:101], v9 offset:40960
v_mfma_f32_16x16x32_bf16 v[196:199], v[20:23], v[64:67], v[196:199]
ds_read_b64_tr_b16 v[102:103], v9 offset:41216
s_add_u32 m0, s28, 78784
v_mfma_f32_16x16x32_bf16 v[200:203], v[24:27], v[64:67], v[200:203]
buffer_load_dwordx4 v3, s[8:11], s25 offen offset:64 lds
s_add_u32 s25, s25, 196608
v_mfma_f32_16x16x32_bf16 v[204:207], v[28:31], v[64:67], v[204:207]
v_mfma_f32_16x16x32_bf16 v[208:211], v[16:19], v[68:71], v[208:211]
v_mfma_f32_16x16x32_bf16 v[212:215], v[20:23], v[68:71], v[212:215]
v_mfma_f32_16x16x32_bf16 v[216:219], v[24:27], v[68:71], v[216:219]
v_mfma_f32_16x16x32_bf16 v[220:223], v[28:31], v[68:71], v[220:223]
v_mfma_f32_16x16x32_bf16 v[224:227], v[72:75], v[16:19], v[224:227]
v_mfma_f32_16x16x32_bf16 v[228:231], v[72:75], v[20:23], v[228:231]
v_mfma_f32_16x16x32_bf16 v[232:235], v[72:75], v[24:27], v[232:235]
v_mfma_f32_16x16x32_bf16 v[236:239], v[72:75], v[28:31], v[236:239]
s_waitcnt vmcnt(8) lgkmcnt(0)
s_barrier
v_mfma_f32_16x16x32_bf16 v[128:131], v[32:35], v[76:79], v[128:131]
ds_read_b128 v[16:19], v5 offset:0
v_mfma_f32_16x16x32_bf16 v[132:135], v[36:39], v[76:79], v[132:135]
ds_read_b128 v[20:23], v5 offset:1024
v_mfma_f32_16x16x32_bf16 v[136:139], v[40:43], v[76:79], v[136:139]
ds_read_b128 v[24:27], v5 offset:2048
s_add_u32 m0, s27, 104448
v_mfma_f32_16x16x32_bf16 v[140:143], v[44:47], v[76:79], v[140:143]
ds_read_b128 v[28:31], v5 offset:3072
buffer_load_dwordx4 v2, s[16:19], s24 offen sc1 lds
v_mfma_f32_16x16x32_bf16 v[144:147], v[32:35], v[80:83], v[144:147]
ds_read_b64_tr_b16 v[48:49], v7 offset:2048
v_mfma_f32_16x16x32_bf16 v[148:151], v[36:39], v[80:83], v[148:151]
ds_read_b64_tr_b16 v[50:51], v7 offset:2304
v_mfma_f32_16x16x32_bf16 v[152:155], v[40:43], v[80:83], v[152:155]
ds_read_b64_tr_b16 v[52:53], v8 offset:2048
v_mfma_f32_16x16x32_bf16 v[156:159], v[44:47], v[80:83], v[156:159]
ds_read_b64_tr_b16 v[54:55], v8 offset:2304
v_mfma_f32_16x16x32_bf16 v[160:163], v[32:35], v[84:87], v[160:163]
ds_read_b64_tr_b16 v[56:57], v7 offset:4096
buffer_load_dwordx4 v2, s[16:19], s24 offen offset:1024 sc1 lds
s_add_u32 s24, s24, 8192
v_mfma_f32_16x16x32_bf16 v[164:167], v[36:39], v[84:87], v[164:167]
ds_read_b64_tr_b16 v[58:59], v7 offset:4352
v_mfma_f32_16x16x32_bf16 v[168:171], v[40:43], v[84:87], v[168:171]
ds_read_b64_tr_b16 v[60:61], v8 offset:4096
v_mfma_f32_16x16x32_bf16 v[172:175], v[44:47], v[84:87], v[172:175]
ds_read_b64_tr_b16 v[62:63], v8 offset:4352
v_mfma_f32_16x16x32_bf16 v[176:179], v[32:35], v[88:91], v[176:179]
ds_read_b64_tr_b16 v[64:65], v7 offset:10240
s_add_u32 m0, s28, 112640
v_mfma_f32_16x16x32_bf16 v[180:183], v[36:39], v[88:91], v[180:183]
ds_read_b64_tr_b16 v[66:67], v7 offset:10496
buffer_load_dwordx4 v3, s[8:11], s25 offen offset:0 lds
v_mfma_f32_16x16x32_bf16 v[184:187], v[40:43], v[88:91], v[184:187]
ds_read_b64_tr_b16 v[68:69], v8 offset:10240
v_mfma_f32_16x16x32_bf16 v[188:191], v[44:47], v[88:91], v[188:191]
ds_read_b64_tr_b16 v[70:71], v8 offset:10496
v_mfma_f32_16x16x32_bf16 v[192:195], v[32:35], v[92:95], v[192:195]
ds_read_b64_tr_b16 v[72:73], v7 offset:6144
v_mfma_f32_16x16x32_bf16 v[196:199], v[36:39], v[92:95], v[196:199]
ds_read_b64_tr_b16 v[74:75], v7 offset:6400
s_add_u32 m0, s28, 113600
v_mfma_f32_16x16x32_bf16 v[200:203], v[40:43], v[92:95], v[200:203]
buffer_load_dwordx4 v3, s[8:11], s25 offen offset:64 lds
s_add_u32 s25, s25, 196608
v_mfma_f32_16x16x32_bf16 v[204:207], v[44:47], v[92:95], v[204:207]
v_mfma_f32_16x16x32_bf16 v[208:211], v[32:35], v[96:99], v[208:211]
v_mfma_f32_16x16x32_bf16 v[212:215], v[36:39], v[96:99], v[212:215]
v_mfma_f32_16x16x32_bf16 v[216:219], v[40:43], v[96:99], v[216:219]
v_mfma_f32_16x16x32_bf16 v[220:223], v[44:47], v[96:99], v[220:223]
v_mfma_f32_16x16x32_bf16 v[224:227], v[100:103], v[32:35], v[224:227]
v_mfma_f32_16x16x32_bf16 v[228:231], v[100:103], v[36:39], v[228:231]
v_mfma_f32_16x16x32_bf16 v[232:235], v[100:103], v[40:43], v[232:235]
v_mfma_f32_16x16x32_bf16 v[236:239], v[100:103], v[44:47], v[236:239]
s_nop 0
s_mov_b32 s29, 6
L_loop1_0:
s_waitcnt vmcnt(8) lgkmcnt(0)
s_barrier
v_mfma_f32_16x16x32_bf16 v[128:131], v[16:19], v[48:51], v[128:131]
ds_read_b128 v[32:35], v5 offset:34816
v_mfma_f32_16x16x32_bf16 v[132:135], v[20:23], v[48:51], v[132:135]
ds_read_b128 v[36:39], v5 offset:35840
v_mfma_f32_16x16x32_bf16 v[136:139], v[24:27], v[48:51], v[136:139]
ds_read_b128 v[40:43], v5 offset:36864
s_nop 0
s_add_u32 m0, s27, 0
v_mfma_f32_16x16x32_bf16 v[140:143], v[28:31], v[48:51], v[140:143]
ds_read_b128 v[44:47], v5 offset:37888
buffer_load_dwordx4 v2, s[16:19], s24 offen sc1 lds
v_mfma_f32_16x16x32_bf16 v[144:147], v[16:19], v[52:55], v[144:147]
ds_read_b64_tr_b16 v[76:77], v7 offset:36864
v_mfma_f32_16x16x32_bf16 v[148:151], v[20:23], v[52:55], v[148:151]
ds_read_b64_tr_b16 v[78:79], v7 offset:37120
v_mfma_f32_16x16x32_bf16 v[152:155], v[24:27], v[52:55], v[152:155]
ds_read_b64_tr_b16 v[80:81], v8 offset:36864
v_mfma_f32_16x16x32_bf16 v[156:159], v[28:31], v[52:55], v[156:159]
ds_read_b64_tr_b16 v[82:83], v8 offset:37120
v_mfma_f32_16x16x32_bf16 v[160:163], v[16:19], v[56:59], v[160:163]
ds_read_b64_tr_b16 v[84:85], v7 offset:38912
buffer_load_dwordx4 v2, s[16:19], s24 offen offset:1024 sc1 lds
s_add_u32 s24, s24, 8192
v_mfma_f32_16x16x32_bf16 v[164:167], v[20:23], v[56:59], v[164:167]
ds_read_b64_tr_b16 v[86:87], v7 offset:39168
v_mfma_f32_16x16x32_bf16 v[168:171], v[24:27], v[56:59], v[168:171]
ds_read_b64_tr_b16 v[88:89], v8 offset:38912
v_mfma_f32_16x16x32_bf16 v[172:175], v[28:31], v[56:59], v[172:175]
ds_read_b64_tr_b16 v[90:91], v8 offset:39168
v_mfma_f32_16x16x32_bf16 v[176:179], v[16:19], v[60:63], v[176:179]
ds_read_b64_tr_b16 v[92:93], v7 offset:45056
s_add_u32 m0, s28, 8192
v_mfma_f32_16x16x32_bf16 v[180:183], v[20:23], v[60:63], v[180:183]
ds_read_b64_tr_b16 v[94:95], v7 offset:45312
buffer_load_dwordx4 v3, s[8:11], s25 offen offset:0 lds
v_mfma_f32_16x16x32_bf16 v[184:187], v[24:27], v[60:63], v[184:187]
ds_read_b64_tr_b16 v[96:97], v8 offset:45056
v_mfma_f32_16x16x32_bf16 v[188:191], v[28:31], v[60:63], v[188:191]
ds_read_b64_tr_b16 v[98:99], v8 offset:45312
v_mfma_f32_16x16x32_bf16 v[192:195], v[16:19], v[64:67], v[192:195]
ds_read_b64_tr_b16 v[100:101], v7 offset:40960
v_mfma_f32_16x16x32_bf16 v[196:199], v[20:23], v[64:67], v[196:199]
ds_read_b64_tr_b16 v[102:103], v7 offset:41216
s_add_u32 m0, s28, 9152
v_mfma_f32_16x16x32_bf16 v[200:203], v[24:27], v[64:67], v[200:203]
buffer_load_dwordx4 v3, s[8:11], s25 offen offset:64 lds
s_add_u32 s25, s25, 196608
v_mfma_f32_16x16x32_bf16 v[204:207], v[28:31], v[64:67], v[204:207]
v_mfma_f32_16x16x32_bf16 v[208:211], v[16:19], v[68:71], v[208:211]
v_mfma_f32_16x16x32_bf16 v[212:215], v[20:23], v[68:71], v[212:215]
v_mfma_f32_16x16x32_bf16 v[216:219], v[24:27], v[68:71], v[216:219]
v_mfma_f32_16x16x32_bf16 v[220:223], v[28:31], v[68:71], v[220:223]
v_mfma_f32_16x16x32_bf16 v[224:227], v[72:75], v[16:19], v[224:227]
v_mfma_f32_16x16x32_bf16 v[228:231], v[72:75], v[20:23], v[228:231]
v_mfma_f32_16x16x32_bf16 v[232:235], v[72:75], v[24:27], v[232:235]
v_mfma_f32_16x16x32_bf16 v[236:239], v[72:75], v[28:31], v[236:239]
s_waitcnt vmcnt(8) lgkmcnt(0)
s_barrier
v_mfma_f32_16x16x32_bf16 v[128:131], v[32:35], v[76:79], v[128:131]
ds_read_b128 v[16:19], v6 offset:0
v_mfma_f32_16x16x32_bf16 v[132:135], v[36:39], v[76:79], v[132:135]
ds_read_b128 v[20:23], v6 offset:1024
v_mfma_f32_16x16x32_bf16 v[136:139], v[40:43], v[76:79], v[136:139]
ds_read_b128 v[24:27], v6 offset:2048
s_add_u32 m0, s27, 34816
v_mfma_f32_16x16x32_bf16 v[140:143], v[44:47], v[76:79], v[140:143]
ds_read_b128 v[28:31], v6 offset:3072
buffer_load_dwordx4 v2, s[16:19], s24 offen sc1 lds
v_mfma_f32_16x16x32_bf16 v[144:147], v[32:35], v[80:83], v[144:147]
ds_read_b64_tr_b16 v[48:49], v9 offset:2048
v_mfma_f32_16x16x32_bf16 v[148:151], v[36:39], v[80:83], v[148:151]
ds_read_b64_tr_b16 v[50:51], v9 offset:2304
v_mfma_f32_16x16x32_bf16 v[152:155], v[40:43], v[80:83], v[152:155]
ds_read_b64_tr_b16 v[52:53], v10 offset:2048
v_mfma_f32_16x16x32_bf16 v[156:159], v[44:47], v[80:83], v[156:159]
ds_read_b64_tr_b16 v[54:55], v10 offset:2304
v_mfma_f32_16x16x32_bf16 v[160:163], v[32:35], v[84:87], v[160:163]
ds_read_b64_tr_b16 v[56:57], v9 offset:4096
buffer_load_dwordx4 v2, s[16:19], s24 offen offset:1024 sc1 lds
s_add_u32 s24, s24, 8192
v_mfma_f32_16x16x32_bf16 v[164:167], v[36:39], v[84:87], v[164:167]
ds_read_b64_tr_b16 v[58:59], v9 offset:4352
v_mfma_f32_16x16x32_bf16 v[168:171], v[40:43], v[84:87], v[168:171]
ds_read_b64_tr_b16 v[60:61], v10 offset:4096
v_mfma_f32_16x16x32_bf16 v[172:175], v[44:47], v[84:87], v[172:175]
ds_read_b64_tr_b16 v[62:63], v10 offset:4352
v_mfma_f32_16x16x32_bf16 v[176:179], v[32:35], v[88:91], v[176:179]
ds_read_b64_tr_b16 v[64:65], v9 offset:10240
s_add_u32 m0, s28, 43008
v_mfma_f32_16x16x32_bf16 v[180:183], v[36:39], v[88:91], v[180:183]
ds_read_b64_tr_b16 v[66:67], v9 offset:10496
buffer_load_dwordx4 v3, s[8:11], s25 offen offset:0 lds
v_mfma_f32_16x16x32_bf16 v[184:187], v[40:43], v[88:91], v[184:187]
ds_read_b64_tr_b16 v[68:69], v10 offset:10240
v_mfma_f32_16x16x32_bf16 v[188:191], v[44:47], v[88:91], v[188:191]
ds_read_b64_tr_b16 v[70:71], v10 offset:10496
v_mfma_f32_16x16x32_bf16 v[192:195], v[32:35], v[92:95], v[192:195]
ds_read_b64_tr_b16 v[72:73], v9 offset:6144
v_mfma_f32_16x16x32_bf16 v[196:199], v[36:39], v[92:95], v[196:199]
ds_read_b64_tr_b16 v[74:75], v9 offset:6400
s_add_u32 m0, s28, 43968
v_mfma_f32_16x16x32_bf16 v[200:203], v[40:43], v[92:95], v[200:203]
buffer_load_dwordx4 v3, s[8:11], s25 offen offset:64 lds
s_add_u32 s25, s25, 196608
v_mfma_f32_16x16x32_bf16 v[204:207], v[44:47], v[92:95], v[204:207]
v_mfma_f32_16x16x32_bf16 v[208:211], v[32:35], v[96:99], v[208:211]
v_mfma_f32_16x16x32_bf16 v[212:215], v[36:39], v[96:99], v[212:215]
v_mfma_f32_16x16x32_bf16 v[216:219], v[40:43], v[96:99], v[216:219]
v_mfma_f32_16x16x32_bf16 v[220:223], v[44:47], v[96:99], v[220:223]
v_mfma_f32_16x16x32_bf16 v[224:227], v[100:103], v[32:35], v[224:227]
v_mfma_f32_16x16x32_bf16 v[228:231], v[100:103], v[36:39], v[228:231]
v_mfma_f32_16x16x32_bf16 v[232:235], v[100:103], v[40:43], v[232:235]
v_mfma_f32_16x16x32_bf16 v[236:239], v[100:103], v[44:47], v[236:239]
s_waitcnt vmcnt(8) lgkmcnt(0)
s_barrier
v_mfma_f32_16x16x32_bf16 v[128:131], v[16:19], v[48:51], v[128:131]
ds_read_b128 v[32:35], v6 offset:34816
v_mfma_f32_16x16x32_bf16 v[132:135], v[20:23], v[48:51], v[132:135]
ds_read_b128 v[36:39], v6 offset:35840
v_mfma_f32_16x16x32_bf16 v[136:139], v[24:27], v[48:51], v[136:139]
ds_read_b128 v[40:43], v6 offset:36864
s_add_u32 m0, s27, 69632
v_mfma_f32_16x16x32_bf16 v[140:143], v[28:31], v[48:51], v[140:143]
ds_read_b128 v[44:47], v6 offset:37888
buffer_load_dwordx4 v2, s[16:19], s24 offen sc1 lds
v_mfma_f32_16x16x32_bf16 v[144:147], v[16:19], v[52:55], v[144:147]
ds_read_b64_tr_b16 v[76:77], v9 offset:36864
v_mfma_f32_16x16x32_bf16 v[148:151], v[20:23], v[52:55], v[148:151]
ds_read_b64_tr_b16 v[78:79], v9 offset:37120
v_mfma_f32_16x16x32_bf16 v[152:155], v[24:27], v[52:55], v[152:155]
ds_read_b64_tr_b16 v[80:81], v10 offset:36864
v_mfma_f32_16x16x32_bf16 v[156:159], v[28:31], v[52:55], v[156:159]
ds_read_b64_tr_b16 v[82:83], v10 offset:37120
v_mfma_f32_16x16x32_bf16 v[160:163], v[16:19], v[56:59], v[160:163]
ds_read_b64_tr_b16 v[84:85], v9 offset:38912
buffer_load_dwordx4 v2, s[16:19], s24 offen offset:1024 sc1 lds
s_add_u32 s24, s24, 8192
v_mfma_f32_16x16x32_bf16 v[164:167], v[20:23], v[56:59], v[164:167]
ds_read_b64_tr_b16 v[86:87], v9 offset:39168
v_mfma_f32_16x16x32_bf16 v[168:171], v[24:27], v[56:59], v[168:171]
ds_read_b64_tr_b16 v[88:89], v10 offset:38912
v_mfma_f32_16x16x32_bf16 v[172:175], v[28:31], v[56:59], v[172:175]
ds_read_b64_tr_b16 v[90:91], v10 offset:39168
v_mfma_f32_16x16x32_bf16 v[176:179], v[16:19], v[60:63], v[176:179]
ds_read_b64_tr_b16 v[92:93], v9 offset:45056
s_add_u32 m0, s28, 77824
v_mfma_f32_16x16x32_bf16 v[180:183], v[20:23], v[60:63], v[180:183]
ds_read_b64_tr_b16 v[94:95], v9 offset:45312
buffer_load_dwordx4 v3, s[8:11], s25 offen offset:0 lds
v_mfma_f32_16x16x32_bf16 v[184:187], v[24:27], v[60:63], v[184:187]
ds_read_b64_tr_b16 v[96:97], v10 offset:45056
v_mfma_f32_16x16x32_bf16 v[188:191], v[28:31], v[60:63], v[188:191]
ds_read_b64_tr_b16 v[98:99], v10 offset:45312
v_mfma_f32_16x16x32_bf16 v[192:195], v[16:19], v[64:67], v[192:195]
ds_read_b64_tr_b16 v[100:101], v9 offset:40960
v_mfma_f32_16x16x32_bf16 v[196:199], v[20:23], v[64:67], v[196:199]
ds_read_b64_tr_b16 v[102:103], v9 offset:41216
s_add_u32 m0, s28, 78784
v_mfma_f32_16x16x32_bf16 v[200:203], v[24:27], v[64:67], v[200:203]
buffer_load_dwordx4 v3, s[8:11], s25 offen offset:64 lds
s_add_u32 s25, s25, 196608
v_mfma_f32_16x16x32_bf16 v[204:207], v[28:31], v[64:67], v[204:207]
v_mfma_f32_16x16x32_bf16 v[208:211], v[16:19], v[68:71], v[208:211]
v_mfma_f32_16x16x32_bf16 v[212:215], v[20:23], v[68:71], v[212:215]
v_mfma_f32_16x16x32_bf16 v[216:219], v[24:27], v[68:71], v[216:219]
v_mfma_f32_16x16x32_bf16 v[220:223], v[28:31], v[68:71], v[220:223]
v_mfma_f32_16x16x32_bf16 v[224:227], v[72:75], v[16:19], v[224:227]
v_mfma_f32_16x16x32_bf16 v[228:231], v[72:75], v[20:23], v[228:231]
v_mfma_f32_16x16x32_bf16 v[232:235], v[72:75], v[24:27], v[232:235]
v_mfma_f32_16x16x32_bf16 v[236:239], v[72:75], v[28:31], v[236:239]
s_waitcnt vmcnt(8) lgkmcnt(0)
s_barrier
v_mfma_f32_16x16x32_bf16 v[128:131], v[32:35], v[76:79], v[128:131]
ds_read_b128 v[16:19], v5 offset:0
v_mfma_f32_16x16x32_bf16 v[132:135], v[36:39], v[76:79], v[132:135]
ds_read_b128 v[20:23], v5 offset:1024
v_mfma_f32_16x16x32_bf16 v[136:139], v[40:43], v[76:79], v[136:139]
ds_read_b128 v[24:27], v5 offset:2048
s_add_u32 m0, s27, 104448
v_mfma_f32_16x16x32_bf16 v[140:143], v[44:47], v[76:79], v[140:143]
ds_read_b128 v[28:31], v5 offset:3072
buffer_load_dwordx4 v2, s[16:19], s24 offen sc1 lds
v_mfma_f32_16x16x32_bf16 v[144:147], v[32:35], v[80:83], v[144:147]
ds_read_b64_tr_b16 v[48:49], v7 offset:2048
v_mfma_f32_16x16x32_bf16 v[148:151], v[36:39], v[80:83], v[148:151]
ds_read_b64_tr_b16 v[50:51], v7 offset:2304
v_mfma_f32_16x16x32_bf16 v[152:155], v[40:43], v[80:83], v[152:155]
ds_read_b64_tr_b16 v[52:53], v8 offset:2048
v_mfma_f32_16x16x32_bf16 v[156:159], v[44:47], v[80:83], v[156:159]
ds_read_b64_tr_b16 v[54:55], v8 offset:2304
v_mfma_f32_16x16x32_bf16 v[160:163], v[32:35], v[84:87], v[160:163]
ds_read_b64_tr_b16 v[56:57], v7 offset:4096
buffer_load_dwordx4 v2, s[16:19], s24 offen offset:1024 sc1 lds
s_add_u32 s24, s24, 8192
v_mfma_f32_16x16x32_bf16 v[164:167], v[36:39], v[84:87], v[164:167]
ds_read_b64_tr_b16 v[58:59], v7 offset:4352
v_mfma_f32_16x16x32_bf16 v[168:171], v[40:43], v[84:87], v[168:171]
ds_read_b64_tr_b16 v[60:61], v8 offset:4096
v_mfma_f32_16x16x32_bf16 v[172:175], v[44:47], v[84:87], v[172:175]
ds_read_b64_tr_b16 v[62:63], v8 offset:4352
v_mfma_f32_16x16x32_bf16 v[176:179], v[32:35], v[88:91], v[176:179]
ds_read_b64_tr_b16 v[64:65], v7 offset:10240
s_add_u32 m0, s28, 112640
v_mfma_f32_16x16x32_bf16 v[180:183], v[36:39], v[88:91], v[180:183]
ds_read_b64_tr_b16 v[66:67], v7 offset:10496
buffer_load_dwordx4 v3, s[8:11], s25 offen offset:0 lds
v_mfma_f32_16x16x32_bf16 v[184:187], v[40:43], v[88:91], v[184:187]
ds_read_b64_tr_b16 v[68:69], v8 offset:10240
v_mfma_f32_16x16x32_bf16 v[188:191], v[44:47], v[88:91], v[188:191]
ds_read_b64_tr_b16 v[70:71], v8 offset:10496
v_mfma_f32_16x16x32_bf16 v[192:195], v[32:35], v[92:95], v[192:195]
ds_read_b64_tr_b16 v[72:73], v7 offset:6144
v_mfma_f32_16x16x32_bf16 v[196:199], v[36:39], v[92:95], v[196:199]
ds_read_b64_tr_b16 v[74:75], v7 offset:6400
s_add_u32 m0, s28, 113600
v_mfma_f32_16x16x32_bf16 v[200:203], v[40:43], v[92:95], v[200:203]
buffer_load_dwordx4 v3, s[8:11], s25 offen offset:64 lds
s_add_u32 s25, s25, 196608
v_mfma_f32_16x16x32_bf16 v[204:207], v[44:47], v[92:95], v[204:207]
v_mfma_f32_16x16x32_bf16 v[208:211], v[32:35], v[96:99], v[208:211]
v_mfma_f32_16x16x32_bf16 v[212:215], v[36:39], v[96:99], v[212:215]
v_mfma_f32_16x16x32_bf16 v[216:219], v[40:43], v[96:99], v[216:219]
v_mfma_f32_16x16x32_bf16 v[220:223], v[44:47], v[96:99], v[220:223]
v_mfma_f32_16x16x32_bf16 v[224:227], v[100:103], v[32:35], v[224:227]
v_mfma_f32_16x16x32_bf16 v[228:231], v[100:103], v[36:39], v[228:231]
v_mfma_f32_16x16x32_bf16 v[232:235], v[100:103], v[40:43], v[232:235]
v_mfma_f32_16x16x32_bf16 v[236:239], v[100:103], v[44:47], v[236:239]
s_nop 0
s_sub_u32 s29, s29, 1
s_cmp_lg_u32 s29, 0
s_cbranch_scc1 L_loop1_0
s_waitcnt vmcnt(8) lgkmcnt(0)
s_barrier
v_mfma_f32_16x16x32_bf16 v[128:131], v[16:19], v[48:51], v[128:131]
ds_read_b128 v[32:35], v5 offset:34816
v_mfma_f32_16x16x32_bf16 v[132:135], v[20:23], v[48:51], v[132:135]
ds_read_b128 v[36:39], v5 offset:35840
v_mfma_f32_16x16x32_bf16 v[136:139], v[24:27], v[48:51], v[136:139]
ds_read_b128 v[40:43], v5 offset:36864
v_mfma_f32_16x16x32_bf16 v[140:143], v[28:31], v[48:51], v[140:143]
ds_read_b128 v[44:47], v5 offset:37888
v_mfma_f32_16x16x32_bf16 v[144:147], v[16:19], v[52:55], v[144:147]
ds_read_b64_tr_b16 v[76:77], v7 offset:36864
v_mfma_f32_16x16x32_bf16 v[148:151], v[20:23], v[52:55], v[148:151]
ds_read_b64_tr_b16 v[78:79], v7 offset:37120
v_mfma_f32_16x16x32_bf16 v[152:155], v[24:27], v[52:55], v[152:155]
ds_read_b64_tr_b16 v[80:81], v8 offset:36864
v_mfma_f32_16x16x32_bf16 v[156:159], v[28:31], v[52:55], v[156:159]
ds_read_b64_tr_b16 v[82:83], v8 offset:37120
v_mfma_f32_16x16x32_bf16 v[160:163], v[16:19], v[56:59], v[160:163]
ds_read_b64_tr_b16 v[84:85], v7 offset:38912
v_mfma_f32_16x16x32_bf16 v[164:167], v[20:23], v[56:59], v[164:167]
ds_read_b64_tr_b16 v[86:87], v7 offset:39168
v_mfma_f32_16x16x32_bf16 v[168:171], v[24:27], v[56:59], v[168:171]
ds_read_b64_tr_b16 v[88:89], v8 offset:38912
v_mfma_f32_16x16x32_bf16 v[172:175], v[28:31], v[56:59], v[172:175]
ds_read_b64_tr_b16 v[90:91], v8 offset:39168
v_mfma_f32_16x16x32_bf16 v[176:179], v[16:19], v[60:63], v[176:179]
ds_read_b64_tr_b16 v[92:93], v7 offset:45056
v_mfma_f32_16x16x32_bf16 v[180:183], v[20:23], v[60:63], v[180:183]
ds_read_b64_tr_b16 v[94:95], v7 offset:45312
v_mfma_f32_16x16x32_bf16 v[184:187], v[24:27], v[60:63], v[184:187]
ds_read_b64_tr_b16 v[96:97], v8 offset:45056
v_mfma_f32_16x16x32_bf16 v[188:191], v[28:31], v[60:63], v[188:191]
ds_read_b64_tr_b16 v[98:99], v8 offset:45312
v_mfma_f32_16x16x32_bf16 v[192:195], v[16:19], v[64:67], v[192:195]
ds_read_b64_tr_b16 v[100:101], v7 offset:40960
v_mfma_f32_16x16x32_bf16 v[196:199], v[20:23], v[64:67], v[196:199]
ds_read_b64_tr_b16 v[102:103], v7 offset:41216
v_mfma_f32_16x16x32_bf16 v[200:203], v[24:27], v[64:67], v[200:203]
v_mfma_f32_16x16x32_bf16 v[204:207], v[28:31], v[64:67], v[204:207]
v_mfma_f32_16x16x32_bf16 v[208:211], v[16:19], v[68:71], v[208:211]
v_mfma_f32_16x16x32_bf16 v[212:215], v[20:23], v[68:71], v[212:215]
v_mfma_f32_16x16x32_bf16 v[216:219], v[24:27], v[68:71], v[216:219]
v_mfma_f32_16x16x32_bf16 v[220:223], v[28:31], v[68:71], v[220:223]
v_mfma_f32_16x16x32_bf16 v[224:227], v[72:75], v[16:19], v[224:227]
v_mfma_f32_16x16x32_bf16 v[228:231], v[72:75], v[20:23], v[228:231]
v_mfma_f32_16x16x32_bf16 v[232:235], v[72:75], v[24:27], v[232:235]
v_mfma_f32_16x16x32_bf16 v[236:239], v[72:75], v[28:31], v[236:239]
s_waitcnt vmcnt(4) lgkmcnt(0)
s_barrier
v_mfma_f32_16x16x32_bf16 v[128:131], v[32:35], v[76:79], v[128:131]
ds_read_b128 v[16:19], v6 offset:0
v_mfma_f32_16x16x32_bf16 v[132:135], v[36:39], v[76:79], v[132:135]
ds_read_b128 v[20:23], v6 offset:1024
v_mfma_f32_16x16x32_bf16 v[136:139], v[40:43], v[76:79], v[136:139]
ds_read_b128 v[24:27], v6 offset:2048
v_mfma_f32_16x16x32_bf16 v[140:143], v[44:47], v[76:79], v[140:143]
ds_read_b128 v[28:31], v6 offset:3072
v_mfma_f32_16x16x32_bf16 v[144:147], v[32:35], v[80:83], v[144:147]
ds_read_b64_tr_b16 v[48:49], v9 offset:2048
v_mfma_f32_16x16x32_bf16 v[148:151], v[36:39], v[80:83], v[148:151]
ds_read_b64_tr_b16 v[50:51], v9 offset:2304
v_mfma_f32_16x16x32_bf16 v[152:155], v[40:43], v[80:83], v[152:155]
ds_read_b64_tr_b16 v[52:53], v10 offset:2048
v_mfma_f32_16x16x32_bf16 v[156:159], v[44:47], v[80:83], v[156:159]
ds_read_b64_tr_b16 v[54:55], v10 offset:2304
v_mfma_f32_16x16x32_bf16 v[160:163], v[32:35], v[84:87], v[160:163]
ds_read_b64_tr_b16 v[56:57], v9 offset:4096
v_mfma_f32_16x16x32_bf16 v[164:167], v[36:39], v[84:87], v[164:167]
ds_read_b64_tr_b16 v[58:59], v9 offset:4352
v_mfma_f32_16x16x32_bf16 v[168:171], v[40:43], v[84:87], v[168:171]
ds_read_b64_tr_b16 v[60:61], v10 offset:4096
v_mfma_f32_16x16x32_bf16 v[172:175], v[44:47], v[84:87], v[172:175]
ds_read_b64_tr_b16 v[62:63], v10 offset:4352
v_mfma_f32_16x16x32_bf16 v[176:179], v[32:35], v[88:91], v[176:179]
ds_read_b64_tr_b16 v[64:65], v9 offset:10240
v_mfma_f32_16x16x32_bf16 v[180:183], v[36:39], v[88:91], v[180:183]
ds_read_b64_tr_b16 v[66:67], v9 offset:10496
v_mfma_f32_16x16x32_bf16 v[184:187], v[40:43], v[88:91], v[184:187]
ds_read_b64_tr_b16 v[68:69], v10 offset:10240
v_mfma_f32_16x16x32_bf16 v[188:191], v[44:47], v[88:91], v[188:191]
ds_read_b64_tr_b16 v[70:71], v10 offset:10496
v_mfma_f32_16x16x32_bf16 v[192:195], v[32:35], v[92:95], v[192:195]
ds_read_b64_tr_b16 v[72:73], v9 offset:6144
v_mfma_f32_16x16x32_bf16 v[196:199], v[36:39], v[92:95], v[196:199]
ds_read_b64_tr_b16 v[74:75], v9 offset:6400
v_mfma_f32_16x16x32_bf16 v[200:203], v[40:43], v[92:95], v[200:203]
v_mfma_f32_16x16x32_bf16 v[204:207], v[44:47], v[92:95], v[204:207]
v_mfma_f32_16x16x32_bf16 v[208:211], v[32:35], v[96:99], v[208:211]
v_mfma_f32_16x16x32_bf16 v[212:215], v[36:39], v[96:99], v[212:215]
v_mfma_f32_16x16x32_bf16 v[216:219], v[40:43], v[96:99], v[216:219]
v_mfma_f32_16x16x32_bf16 v[220:223], v[44:47], v[96:99], v[220:223]
v_mfma_f32_16x16x32_bf16 v[224:227], v[100:103], v[32:35], v[224:227]
v_mfma_f32_16x16x32_bf16 v[228:231], v[100:103], v[36:39], v[228:231]
v_mfma_f32_16x16x32_bf16 v[232:235], v[100:103], v[40:43], v[232:235]
v_mfma_f32_16x16x32_bf16 v[236:239], v[100:103], v[44:47], v[236:239]
s_waitcnt vmcnt(0) lgkmcnt(0)
s_barrier
v_mfma_f32_16x16x32_bf16 v[128:131], v[16:19], v[48:51], v[128:131]
ds_read_b128 v[32:35], v6 offset:34816
v_mfma_f32_16x16x32_bf16 v[132:135], v[20:23], v[48:51], v[132:135]
ds_read_b128 v[36:39], v6 offset:35840
v_mfma_f32_16x16x32_bf16 v[136:139], v[24:27], v[48:51], v[136:139]
ds_read_b128 v[40:43], v6 offset:36864
v_mfma_f32_16x16x32_bf16 v[140:143], v[28:31], v[48:51], v[140:143]
ds_read_b128 v[44:47], v6 offset:37888
v_mfma_f32_16x16x32_bf16 v[144:147], v[16:19], v[52:55], v[144:147]
ds_read_b64_tr_b16 v[76:77], v9 offset:36864
v_mfma_f32_16x16x32_bf16 v[148:151], v[20:23], v[52:55], v[148:151]
ds_read_b64_tr_b16 v[78:79], v9 offset:37120
v_mfma_f32_16x16x32_bf16 v[152:155], v[24:27], v[52:55], v[152:155]
ds_read_b64_tr_b16 v[80:81], v10 offset:36864
v_mfma_f32_16x16x32_bf16 v[156:159], v[28:31], v[52:55], v[156:159]
ds_read_b64_tr_b16 v[82:83], v10 offset:37120
v_mfma_f32_16x16x32_bf16 v[160:163], v[16:19], v[56:59], v[160:163]
ds_read_b64_tr_b16 v[84:85], v9 offset:38912
v_mfma_f32_16x16x32_bf16 v[164:167], v[20:23], v[56:59], v[164:167]
ds_read_b64_tr_b16 v[86:87], v9 offset:39168
v_mfma_f32_16x16x32_bf16 v[168:171], v[24:27], v[56:59], v[168:171]
ds_read_b64_tr_b16 v[88:89], v10 offset:38912
v_mfma_f32_16x16x32_bf16 v[172:175], v[28:31], v[56:59], v[172:175]
ds_read_b64_tr_b16 v[90:91], v10 offset:39168
v_mfma_f32_16x16x32_bf16 v[176:179], v[16:19], v[60:63], v[176:179]
ds_read_b64_tr_b16 v[92:93], v9 offset:45056
v_mfma_f32_16x16x32_bf16 v[180:183], v[20:23], v[60:63], v[180:183]
ds_read_b64_tr_b16 v[94:95], v9 offset:45312
v_mfma_f32_16x16x32_bf16 v[184:187], v[24:27], v[60:63], v[184:187]
ds_read_b64_tr_b16 v[96:97], v10 offset:45056
v_mfma_f32_16x16x32_bf16 v[188:191], v[28:31], v[60:63], v[188:191]
ds_read_b64_tr_b16 v[98:99], v10 offset:45312
v_mfma_f32_16x16x32_bf16 v[192:195], v[16:19], v[64:67], v[192:195]
ds_read_b64_tr_b16 v[100:101], v9 offset:40960
v_mfma_f32_16x16x32_bf16 v[196:199], v[20:23], v[64:67], v[196:199]
ds_read_b64_tr_b16 v[102:103], v9 offset:41216
v_mfma_f32_16x16x32_bf16 v[200:203], v[24:27], v[64:67], v[200:203]
v_mfma_f32_16x16x32_bf16 v[204:207], v[28:31], v[64:67], v[204:207]
v_mfma_f32_16x16x32_bf16 v[208:211], v[16:19], v[68:71], v[208:211]
v_mfma_f32_16x16x32_bf16 v[212:215], v[20:23], v[68:71], v[212:215]
v_mfma_f32_16x16x32_bf16 v[216:219], v[24:27], v[68:71], v[216:219]
v_mfma_f32_16x16x32_bf16 v[220:223], v[28:31], v[68:71], v[220:223]
v_mfma_f32_16x16x32_bf16 v[224:227], v[72:75], v[16:19], v[224:227]
v_mfma_f32_16x16x32_bf16 v[228:231], v[72:75], v[20:23], v[228:231]
v_mfma_f32_16x16x32_bf16 v[232:235], v[72:75], v[24:27], v[232:235]
v_mfma_f32_16x16x32_bf16 v[236:239], v[72:75], v[28:31], v[236:239]
s_lshl_b32 s24, s21, 19
s_lshl_b32 s36, s20, 17
s_add_u32 s24, s24, s36
s_lshl_b32 s27, s20, 12
s_waitcnt lgkmcnt(0)
s_barrier
v_mfma_f32_16x16x32_bf16 v[128:131], v[32:35], v[76:79], v[128:131]
s_nop 0
s_add_u32 m0, s27, 0
v_mfma_f32_16x16x32_bf16 v[132:135], v[36:39], v[76:79], v[132:135]
buffer_load_dwordx4 v112, s[56:59], s24 offen offset:0 lds
v_mfma_f32_16x16x32_bf16 v[136:139], v[40:43], v[76:79], v[136:139]
v_mfma_f32_16x16x32_bf16 v[140:143], v[44:47], v[76:79], v[140:143]
buffer_load_dwordx4 v113, s[56:59], s24 offen offset:1024 lds
v_mfma_f32_16x16x32_bf16 v[144:147], v[32:35], v[80:83], v[144:147]
v_mfma_f32_16x16x32_bf16 v[148:151], v[36:39], v[80:83], v[148:151]
buffer_load_dwordx4 v114, s[56:59], s24 offen offset:2048 lds
v_mfma_f32_16x16x32_bf16 v[152:155], v[40:43], v[80:83], v[152:155]
v_mfma_f32_16x16x32_bf16 v[156:159], v[44:47], v[80:83], v[156:159]
buffer_load_dwordx4 v115, s[56:59], s24 offen offset:3072 lds
s_add_u32 s24, s24, 128
v_mfma_f32_16x16x32_bf16 v[160:163], v[32:35], v[84:87], v[160:163]
s_add_u32 m0, s27, 30720
v_mfma_f32_16x16x32_bf16 v[164:167], v[36:39], v[84:87], v[164:167]
buffer_load_dwordx4 v112, s[56:59], s24 offen offset:0 lds
v_mfma_f32_16x16x32_bf16 v[168:171], v[40:43], v[84:87], v[168:171]
v_mfma_f32_16x16x32_bf16 v[172:175], v[44:47], v[84:87], v[172:175]
buffer_load_dwordx4 v113, s[56:59], s24 offen offset:1024 lds
v_mfma_f32_16x16x32_bf16 v[176:179], v[32:35], v[88:91], v[176:179]
v_mfma_f32_16x16x32_bf16 v[180:183], v[36:39], v[88:91], v[180:183]
buffer_load_dwordx4 v114, s[56:59], s24 offen offset:2048 lds
v_mfma_f32_16x16x32_bf16 v[184:187], v[40:43], v[88:91], v[184:187]
v_mfma_f32_16x16x32_bf16 v[188:191], v[44:47], v[88:91], v[188:191]
buffer_load_dwordx4 v115, s[56:59], s24 offen offset:3072 lds
s_add_u32 s24, s24, 128
v_mfma_f32_16x16x32_bf16 v[192:195], v[32:35], v[92:95], v[192:195]
s_add_u32 m0, s27, 61440
v_mfma_f32_16x16x32_bf16 v[196:199], v[36:39], v[92:95], v[196:199]
buffer_load_dwordx4 v112, s[56:59], s24 offen offset:0 lds
v_mfma_f32_16x16x32_bf16 v[200:203], v[40:43], v[92:95], v[200:203]
v_mfma_f32_16x16x32_bf16 v[204:207], v[44:47], v[92:95], v[204:207]
buffer_load_dwordx4 v113, s[56:59], s24 offen offset:1024 lds
v_mfma_f32_16x16x32_bf16 v[208:211], v[32:35], v[96:99], v[208:211]
v_mfma_f32_16x16x32_bf16 v[212:215], v[36:39], v[96:99], v[212:215]
buffer_load_dwordx4 v114, s[56:59], s24 offen offset:2048 lds
v_mfma_f32_16x16x32_bf16 v[216:219], v[40:43], v[96:99], v[216:219]
v_mfma_f32_16x16x32_bf16 v[220:223], v[44:47], v[96:99], v[220:223]
buffer_load_dwordx4 v115, s[56:59], s24 offen offset:3072 lds
s_add_u32 s24, s24, 128
v_mfma_f32_16x16x32_bf16 v[224:227], v[100:103], v[32:35], v[224:227]
s_add_u32 m0, s27, 92160
v_mfma_f32_16x16x32_bf16 v[228:231], v[100:103], v[36:39], v[228:231]
buffer_load_dwordx4 v112, s[56:59], s24 offen offset:0 lds
v_mfma_f32_16x16x32_bf16 v[232:235], v[100:103], v[40:43], v[232:235]
v_mfma_f32_16x16x32_bf16 v[236:239], v[100:103], v[44:47], v[236:239]
buffer_load_dwordx4 v113, s[56:59], s24 offen offset:1024 lds
buffer_load_dwordx4 v114, s[56:59], s24 offen offset:2048 lds
buffer_load_dwordx4 v115, s[56:59], s24 offen offset:3072 lds
s_add_u32 s24, s24, 128
s_mov_b32 s42, 0xbdd2d3e8
s_mov_b32 s43, 0xbdd2d3e8
s_mov_b32 s44, 0x3f800000
s_mov_b32 s45, 0x3f800000
s_mov_b32 s46, 0x3fb8aa3b
s_mov_b32 s47, 0x3fb8aa3b
s_mov_b32 s48, 0x358637bd
s_mov_b32 s49, 0x358637bd
v_mov_b32 v12, 0xc0135761
v_mov_b32 v13, 0xc0135761
v_and_b32_e64 v1, 63, v0
v_bfe_u32 v2, v1, 3, 1
v_lshlrev_b32_e64 v2, 9, v2
v_bfe_u32 v3, v1, 2, 1
v_lshl_add_u32 v2, v3, 7, v2
v_lshrrev_b32 v3, 4, v1
v_lshlrev_b32_e64 v5, 5, v3
s_lshl_b32 s30, s23, 8
s_add_u32 s30, s30, 151552
v_add_u32 v5, s30, v5
v_add_u32_e64 v2, v2, v5
s_lshl_b32 s30, s23, 11
s_add_u32 s30, s30, 122880
v_add_u32_e64 v6, s30, v11
v_pk_mul_f32 v[104:105], v[192:193], v[192:193]
v_pk_mul_f32 v[106:107], v[194:195], v[194:195]
v_pk_mul_f32 v[108:109], v[196:197], v[196:197]
v_pk_mul_f32 v[110:111], v[198:199], v[198:199]
v_pk_fma_f32 v[104:105], v[104:105], s[42:43], v[12:13]
v_pk_fma_f32 v[106:107], v[106:107], s[42:43], v[12:13]
v_pk_fma_f32 v[108:109], v[108:109], s[42:43], v[12:13]
v_pk_fma_f32 v[110:111], v[110:111], s[42:43], v[12:13]
v_pk_mul_f32 v[104:105], v[104:105], v[192:193]
v_pk_mul_f32 v[106:107], v[106:107], v[194:195]
v_pk_mul_f32 v[108:109], v[108:109], v[196:197]
v_pk_mul_f32 v[110:111], v[110:111], v[198:199]
v_exp_f32 v104, v104
v_exp_f32 v105, v105
v_exp_f32 v106, v106
v_exp_f32 v107, v107
v_exp_f32 v108, v108
v_exp_f32 v109, v109
v_exp_f32 v110, v110
v_exp_f32 v111, v111
v_pk_add_f32 v[104:105], v[104:105], s[44:45]
v_pk_add_f32 v[106:107], v[106:107], s[44:45]
v_pk_add_f32 v[108:109], v[108:109], s[44:45]
v_pk_add_f32 v[110:111], v[110:111], s[44:45]
v_rcp_f32 v104, v104
v_rcp_f32 v105, v105
v_rcp_f32 v106, v106
v_rcp_f32 v107, v107
v_rcp_f32 v108, v108
v_rcp_f32 v109, v109
v_rcp_f32 v110, v110
v_rcp_f32 v111, v111
v_pk_mul_f32 v[192:193], v[192:193], v[104:105]
v_pk_mul_f32 v[194:195], v[194:195], v[106:107]
v_pk_mul_f32 v[196:197], v[196:197], v[108:109]
v_pk_mul_f32 v[198:199], v[198:199], v[110:111]
v_pk_mul_f32 v[32:33], v[192:193], v[192:193]
v_pk_mul_f32 v[34:35], v[194:195], v[194:195]
v_pk_mul_f32 v[36:37], v[196:197], v[196:197]
v_pk_mul_f32 v[38:39], v[198:199], v[198:199]
v_pk_mul_f32 v[104:105], v[200:201], v[200:201]
v_pk_mul_f32 v[106:107], v[202:203], v[202:203]
v_pk_mul_f32 v[108:109], v[204:205], v[204:205]
v_pk_mul_f32 v[110:111], v[206:207], v[206:207]
v_pk_fma_f32 v[104:105], v[104:105], s[42:43], v[12:13]
v_pk_fma_f32 v[106:107], v[106:107], s[42:43], v[12:13]
v_pk_fma_f32 v[108:109], v[108:109], s[42:43], v[12:13]
v_pk_fma_f32 v[110:111], v[110:111], s[42:43], v[12:13]
v_pk_mul_f32 v[104:105], v[104:105], v[200:201]
v_pk_mul_f32 v[106:107], v[106:107], v[202:203]
v_pk_mul_f32 v[108:109], v[108:109], v[204:205]
v_pk_mul_f32 v[110:111], v[110:111], v[206:207]
v_exp_f32 v104, v104
v_exp_f32 v105, v105
v_exp_f32 v106, v106
v_exp_f32 v107, v107
v_exp_f32 v108, v108
v_exp_f32 v109, v109
v_exp_f32 v110, v110
v_exp_f32 v111, v111
v_pk_add_f32 v[104:105], v[104:105], s[44:45]
v_pk_add_f32 v[106:107], v[106:107], s[44:45]
v_pk_add_f32 v[108:109], v[108:109], s[44:45]
v_pk_add_f32 v[110:111], v[110:111], s[44:45]
v_rcp_f32 v104, v104
v_rcp_f32 v105, v105
v_rcp_f32 v106, v106
v_rcp_f32 v107, v107
v_rcp_f32 v108, v108
v_rcp_f32 v109, v109
v_rcp_f32 v110, v110
v_rcp_f32 v111, v111
v_pk_mul_f32 v[200:201], v[200:201], v[104:105]
v_pk_mul_f32 v[202:203], v[202:203], v[106:107]
v_pk_mul_f32 v[204:205], v[204:205], v[108:109]
v_pk_mul_f32 v[206:207], v[206:207], v[110:111]
v_pk_mul_f32 v[40:41], v[200:201], v[200:201]
v_pk_mul_f32 v[42:43], v[202:203], v[202:203]
v_pk_mul_f32 v[44:45], v[204:205], v[204:205]
v_pk_mul_f32 v[46:47], v[206:207], v[206:207]
v_pk_mul_f32 v[104:105], v[208:209], v[208:209]
v_pk_mul_f32 v[106:107], v[210:211], v[210:211]
v_pk_mul_f32 v[108:109], v[212:213], v[212:213]
v_pk_mul_f32 v[110:111], v[214:215], v[214:215]
v_pk_fma_f32 v[104:105], v[104:105], s[42:43], v[12:13]
v_pk_fma_f32 v[106:107], v[106:107], s[42:43], v[12:13]
v_pk_fma_f32 v[108:109], v[108:109], s[42:43], v[12:13]
v_pk_fma_f32 v[110:111], v[110:111], s[42:43], v[12:13]
v_pk_mul_f32 v[104:105], v[104:105], v[208:209]
v_pk_mul_f32 v[106:107], v[106:107], v[210:211]
v_pk_mul_f32 v[108:109], v[108:109], v[212:213]
v_pk_mul_f32 v[110:111], v[110:111], v[214:215]
v_exp_f32 v104, v104
v_exp_f32 v105, v105
v_exp_f32 v106, v106
v_exp_f32 v107, v107
v_exp_f32 v108, v108
v_exp_f32 v109, v109
v_exp_f32 v110, v110
v_exp_f32 v111, v111
v_pk_add_f32 v[104:105], v[104:105], s[44:45]
v_pk_add_f32 v[106:107], v[106:107], s[44:45]
v_pk_add_f32 v[108:109], v[108:109], s[44:45]
v_pk_add_f32 v[110:111], v[110:111], s[44:45]
v_rcp_f32 v104, v104
v_rcp_f32 v105, v105
v_rcp_f32 v106, v106
v_rcp_f32 v107, v107
v_rcp_f32 v108, v108
v_rcp_f32 v109, v109
v_rcp_f32 v110, v110
v_rcp_f32 v111, v111
v_pk_mul_f32 v[208:209], v[208:209], v[104:105]
v_pk_mul_f32 v[210:211], v[210:211], v[106:107]
v_pk_mul_f32 v[212:213], v[212:213], v[108:109]
v_pk_mul_f32 v[214:215], v[214:215], v[110:111]
v_pk_add_f32 v[16:17], v[192:193], v[208:209]
v_pk_fma_f32 v[32:33], v[208:209], v[208:209], v[32:33]
v_pk_add_f32 v[18:19], v[194:195], v[210:211]
v_pk_fma_f32 v[34:35], v[210:211], v[210:211], v[34:35]
v_pk_add_f32 v[20:21], v[196:197], v[212:213]
v_pk_fma_f32 v[36:37], v[212:213], v[212:213], v[36:37]
v_pk_add_f32 v[22:23], v[198:199], v[214:215]
v_pk_fma_f32 v[38:39], v[214:215], v[214:215], v[38:39]
v_pk_mul_f32 v[104:105], v[216:217], v[216:217]
v_pk_mul_f32 v[106:107], v[218:219], v[218:219]
v_pk_mul_f32 v[108:109], v[220:221], v[220:221]
v_pk_mul_f32 v[110:111], v[222:223], v[222:223]
v_pk_fma_f32 v[104:105], v[104:105], s[42:43], v[12:13]
v_pk_fma_f32 v[106:107], v[106:107], s[42:43], v[12:13]
v_pk_fma_f32 v[108:109], v[108:109], s[42:43], v[12:13]
v_pk_fma_f32 v[110:111], v[110:111], s[42:43], v[12:13]
v_pk_mul_f32 v[104:105], v[104:105], v[216:217]
v_pk_mul_f32 v[106:107], v[106:107], v[218:219]
v_pk_mul_f32 v[108:109], v[108:109], v[220:221]
v_pk_mul_f32 v[110:111], v[110:111], v[222:223]
v_exp_f32 v104, v104
v_exp_f32 v105, v105
v_exp_f32 v106, v106
v_exp_f32 v107, v107
v_exp_f32 v108, v108
v_exp_f32 v109, v109
v_exp_f32 v110, v110
v_exp_f32 v111, v111
v_pk_add_f32 v[104:105], v[104:105], s[44:45]
v_pk_add_f32 v[106:107], v[106:107], s[44:45]
v_pk_add_f32 v[108:109], v[108:109], s[44:45]
v_pk_add_f32 v[110:111], v[110:111], s[44:45]
v_rcp_f32 v104, v104
v_rcp_f32 v105, v105
v_rcp_f32 v106, v106
v_rcp_f32 v107, v107
v_rcp_f32 v108, v108
v_rcp_f32 v109, v109
v_rcp_f32 v110, v110
v_rcp_f32 v111, v111
v_pk_mul_f32 v[216:217], v[216:217], v[104:105]
v_pk_mul_f32 v[218:219], v[218:219], v[106:107]
v_pk_mul_f32 v[220:221], v[220:221], v[108:109]
v_pk_mul_f32 v[222:223], v[222:223], v[110:111]
v_pk_add_f32 v[24:25], v[200:201], v[216:217]
v_pk_fma_f32 v[40:41], v[216:217], v[216:217], v[40:41]
v_pk_add_f32 v[26:27], v[202:203], v[218:219]
v_pk_fma_f32 v[42:43], v[218:219], v[218:219], v[42:43]
v_pk_add_f32 v[28:29], v[204:205], v[220:221]
v_pk_fma_f32 v[44:45], v[220:221], v[220:221], v[44:45]
v_pk_add_f32 v[30:31], v[206:207], v[222:223]
v_pk_fma_f32 v[46:47], v[222:223], v[222:223], v[46:47]
s_nop 0
s_nop 1
v_add_f32_dpp v16, v16, v16 row_ror:8 row_mask:0xf bank_mask:0x3
v_add_f32_dpp v17, v17, v17 row_ror:8 row_mask:0xf bank_mask:0x3
v_add_f32_dpp v18, v18, v18 row_ror:8 row_mask:0xf bank_mask:0x3
v_add_f32_dpp v19, v19, v19 row_ror:8 row_mask:0xf bank_mask:0x3
v_add_f32_dpp v20, v20, v20 row_ror:8 row_mask:0xf bank_mask:0x3
v_add_f32_dpp v21, v21, v21 row_ror:8 row_mask:0xf bank_mask:0x3
v_add_f32_dpp v22, v22, v22 row_ror:8 row_mask:0xf bank_mask:0x3
v_add_f32_dpp v23, v23, v23 row_ror:8 row_mask:0xf bank_mask:0x3
v_add_f32_dpp v24, v24, v24 row_ror:8 row_mask:0xf bank_mask:0x3
v_add_f32_dpp v25, v25, v25 row_ror:8 row_mask:0xf bank_mask:0x3
v_add_f32_dpp v26, v26, v26 row_ror:8 row_mask:0xf bank_mask:0x3
v_add_f32_dpp v27, v27, v27 row_ror:8 row_mask:0xf bank_mask:0x3
v_add_f32_dpp v28, v28, v28 row_ror:8 row_mask:0xf bank_mask:0x3
v_add_f32_dpp v29, v29, v29 row_ror:8 row_mask:0xf bank_mask:0x3
v_add_f32_dpp v30, v30, v30 row_ror:8 row_mask:0xf bank_mask:0x3
v_add_f32_dpp v31, v31, v31 row_ror:8 row_mask:0xf bank_mask:0x3
v_add_f32_dpp v16, v32, v32 row_ror:8 row_mask:0xf bank_mask:0xc
v_add_f32_dpp v17, v33, v33 row_ror:8 row_mask:0xf bank_mask:0xc
v_add_f32_dpp v18, v34, v34 row_ror:8 row_mask:0xf bank_mask:0xc
v_add_f32_dpp v19, v35, v35 row_ror:8 row_mask:0xf bank_mask:0xc
v_add_f32_dpp v20, v36, v36 row_ror:8 row_mask:0xf bank_mask:0xc
v_add_f32_dpp v21, v37, v37 row_ror:8 row_mask:0xf bank_mask:0xc
v_add_f32_dpp v22, v38, v38 row_ror:8 row_mask:0xf bank_mask:0xc
v_add_f32_dpp v23, v39, v39 row_ror:8 row_mask:0xf bank_mask:0xc
v_add_f32_dpp v24, v40, v40 row_ror:8 row_mask:0xf bank_mask:0xc
v_add_f32_dpp v25, v41, v41 row_ror:8 row_mask:0xf bank_mask:0xc
v_add_f32_dpp v26, v42, v42 row_ror:8 row_mask:0xf bank_mask:0xc
v_add_f32_dpp v27, v43, v43 row_ror:8 row_mask:0xf bank_mask:0xc
v_add_f32_dpp v28, v44, v44 row_ror:8 row_mask:0xf bank_mask:0xc
v_add_f32_dpp v29, v45, v45 row_ror:8 row_mask:0xf bank_mask:0xc
v_add_f32_dpp v30, v46, v46 row_ror:8 row_mask:0xf bank_mask:0xc
v_add_f32_dpp v31, v47, v47 row_ror:8 row_mask:0xf bank_mask:0xc
v_add_f32_dpp v16, v16, v16 row_shl:4 row_mask:0xf bank_mask:0x5
v_add_f32_dpp v17, v17, v17 row_shl:4 row_mask:0xf bank_mask:0x5
v_add_f32_dpp v18, v18, v18 row_shl:4 row_mask:0xf bank_mask:0x5
v_add_f32_dpp v19, v19, v19 row_shl:4 row_mask:0xf bank_mask:0x5
v_add_f32_dpp v20, v20, v20 row_shl:4 row_mask:0xf bank_mask:0x5
v_add_f32_dpp v21, v21, v21 row_shl:4 row_mask:0xf bank_mask:0x5
v_add_f32_dpp v22, v22, v22 row_shl:4 row_mask:0xf bank_mask:0x5
v_add_f32_dpp v23, v23, v23 row_shl:4 row_mask:0xf bank_mask:0x5
v_add_f32_dpp v16, v24, v24 row_shr:4 row_mask:0xf bank_mask:0xa
v_add_f32_dpp v17, v25, v25 row_shr:4 row_mask:0xf bank_mask:0xa
v_add_f32_dpp v18, v26, v26 row_shr:4 row_mask:0xf bank_mask:0xa
v_add_f32_dpp v19, v27, v27 row_shr:4 row_mask:0xf bank_mask:0xa
v_add_f32_dpp v20, v28, v28 row_shr:4 row_mask:0xf bank_mask:0xa
v_add_f32_dpp v21, v29, v29 row_shr:4 row_mask:0xf bank_mask:0xa
v_add_f32_dpp v22, v30, v30 row_shr:4 row_mask:0xf bank_mask:0xa
v_add_f32_dpp v23, v31, v31 row_shr:4 row_mask:0xf bank_mask:0xa
v_add_f32_dpp v16, v16, v16 quad_perm:[1,0,3,2] row_mask:0xf bank_mask:0xf
v_add_f32_dpp v17, v17, v17 quad_perm:[1,0,3,2] row_mask:0xf bank_mask:0xf
v_add_f32_dpp v18, v18, v18 quad_perm:[1,0,3,2] row_mask:0xf bank_mask:0xf
v_add_f32_dpp v19, v19, v19 quad_perm:[1,0,3,2] row_mask:0xf bank_mask:0xf
v_add_f32_dpp v20, v20, v20 quad_perm:[1,0,3,2] row_mask:0xf bank_mask:0xf
v_add_f32_dpp v21, v21, v21 quad_perm:[1,0,3,2] row_mask:0xf bank_mask:0xf
v_add_f32_dpp v22, v22, v22 quad_perm:[1,0,3,2] row_mask:0xf bank_mask:0xf
v_add_f32_dpp v23, v23, v23 quad_perm:[1,0,3,2] row_mask:0xf bank_mask:0xf
v_add_f32_dpp v16, v16, v16 quad_perm:[2,3,0,1] row_mask:0xf bank_mask:0xf
v_add_f32_dpp v17, v17, v17 quad_perm:[2,3,0,1] row_mask:0xf bank_mask:0xf
v_add_f32_dpp v18, v18, v18 quad_perm:[2,3,0,1] row_mask:0xf bank_mask:0xf
v_add_f32_dpp v19, v19, v19 quad_perm:[2,3,0,1] row_mask:0xf bank_mask:0xf
v_add_f32_dpp v20, v20, v20 quad_perm:[2,3,0,1] row_mask:0xf bank_mask:0xf
v_add_f32_dpp v21, v21, v21 quad_perm:[2,3,0,1] row_mask:0xf bank_mask:0xf
v_add_f32_dpp v22, v22, v22 quad_perm:[2,3,0,1] row_mask:0xf bank_mask:0xf
v_add_f32_dpp v23, v23, v23 quad_perm:[2,3,0,1] row_mask:0xf bank_mask:0xf
s_mov_b32 s30, 0x11111111
s_mov_b32 s31, 0x11111111
s_mov_b64 exec, s[30:31]
ds_write_b128 v2, v[16:19] offset:0
ds_write_b128 v2, v[20:23] offset:16
s_mov_b64 exec, -1
s_waitcnt lgkmcnt(0)
s_barrier
v_mov_b32 v48, 0x3f803f80
v_mov_b32 v49, 0x3f803f80
v_mov_b32 v50, 0x3f803f80
v_mov_b32 v51, 0x3f803f80
v_cvt_pk_bf16_f32 v32, v160, v161
v_cvt_pk_bf16_f32 v33, v162, v163
v_cvt_pk_bf16_f32 v34, v164, v165
v_cvt_pk_bf16_f32 v35, v166, v167
v_cvt_pk_bf16_f32 v36, v168, v169
v_cvt_pk_bf16_f32 v37, v170, v171
v_cvt_pk_bf16_f32 v38, v172, v173
v_cvt_pk_bf16_f32 v39, v174, v175
v_cvt_pk_bf16_f32 v40, v176, v177
v_cvt_pk_bf16_f32 v41, v178, v179
v_cvt_pk_bf16_f32 v42, v180, v181
v_cvt_pk_bf16_f32 v43, v182, v183
v_cvt_pk_bf16_f32 v44, v184, v185
v_cvt_pk_bf16_f32 v45, v186, v187
v_cvt_pk_bf16_f32 v46, v188, v189
v_cvt_pk_bf16_f32 v47, v190, v191
v_pk_mul_f32 v[104:105], v[128:129], s[46:47]
v_pk_mul_f32 v[106:107], v[130:131], s[46:47]
v_pk_mul_f32 v[108:109], v[132:133], s[46:47]
v_pk_mul_f32 v[110:111], v[134:135], s[46:47]
v_max_f32 v128, 0, v128
v_max_f32 v129, 0, v129
v_max_f32 v130, 0, v130
v_max_f32 v131, 0, v131
v_max_f32 v132, 0, v132
v_max_f32 v133, 0, v133
v_max_f32 v134, 0, v134
v_max_f32 v135, 0, v135
v_exp_f32_e64 v104, v104 clamp
v_exp_f32_e64 v105, v105 clamp
v_exp_f32_e64 v106, v106 clamp
v_exp_f32_e64 v107, v107 clamp
v_exp_f32_e64 v108, v108 clamp
v_exp_f32_e64 v109, v109 clamp
v_exp_f32_e64 v110, v110 clamp
v_exp_f32_e64 v111, v111 clamp
v_pk_add_f32 v[128:129], v[128:129], s[48:49]
v_pk_add_f32 v[130:131], v[130:131], s[48:49]
v_pk_add_f32 v[132:133], v[132:133], s[48:49]
v_pk_add_f32 v[134:135], v[134:135], s[48:49]
v_pk_add_f32 v[128:129], v[128:129], v[104:105]
v_pk_add_f32 v[130:131], v[130:131], v[106:107]
v_pk_add_f32 v[132:133], v[132:133], v[108:109]
v_pk_add_f32 v[134:135], v[134:135], v[110:111]
v_cvt_pk_bf16_f32 v16, v128, v129
v_cvt_pk_bf16_f32 v17, v130, v131
v_cvt_pk_bf16_f32 v18, v132, v133
v_cvt_pk_bf16_f32 v19, v134, v135
v_pk_mul_f32 v[104:105], v[136:137], s[46:47]
v_pk_mul_f32 v[106:107], v[138:139], s[46:47]
v_pk_mul_f32 v[108:109], v[140:141], s[46:47]
v_pk_mul_f32 v[110:111], v[142:143], s[46:47]
v_max_f32 v136, 0, v136
v_max_f32 v137, 0, v137
v_max_f32 v138, 0, v138
v_max_f32 v139, 0, v139
v_max_f32 v140, 0, v140
v_max_f32 v141, 0, v141
v_max_f32 v142, 0, v142
v_max_f32 v143, 0, v143
v_exp_f32_e64 v104, v104 clamp
v_exp_f32_e64 v105, v105 clamp
v_exp_f32_e64 v106, v106 clamp
v_exp_f32_e64 v107, v107 clamp
v_exp_f32_e64 v108, v108 clamp
v_exp_f32_e64 v109, v109 clamp
v_exp_f32_e64 v110, v110 clamp
v_exp_f32_e64 v111, v111 clamp
v_pk_add_f32 v[136:137], v[136:137], s[48:49]
v_pk_add_f32 v[138:139], v[138:139], s[48:49]
v_pk_add_f32 v[140:141], v[140:141], s[48:49]
v_pk_add_f32 v[142:143], v[142:143], s[48:49]
v_pk_add_f32 v[136:137], v[136:137], v[104:105]
v_pk_add_f32 v[138:139], v[138:139], v[106:107]
v_pk_add_f32 v[140:141], v[140:141], v[108:109]
v_pk_add_f32 v[142:143], v[142:143], v[110:111]
v_cvt_pk_bf16_f32 v20, v136, v137
v_cvt_pk_bf16_f32 v21, v138, v139
v_cvt_pk_bf16_f32 v22, v140, v141
v_cvt_pk_bf16_f32 v23, v142, v143
v_pk_mul_f32 v[104:105], v[144:145], s[46:47]
v_pk_mul_f32 v[106:107], v[146:147], s[46:47]
v_pk_mul_f32 v[108:109], v[148:149], s[46:47]
v_pk_mul_f32 v[110:111], v[150:151], s[46:47]
v_max_f32 v144, 0, v144
v_max_f32 v145, 0, v145
v_max_f32 v146, 0, v146
v_max_f32 v147, 0, v147
v_max_f32 v148, 0, v148
v_max_f32 v149, 0, v149
v_max_f32 v150, 0, v150
v_max_f32 v151, 0, v151
v_exp_f32_e64 v104, v104 clamp
v_exp_f32_e64 v105, v105 clamp
v_exp_f32_e64 v106, v106 clamp
v_exp_f32_e64 v107, v107 clamp
v_exp_f32_e64 v108, v108 clamp
v_exp_f32_e64 v109, v109 clamp
v_exp_f32_e64 v110, v110 clamp
v_exp_f32_e64 v111, v111 clamp
v_pk_add_f32 v[144:145], v[144:145], s[48:49]
v_pk_add_f32 v[146:147], v[146:147], s[48:49]
v_pk_add_f32 v[148:149], v[148:149], s[48:49]
v_pk_add_f32 v[150:151], v[150:151], s[48:49]
v_pk_add_f32 v[144:145], v[144:145], v[104:105]
v_pk_add_f32 v[146:147], v[146:147], v[106:107]
v_pk_add_f32 v[148:149], v[148:149], v[108:109]
v_pk_add_f32 v[150:151], v[150:151], v[110:111]
v_cvt_pk_bf16_f32 v24, v144, v145
v_cvt_pk_bf16_f32 v25, v146, v147
v_cvt_pk_bf16_f32 v26, v148, v149
v_cvt_pk_bf16_f32 v27, v150, v151
v_pk_mul_f32 v[104:105], v[152:153], s[46:47]
v_pk_mul_f32 v[106:107], v[154:155], s[46:47]
v_pk_mul_f32 v[108:109], v[156:157], s[46:47]
v_pk_mul_f32 v[110:111], v[158:159], s[46:47]
v_max_f32 v152, 0, v152
v_max_f32 v153, 0, v153
v_max_f32 v154, 0, v154
v_max_f32 v155, 0, v155
v_max_f32 v156, 0, v156
v_max_f32 v157, 0, v157
v_max_f32 v158, 0, v158
v_max_f32 v159, 0, v159
v_exp_f32_e64 v104, v104 clamp
v_exp_f32_e64 v105, v105 clamp
v_exp_f32_e64 v106, v106 clamp
v_exp_f32_e64 v107, v107 clamp
v_exp_f32_e64 v108, v108 clamp
v_exp_f32_e64 v109, v109 clamp
v_exp_f32_e64 v110, v110 clamp
v_exp_f32_e64 v111, v111 clamp
v_pk_add_f32 v[152:153], v[152:153], s[48:49]
v_pk_add_f32 v[154:155], v[154:155], s[48:49]
v_pk_add_f32 v[156:157], v[156:157], s[48:49]
v_pk_add_f32 v[158:159], v[158:159], s[48:49]
v_pk_add_f32 v[152:153], v[152:153], v[104:105]
v_pk_add_f32 v[154:155], v[154:155], v[106:107]
v_pk_add_f32 v[156:157], v[156:157], v[108:109]
v_pk_add_f32 v[158:159], v[158:159], v[110:111]
v_cvt_pk_bf16_f32 v28, v152, v153
v_cvt_pk_bf16_f32 v29, v154, v155
v_cvt_pk_bf16_f32 v30, v156, v157
v_cvt_pk_bf16_f32 v31, v158, v159
s_nop 0
s_nop 1
v_mfma_f32_16x16x32_bf16 v[56:59], v[16:19], v[32:35], 0
v_mfma_f32_16x16x32_bf16 v[60:63], v[24:27], v[32:35], 0
v_mfma_f32_16x16x32_bf16 v[64:67], v[16:19], v[40:43], 0
v_mfma_f32_16x16x32_bf16 v[68:71], v[24:27], v[40:43], 0
v_mfma_f32_16x16x32_bf16 v[72:75], v[16:19], v[48:51], 0
v_mfma_f32_16x16x32_bf16 v[76:79], v[24:27], v[48:51], 0
v_mfma_f32_16x16x32_bf16 v[56:59], v[20:23], v[36:39], v[56:59]
v_mfma_f32_16x16x32_bf16 v[60:63], v[28:31], v[36:39], v[60:63]
v_mfma_f32_16x16x32_bf16 v[64:67], v[20:23], v[44:47], v[64:67]
v_mfma_f32_16x16x32_bf16 v[68:71], v[28:31], v[44:47], v[68:71]
v_mfma_f32_16x16x32_bf16 v[72:75], v[20:23], v[48:51], v[72:75]
v_mfma_f32_16x16x32_bf16 v[76:79], v[28:31], v[48:51], v[76:79]
s_lshl_b32 s30, s100, 1
s_lshl_b32 s30, s30, 5
s_lshl_b32 s31, s21, 1
s_add_u32 s30, s30, s31
s_add_u32 s30, s30, s23
s_mul_i32 s30, s30, 6144
s_add_u32 s30, s30, 37748736
s_add_u32 s31, s30, 4096
s_nop 7
buffer_store_dwordx4 v[56:59], v11, s[16:19], s30 offen offset:0 sc1
buffer_store_dwordx4 v[60:63], v11, s[16:19], s30 offen offset:1024 sc1
buffer_store_dwordx4 v[64:67], v11, s[16:19], s30 offen offset:2048 sc1
buffer_store_dwordx4 v[68:71], v11, s[16:19], s30 offen offset:3072 sc1
buffer_store_dwordx4 v[72:75], v11, s[16:19], s31 offen offset:0 sc1
buffer_store_dwordx4 v[76:79], v11, s[16:19], s31 offen offset:1024 sc1
s_nop 0
s_barrier
ds_read_b128 v[16:19], v5 offset:4096
ds_read_b128 v[32:35], v5 offset:4608
ds_read_b128 v[20:23], v5 offset:4112
ds_read_b128 v[36:39], v5 offset:4624
ds_read_b128 v[24:27], v5 offset:4224
ds_read_b128 v[40:43], v5 offset:4736
ds_read_b128 v[28:31], v5 offset:4240
ds_read_b128 v[44:47], v5 offset:4752
s_lshl_b32 s32, s22, 6
s_lshl_b32 s33, s21, 2
s_add_u32 s32, s32, s33
s_lshl_b32 s33, s23, 1
s_add_u32 s32, s32, s33
s_mul_i32 s32, s32, 7168
s_add_u32 s32, s32, 16777216
s_waitcnt lgkmcnt(0)
v_pk_fma_f32 v[192:193], v[192:193], v[16:17], v[32:33]
v_pk_fma_f32 v[194:195], v[194:195], v[18:19], v[34:35]
v_pk_fma_f32 v[196:197], v[196:197], v[20:21], v[36:37]
v_pk_fma_f32 v[198:199], v[198:199], v[22:23], v[38:39]
s_nop 0
s_add_u32 s33, s32, 0
v_cvt_pk_bf16_f32 v80, v192, v193
v_cvt_pk_bf16_f32 v81, v194, v195
v_cvt_pk_bf16_f32 v82, v196, v197
v_cvt_pk_bf16_f32 v83, v198, v199
buffer_store_dwordx4 v[80:83], v11, s[16:19], s33 offen sc1
v_pk_fma_f32 v[200:201], v[200:201], v[24:25], v[40:41]
v_pk_fma_f32 v[202:203], v[202:203], v[26:27], v[42:43]
v_pk_fma_f32 v[204:205], v[204:205], v[28:29], v[44:45]
v_pk_fma_f32 v[206:207], v[206:207], v[30:31], v[46:47]
s_add_u32 s33, s32, 7168
v_cvt_pk_bf16_f32 v84, v200, v201
v_cvt_pk_bf16_f32 v85, v202, v203
v_cvt_pk_bf16_f32 v86, v204, v205
v_cvt_pk_bf16_f32 v87, v206, v207
buffer_store_dwordx4 v[84:87], v11, s[16:19], s33 offen sc1
v_pk_fma_f32 v[208:209], v[208:209], v[16:17], v[32:33]
v_pk_fma_f32 v[210:211], v[210:211], v[18:19], v[34:35]
v_pk_fma_f32 v[212:213], v[212:213], v[20:21], v[36:37]
v_pk_fma_f32 v[214:215], v[214:215], v[22:23], v[38:39]
s_add_u32 s33, s32, 1024
v_cvt_pk_bf16_f32 v88, v208, v209
v_cvt_pk_bf16_f32 v89, v210, v211
v_cvt_pk_bf16_f32 v90, v212, v213
v_cvt_pk_bf16_f32 v91, v214, v215
buffer_store_dwordx4 v[88:91], v11, s[16:19], s33 offen sc1
v_pk_fma_f32 v[216:217], v[216:217], v[24:25], v[40:41]
v_pk_fma_f32 v[218:219], v[218:219], v[26:27], v[42:43]
v_pk_fma_f32 v[220:221], v[220:221], v[28:29], v[44:45]
v_pk_fma_f32 v[222:223], v[222:223], v[30:31], v[46:47]
s_add_u32 s33, s32, 8192
v_cvt_pk_bf16_f32 v92, v216, v217
v_cvt_pk_bf16_f32 v93, v218, v219
v_cvt_pk_bf16_f32 v94, v220, v221
v_cvt_pk_bf16_f32 v95, v222, v223
buffer_store_dwordx4 v[92:95], v11, s[16:19], s33 offen sc1
v_pk_mul_f32 v[104:105], v[224:225], v[224:225]
v_pk_mul_f32 v[106:107], v[226:227], v[226:227]
v_pk_mul_f32 v[108:109], v[228:229], v[228:229]
v_pk_mul_f32 v[110:111], v[230:231], v[230:231]
v_pk_fma_f32 v[104:105], v[104:105], s[42:43], v[12:13]
v_pk_fma_f32 v[106:107], v[106:107], s[42:43], v[12:13]
v_pk_fma_f32 v[108:109], v[108:109], s[42:43], v[12:13]
v_pk_fma_f32 v[110:111], v[110:111], s[42:43], v[12:13]
v_pk_mul_f32 v[104:105], v[104:105], v[224:225]
v_pk_mul_f32 v[106:107], v[106:107], v[226:227]
v_pk_mul_f32 v[108:109], v[108:109], v[228:229]
v_pk_mul_f32 v[110:111], v[110:111], v[230:231]
v_exp_f32 v104, v104
v_exp_f32 v105, v105
v_exp_f32 v106, v106
v_exp_f32 v107, v107
v_exp_f32 v108, v108
v_exp_f32 v109, v109
v_exp_f32 v110, v110
v_exp_f32 v111, v111
v_pk_add_f32 v[104:105], v[104:105], s[44:45]
v_pk_add_f32 v[106:107], v[106:107], s[44:45]
v_pk_add_f32 v[108:109], v[108:109], s[44:45]
v_pk_add_f32 v[110:111], v[110:111], s[44:45]
v_rcp_f32 v104, v104
v_rcp_f32 v105, v105
v_rcp_f32 v106, v106
v_rcp_f32 v107, v107
v_rcp_f32 v108, v108
v_rcp_f32 v109, v109
v_rcp_f32 v110, v110
v_rcp_f32 v111, v111
v_pk_mul_f32 v[224:225], v[224:225], v[104:105]
v_pk_mul_f32 v[226:227], v[226:227], v[106:107]
v_pk_mul_f32 v[228:229], v[228:229], v[108:109]
v_pk_mul_f32 v[230:231], v[230:231], v[110:111]
v_cvt_pk_bf16_f32 v96, v224, v225
v_cvt_pk_bf16_f32 v97, v226, v227
v_cvt_pk_bf16_f32 v98, v228, v229
v_cvt_pk_bf16_f32 v99, v230, v231
ds_write_b128 v6, v[96:99] offset:0
v_pk_mul_f32 v[104:105], v[232:233], v[232:233]
v_pk_mul_f32 v[106:107], v[234:235], v[234:235]
v_pk_mul_f32 v[108:109], v[236:237], v[236:237]
v_pk_mul_f32 v[110:111], v[238:239], v[238:239]
v_pk_fma_f32 v[104:105], v[104:105], s[42:43], v[12:13]
v_pk_fma_f32 v[106:107], v[106:107], s[42:43], v[12:13]
v_pk_fma_f32 v[108:109], v[108:109], s[42:43], v[12:13]
v_pk_fma_f32 v[110:111], v[110:111], s[42:43], v[12:13]
v_pk_mul_f32 v[104:105], v[104:105], v[232:233]
v_pk_mul_f32 v[106:107], v[106:107], v[234:235]
v_pk_mul_f32 v[108:109], v[108:109], v[236:237]
v_pk_mul_f32 v[110:111], v[110:111], v[238:239]
v_exp_f32 v104, v104
v_exp_f32 v105, v105
v_exp_f32 v106, v106
v_exp_f32 v107, v107
v_exp_f32 v108, v108
v_exp_f32 v109, v109
v_exp_f32 v110, v110
v_exp_f32 v111, v111
v_pk_add_f32 v[104:105], v[104:105], s[44:45]
v_pk_add_f32 v[106:107], v[106:107], s[44:45]
v_pk_add_f32 v[108:109], v[108:109], s[44:45]
v_pk_add_f32 v[110:111], v[110:111], s[44:45]
v_rcp_f32 v104, v104
v_rcp_f32 v105, v105
v_rcp_f32 v106, v106
v_rcp_f32 v107, v107
v_rcp_f32 v108, v108
v_rcp_f32 v109, v109
v_rcp_f32 v110, v110
v_rcp_f32 v111, v111
v_pk_mul_f32 v[232:233], v[232:233], v[104:105]
v_pk_mul_f32 v[234:235], v[234:235], v[106:107]
v_pk_mul_f32 v[236:237], v[236:237], v[108:109]
v_pk_mul_f32 v[238:239], v[238:239], v[110:111]
v_cvt_pk_bf16_f32 v100, v232, v233
v_cvt_pk_bf16_f32 v101, v234, v235
v_cvt_pk_bf16_f32 v102, v236, v237
v_cvt_pk_bf16_f32 v103, v238, v239
ds_write_b128 v6, v[100:103] offset:1024
s_waitcnt vmcnt(0)
s_barrier
s_cmp_lg_u32 s20, 0
s_cbranch_scc1 L_noz_6
s_lshl_b32 s30, s22, 4
s_add_u32 s30, s30, s21
s_lshl_b32 s30, s30, 7
s_add_u32 s30, s30, 47185920
v_mov_b32 v20, 0
v_mov_b32 v21, 0
v_mov_b32 v22, 0
v_mov_b32_e64 v23, 0
s_mov_b64 exec, 0xff
buffer_store_dwordx4 v[20:23], v11, s[16:19], s30 offen sc1
s_mov_b64 exec, -1
s_lshl_b32 s30, s22, 11
s_add_u32 s30, s30, 47185920
s_mov_b32 s36, 0
L_poll_7:
v_mov_b32 v24, 0
v_lshlrev_b32_e64 v25, 3, v11
s_mov_b64 exec, 0xffff
buffer_load_dword v24, v25, s[16:19], s30 offen sc1
s_mov_b64 exec, -1
s_waitcnt vmcnt(0)
L_pollc_9:
v_cmp_eq_u32 vcc, -1, v24
s_add_u32 s36, s36, 1
s_cmp_ge_u32 s36, 6000
s_cbranch_scc1 L_pollx_8
s_cmp_lg_u64 vcc, 0
s_cbranch_scc1 L_poll_7
L_pollx_8:
L_noz_6:
s_branch L_r0
L_g1:
s_lshl_b32 s24, s21, 18
s_lshl_b32 s25, s100, 7
s_add_u32 s25, s25, 2048
s_mul_i32 s26, s22, 224
s_lshl_b32 s27, s20, 11
s_mul_i32 s28, s23, 13312
s_lshr_b32 s30, s22, 1
s_and_b32 s31, s22, 1
s_lshl_b32 s33, s22, 4
s_add_u32 s33, s33, s21
s_lshl_b32 s34, s21, 4
s_add_u32 s34, s34, s22
v_mov_b32 v72, s33
v_mov_b32 v73, s34
v_cmp_gt_u32 vcc, 8, v12
v_cndmask_b32 v72, v73, v72, vcc
v_min_u32 v73, 31, v12
v_lshrrev_b32_e64 v74, 3, v73
v_lshl_add_u32 v72, v74, 8, v72
v_and_b32 v73, 7, v73
v_lshlrev_b32 v73, 4, v73
v_lshl_add_u32 v68, v72, 7, v73
s_mov_b32 s33, 47185920
v_mov_b32 v72, -1
v_mov_b32 v73, -1
v_mov_b32 v74, -1
v_mov_b32 v75, -1
buffer_store_dwordx4 v[72:75], v68, s[16:19], s33 offen sc1
s_add_u32 m0, s28, 10240
s_nop 0
buffer_load_dwordx4 v3, s[8:11], s25 offen offset:0 lds
s_add_u32 m0, s28, 11200
s_nop 0
buffer_load_dwordx4 v3, s[8:11], s25 offen offset:64 lds
s_add_u32 s25, s25, 196608
s_add_u32 m0, s28, 45056
s_nop 0
buffer_load_dwordx4 v3, s[8:11], s25 offen offset:0 lds
s_add_u32 m0, s28, 46016
s_nop 0
buffer_load_dwordx4 v3, s[8:11], s25 offen offset:64 lds
s_add_u32 s25, s25, 196608
s_lshl_b32 s32, s21, 18
s_lshl_b32 s33, s30, 10
s_add_u32 s32, s32, s33
s_lshl_b32 s33, s31, 7
s_add_u32 s32, s32, s33
s_lshl_b32 s33, s20, 15
s_add_u32 s32, s32, s33
s_add_u32 s33, s32, 16384
s_mov_b32 s36, 0xffff0000
s_waitcnt vmcnt(5)
v_lshlrev_b32 v32, 16, v16
v_and_b32 v33, s36, v16
v_lshlrev_b32 v34, 16, v17
v_and_b32 v35, s36, v17
v_lshlrev_b32 v36, 16, v18
v_and_b32 v37, s36, v18
v_lshlrev_b32 v38, 16, v19
v_and_b32 v39, s36, v19
v_lshlrev_b32 v40, 16, v20
v_and_b32 v41, s36, v20
v_lshlrev_b32 v42, 16, v21
v_and_b32 v43, s36, v21
v_lshlrev_b32 v44, 16, v22
v_and_b32 v45, s36, v22
v_lshlrev_b32 v46, 16, v23
v_and_b32 v47, s36, v23
v_pk_add_f32 v[66:67], v[32:33], v[34:35]
v_pk_mul_f32 v[68:69], v[32:33], v[32:33]
v_pk_fma_f32 v[68:69], v[34:35], v[34:35], v[68:69]
v_pk_add_f32 v[66:67], v[66:67], v[36:37]
v_pk_fma_f32 v[68:69], v[36:37], v[36:37], v[68:69]
v_pk_add_f32 v[66:67], v[66:67], v[38:39]
v_pk_fma_f32 v[68:69], v[38:39], v[38:39], v[68:69]
v_pk_add_f32 v[66:67], v[66:67], v[40:41]
v_pk_fma_f32 v[68:69], v[40:41], v[40:41], v[68:69]
v_pk_add_f32 v[66:67], v[66:67], v[42:43]
v_pk_fma_f32 v[68:69], v[42:43], v[42:43], v[68:69]
v_pk_add_f32 v[66:67], v[66:67], v[44:45]
v_pk_fma_f32 v[68:69], v[44:45], v[44:45], v[68:69]
v_pk_add_f32 v[66:67], v[66:67], v[46:47]
v_pk_fma_f32 v[68:69], v[46:47], v[46:47], v[68:69]
v_add_f32 v66, v66, v67
v_add_f32_e64 v67, v68, v69
s_nop 1
v_add_f32_dpp v66, v66, v66 row_ror:8 row_mask:0xf bank_mask:0xf
v_add_f32_dpp v67, v67, v67 row_ror:8 row_mask:0xf bank_mask:0xf
v_mov_b32 v68, v66
v_mov_b32 v69, v67
s_nop 1
v_permlane16_swap_b32 v68, v66
v_permlane16_swap_b32 v69, v67
s_nop 1
v_pk_add_f32 v[66:67], v[66:67], v[68:69]
v_mov_b32 v68, v66
v_mov_b32 v69, v67
s_nop 1
v_permlane32_swap_b32 v68, v66
v_permlane32_swap_b32 v69, v67
s_nop 1
v_pk_add_f32 v[66:67], v[66:67], v[68:69]
s_mov_b64 exec, 0xff
ds_write_b64 v62, v[66:67]
s_nop 0
s_mov_b64 exec, -1
s_waitcnt lgkmcnt(0)
s_barrier
ds_read_b128 v[16:19], v63 offset:0
ds_read_b128 v[20:23], v63 offset:16
ds_read_b128 v[24:27], v63 offset:32
ds_read_b128 v[28:31], v63 offset:48
s_nop 0
s_waitcnt lgkmcnt(0)
v_pk_add_f32 v[16:17], v[16:17], v[24:25]
v_pk_add_f32 v[18:19], v[18:19], v[26:27]
v_pk_add_f32 v[20:21], v[20:21], v[28:29]
v_pk_add_f32 v[22:23], v[22:23], v[30:31]
v_pk_add_f32 v[16:17], v[16:17], v[20:21]
v_pk_add_f32 v[18:19], v[18:19], v[22:23]
v_pk_add_f32 v[16:17], v[16:17], v[18:19]
v_mul_f32 v16, 0x3a800000, v16
v_mul_f32 v17, 0x3a800000, v17
v_fma_f32 v17, -v16, v16, v17
v_max_f32_e64 v17, 0, v17
v_add_f32 v17, 0x3727c5ac, v17
v_rsq_f32 v18, v17
v_mul_f32 v16, -1.0, v16
v_mov_b32 v17, v16
v_mov_b32 v19, v18
v_pk_add_f32 v[32:33], v[32:33], v[16:17]
v_pk_add_f32 v[34:35], v[34:35], v[16:17]
v_pk_add_f32 v[36:37], v[36:37], v[16:17]
v_pk_add_f32 v[38:39], v[38:39], v[16:17]
v_pk_add_f32 v[40:41], v[40:41], v[16:17]
v_pk_add_f32 v[42:43], v[42:43], v[16:17]
v_pk_add_f32 v[44:45], v[44:45], v[16:17]
v_pk_add_f32 v[46:47], v[46:47], v[16:17]
v_pk_mul_f32 v[32:33], v[32:33], v[18:19]
v_pk_mul_f32 v[34:35], v[34:35], v[18:19]
v_pk_mul_f32 v[36:37], v[36:37], v[18:19]
v_pk_mul_f32 v[38:39], v[38:39], v[18:19]
v_pk_mul_f32 v[40:41], v[40:41], v[18:19]
v_pk_mul_f32 v[42:43], v[42:43], v[18:19]
v_pk_mul_f32 v[44:45], v[44:45], v[18:19]
v_pk_mul_f32 v[46:47], v[46:47], v[18:19]
v_cvt_pk_bf16_f32 v20, v32, v33
v_cvt_pk_bf16_f32 v21, v34, v35
v_cvt_pk_bf16_f32 v22, v36, v37
v_cvt_pk_bf16_f32 v23, v38, v39
v_cvt_pk_bf16_f32 v24, v40, v41
v_cvt_pk_bf16_f32 v25, v42, v43
v_cvt_pk_bf16_f32 v26, v44, v45
v_cvt_pk_bf16_f32 v27, v46, v47
buffer_store_dwordx4 v[20:23], v65, s[16:19], s32 offen sc1
buffer_store_dwordx4 v[24:27], v65, s[16:19], s33 offen sc1
s_lshl_b32 s30, s21, 4
s_waitcnt vmcnt(0)
s_barrier
s_add_u32 m0, s28, 79872
s_nop 0
buffer_load_dwordx4 v3, s[8:11], s25 offen offset:0 lds
s_add_u32 m0, s28, 80832
s_nop 0
buffer_load_dwordx4 v3, s[8:11], s25 offen offset:64 lds
s_add_u32 s25, s25, 196608
s_add_u32 m0, s28, 114688
s_nop 0
buffer_load_dwordx4 v3, s[8:11], s25 offen offset:0 lds
s_add_u32 m0, s28, 115648
s_nop 0
buffer_load_dwordx4 v3, s[8:11], s25 offen offset:64 lds
s_add_u32 s25, s25, 196608
v_lshrrev_b32 v13, 3, v12
v_lshrrev_b32 v14, 5, v12
v_and_b32 v123, 3, v13
v_lshl_add_u32 v14, v14, 3, v123
v_lshlrev_b32 v14, 12, v14
v_lshrrev_b32 v13, 4, v12
v_and_b32 v123, 7, v12
v_xor_b32 v13, v13, v123
v_lshl_add_u32 v112, v13, 4, v14
v_xor_b32_e64 v113, 64, v112
v_add_u32 v114, 14336, v112
v_add_u32 v115, 78848, v113
v_add_u32 v113, 64512, v113
v_and_b32 v13, 15, v12
v_lshrrev_b32 v14, 1, v13
v_lshrrev_b32 v123, 4, v12
v_xor_b32 v14, v14, v123
v_lshlrev_b32_e64 v14, 4, v14
v_lshl_add_u32 v116, v13, 7, v14
s_and_b32 s36, s20, 3
s_lshl_b32 s36, s36, 12
v_add_u32 v116, s36, v116
v_xor_b32 v117, 64, v116
v_add_u32 v118, 61440, v116
v_add_u32 v119, 61440, v117
s_lshr_b32 s36, s20, 2
s_lshl_b32 s36, s36, 12
s_add_u32 s36, s36, 16384
v_add_u32_e64 v121, s36, v11
v_add_u32 v122, 61440, v121
v_bfe_u32 v13, v12, 2, 2
v_and_b32_e64 v14, 3, v12
v_lshl_add_u32 v13, v13, 3, v14
v_lshlrev_b32 v120, 1, v13
s_barrier
s_add_u32 m0, s27, 0
s_nop 0
buffer_load_dwordx4 v2, s[16:19], s24 offen sc1 lds
buffer_load_dwordx4 v2, s[16:19], s24 offen offset:1024 sc1 lds
s_add_u32 s24, s24, 8192
s_add_u32 m0, s27, 34816
s_nop 0
s_nop 0
buffer_load_dwordx4 v2, s[16:19], s24 offen sc1 lds
buffer_load_dwordx4 v2, s[16:19], s24 offen offset:1024 sc1 lds
s_add_u32 s24, s24, 8192
s_add_u32 m0, s27, 69632
s_nop 0
s_nop 0
buffer_load_dwordx4 v2, s[16:19], s24 offen sc1 lds
buffer_load_dwordx4 v2, s[16:19], s24 offen offset:1024 sc1 lds
s_add_u32 s24, s24, 8192
s_add_u32 m0, s27, 104448
s_nop 0
buffer_load_dwordx4 v2, s[16:19], s24 offen sc1 lds
buffer_load_dwordx4 v2, s[16:19], s24 offen offset:1024 sc1 lds
s_add_u32 s24, s24, 8192
s_nop 0
s_waitcnt vmcnt(6)
s_barrier
ds_read_b128 v[16:19], v5 offset:0
ds_read_b128 v[20:23], v5 offset:1024
ds_read_b128 v[24:27], v5 offset:2048
ds_read_b128 v[28:31], v5 offset:3072
ds_read_b64_tr_b16 v[48:49], v7 offset:3072
ds_read_b64_tr_b16 v[50:51], v7 offset:3328
ds_read_b64_tr_b16 v[52:53], v8 offset:3072
ds_read_b64_tr_b16 v[54:55], v8 offset:3328
ds_read_b64_tr_b16 v[56:57], v7 offset:5120
ds_read_b64_tr_b16 v[58:59], v7 offset:5376
ds_read_b64_tr_b16 v[60:61], v8 offset:5120
ds_read_b64_tr_b16 v[62:63], v8 offset:5376
ds_read_b64_tr_b16 v[64:65], v7 offset:11264
ds_read_b64_tr_b16 v[66:67], v7 offset:11520
ds_read_b64_tr_b16 v[68:69], v8 offset:6144
ds_read_b64_tr_b16 v[70:71], v8 offset:6400
ds_read_b64_tr_b16 v[72:73], v7 offset:7168
ds_read_b64_tr_b16 v[74:75], v7 offset:7424
s_waitcnt vmcnt(4) lgkmcnt(0)
s_barrier
v_mfma_f32_16x16x32_bf16 v[128:131], v[16:19], v[48:51], 0
ds_read_b128 v[32:35], v5 offset:34816
v_mfma_f32_16x16x32_bf16 v[132:135], v[20:23], v[48:51], 0
ds_read_b128 v[36:39], v5 offset:35840
v_mfma_f32_16x16x32_bf16 v[136:139], v[24:27], v[48:51], 0
ds_read_b128 v[40:43], v5 offset:36864
s_nop 0
s_add_u32 m0, s27, 0
v_mfma_f32_16x16x32_bf16 v[140:143], v[28:31], v[48:51], 0
ds_read_b128 v[44:47], v5 offset:37888
buffer_load_dwordx4 v2, s[16:19], s24 offen sc1 lds
v_mfma_f32_16x16x32_bf16 v[144:147], v[16:19], v[52:55], 0
ds_read_b64_tr_b16 v[76:77], v7 offset:37888
v_mfma_f32_16x16x32_bf16 v[148:151], v[20:23], v[52:55], 0
ds_read_b64_tr_b16 v[78:79], v7 offset:38144
v_mfma_f32_16x16x32_bf16 v[152:155], v[24:27], v[52:55], 0
ds_read_b64_tr_b16 v[80:81], v8 offset:37888
v_mfma_f32_16x16x32_bf16 v[156:159], v[28:31], v[52:55], 0
ds_read_b64_tr_b16 v[82:83], v8 offset:38144
v_mfma_f32_16x16x32_bf16 v[160:163], v[16:19], v[56:59], 0
ds_read_b64_tr_b16 v[84:85], v7 offset:39936
buffer_load_dwordx4 v2, s[16:19], s24 offen offset:1024 sc1 lds
s_add_u32 s24, s24, 8192
v_mfma_f32_16x16x32_bf16 v[164:167], v[20:23], v[56:59], 0
ds_read_b64_tr_b16 v[86:87], v7 offset:40192
v_mfma_f32_16x16x32_bf16 v[168:171], v[24:27], v[56:59], 0
ds_read_b64_tr_b16 v[88:89], v8 offset:39936
v_mfma_f32_16x16x32_bf16 v[172:175], v[28:31], v[56:59], 0
ds_read_b64_tr_b16 v[90:91], v8 offset:40192
v_mfma_f32_16x16x32_bf16 v[176:179], v[16:19], v[60:63], 0
ds_read_b64_tr_b16 v[92:93], v7 offset:46080
s_add_u32 m0, s28, 10240
v_mfma_f32_16x16x32_bf16 v[180:183], v[20:23], v[60:63], 0
ds_read_b64_tr_b16 v[94:95], v7 offset:46336
buffer_load_dwordx4 v3, s[8:11], s25 offen offset:0 lds
v_mfma_f32_16x16x32_bf16 v[184:187], v[24:27], v[60:63], 0
ds_read_b64_tr_b16 v[96:97], v8 offset:40960
v_mfma_f32_16x16x32_bf16 v[188:191], v[28:31], v[60:63], 0
ds_read_b64_tr_b16 v[98:99], v8 offset:41216
v_mfma_f32_16x16x32_bf16 v[192:195], v[16:19], v[64:67], 0
ds_read_b64_tr_b16 v[100:101], v7 offset:41984
v_mfma_f32_16x16x32_bf16 v[196:199], v[20:23], v[64:67], 0
ds_read_b64_tr_b16 v[102:103], v7 offset:42240
s_add_u32 m0, s28, 11200
v_mfma_f32_16x16x32_bf16 v[200:203], v[24:27], v[64:67], 0
buffer_load_dwordx4 v3, s[8:11], s25 offen offset:64 lds
s_add_u32 s25, s25, 196608
v_mfma_f32_16x16x32_bf16 v[204:207], v[28:31], v[64:67], 0
v_mfma_f32_16x16x32_bf16 v[208:211], v[68:71], v[16:19], 0
v_mfma_f32_16x16x32_bf16 v[212:215], v[68:71], v[20:23], 0
v_mfma_f32_16x16x32_bf16 v[216:219], v[68:71], v[24:27], 0
v_mfma_f32_16x16x32_bf16 v[220:223], v[68:71], v[28:31], 0
v_mfma_f32_16x16x32_bf16 v[224:227], v[72:75], v[16:19], 0
v_mfma_f32_16x16x32_bf16 v[228:231], v[72:75], v[20:23], 0
v_mfma_f32_16x16x32_bf16 v[232:235], v[72:75], v[24:27], 0
v_mfma_f32_16x16x32_bf16 v[236:239], v[72:75], v[28:31], 0
s_waitcnt vmcnt(6) lgkmcnt(0)
s_barrier
v_mfma_f32_16x16x32_bf16 v[128:131], v[32:35], v[76:79], v[128:131]
ds_read_b128 v[16:19], v6 offset:0
v_mfma_f32_16x16x32_bf16 v[132:135], v[36:39], v[76:79], v[132:135]
ds_read_b128 v[20:23], v6 offset:1024
v_mfma_f32_16x16x32_bf16 v[136:139], v[40:43], v[76:79], v[136:139]
ds_read_b128 v[24:27], v6 offset:2048
s_add_u32 m0, s27, 34816
v_mfma_f32_16x16x32_bf16 v[140:143], v[44:47], v[76:79], v[140:143]
ds_read_b128 v[28:31], v6 offset:3072
buffer_load_dwordx4 v2, s[16:19], s24 offen sc1 lds
v_mfma_f32_16x16x32_bf16 v[144:147], v[32:35], v[80:83], v[144:147]
ds_read_b64_tr_b16 v[48:49], v9 offset:3072
v_mfma_f32_16x16x32_bf16 v[148:151], v[36:39], v[80:83], v[148:151]
ds_read_b64_tr_b16 v[50:51], v9 offset:3328
v_mfma_f32_16x16x32_bf16 v[152:155], v[40:43], v[80:83], v[152:155]
ds_read_b64_tr_b16 v[52:53], v10 offset:3072
v_mfma_f32_16x16x32_bf16 v[156:159], v[44:47], v[80:83], v[156:159]
ds_read_b64_tr_b16 v[54:55], v10 offset:3328
v_mfma_f32_16x16x32_bf16 v[160:163], v[32:35], v[84:87], v[160:163]
ds_read_b64_tr_b16 v[56:57], v9 offset:5120
buffer_load_dwordx4 v2, s[16:19], s24 offen offset:1024 sc1 lds
s_add_u32 s24, s24, 8192
v_mfma_f32_16x16x32_bf16 v[164:167], v[36:39], v[84:87], v[164:167]
ds_read_b64_tr_b16 v[58:59], v9 offset:5376
v_mfma_f32_16x16x32_bf16 v[168:171], v[40:43], v[84:87], v[168:171]
ds_read_b64_tr_b16 v[60:61], v10 offset:5120
v_mfma_f32_16x16x32_bf16 v[172:175], v[44:47], v[84:87], v[172:175]
ds_read_b64_tr_b16 v[62:63], v10 offset:5376
v_mfma_f32_16x16x32_bf16 v[176:179], v[32:35], v[88:91], v[176:179]
ds_read_b64_tr_b16 v[64:65], v9 offset:11264
s_add_u32 m0, s28, 45056
v_mfma_f32_16x16x32_bf16 v[180:183], v[36:39], v[88:91], v[180:183]
ds_read_b64_tr_b16 v[66:67], v9 offset:11520
buffer_load_dwordx4 v3, s[8:11], s25 offen offset:0 lds
v_mfma_f32_16x16x32_bf16 v[184:187], v[40:43], v[88:91], v[184:187]
ds_read_b64_tr_b16 v[68:69], v10 offset:6144
v_mfma_f32_16x16x32_bf16 v[188:191], v[44:47], v[88:91], v[188:191]
ds_read_b64_tr_b16 v[70:71], v10 offset:6400
v_mfma_f32_16x16x32_bf16 v[192:195], v[32:35], v[92:95], v[192:195]
ds_read_b64_tr_b16 v[72:73], v9 offset:7168
v_mfma_f32_16x16x32_bf16 v[196:199], v[36:39], v[92:95], v[196:199]
ds_read_b64_tr_b16 v[74:75], v9 offset:7424
s_add_u32 m0, s28, 46016
v_mfma_f32_16x16x32_bf16 v[200:203], v[40:43], v[92:95], v[200:203]
buffer_load_dwordx4 v3, s[8:11], s25 offen offset:64 lds
s_add_u32 s25, s25, 196608
v_mfma_f32_16x16x32_bf16 v[204:207], v[44:47], v[92:95], v[204:207]
v_mfma_f32_16x16x32_bf16 v[208:211], v[96:99], v[32:35], v[208:211]
v_mfma_f32_16x16x32_bf16 v[212:215], v[96:99], v[36:39], v[212:215]
v_mfma_f32_16x16x32_bf16 v[216:219], v[96:99], v[40:43], v[216:219]
v_mfma_f32_16x16x32_bf16 v[220:223], v[96:99], v[44:47], v[220:223]
v_mfma_f32_16x16x32_bf16 v[224:227], v[100:103], v[32:35], v[224:227]
v_mfma_f32_16x16x32_bf16 v[228:231], v[100:103], v[36:39], v[228:231]
v_mfma_f32_16x16x32_bf16 v[232:235], v[100:103], v[40:43], v[232:235]
v_mfma_f32_16x16x32_bf16 v[236:239], v[100:103], v[44:47], v[236:239]
s_waitcnt vmcnt(8) lgkmcnt(0)
s_barrier
v_mfma_f32_16x16x32_bf16 v[128:131], v[16:19], v[48:51], v[128:131]
ds_read_b128 v[32:35], v6 offset:34816
v_mfma_f32_16x16x32_bf16 v[132:135], v[20:23], v[48:51], v[132:135]
ds_read_b128 v[36:39], v6 offset:35840
v_mfma_f32_16x16x32_bf16 v[136:139], v[24:27], v[48:51], v[136:139]
ds_read_b128 v[40:43], v6 offset:36864
s_add_u32 m0, s27, 69632
v_mfma_f32_16x16x32_bf16 v[140:143], v[28:31], v[48:51], v[140:143]
ds_read_b128 v[44:47], v6 offset:37888
buffer_load_dwordx4 v2, s[16:19], s24 offen sc1 lds
v_mfma_f32_16x16x32_bf16 v[144:147], v[16:19], v[52:55], v[144:147]
ds_read_b64_tr_b16 v[76:77], v9 offset:37888
v_mfma_f32_16x16x32_bf16 v[148:151], v[20:23], v[52:55], v[148:151]
ds_read_b64_tr_b16 v[78:79], v9 offset:38144
v_mfma_f32_16x16x32_bf16 v[152:155], v[24:27], v[52:55], v[152:155]
ds_read_b64_tr_b16 v[80:81], v10 offset:37888
v_mfma_f32_16x16x32_bf16 v[156:159], v[28:31], v[52:55], v[156:159]
ds_read_b64_tr_b16 v[82:83], v10 offset:38144
v_mfma_f32_16x16x32_bf16 v[160:163], v[16:19], v[56:59], v[160:163]
ds_read_b64_tr_b16 v[84:85], v9 offset:39936
buffer_load_dwordx4 v2, s[16:19], s24 offen offset:1024 sc1 lds
s_add_u32 s24, s24, 8192
v_mfma_f32_16x16x32_bf16 v[164:167], v[20:23], v[56:59], v[164:167]
ds_read_b64_tr_b16 v[86:87], v9 offset:40192
v_mfma_f32_16x16x32_bf16 v[168:171], v[24:27], v[56:59], v[168:171]
ds_read_b64_tr_b16 v[88:89], v10 offset:39936
v_mfma_f32_16x16x32_bf16 v[172:175], v[28:31], v[56:59], v[172:175]
ds_read_b64_tr_b16 v[90:91], v10 offset:40192
v_mfma_f32_16x16x32_bf16 v[176:179], v[16:19], v[60:63], v[176:179]
ds_read_b64_tr_b16 v[92:93], v9 offset:46080
s_add_u32 m0, s28, 79872
v_mfma_f32_16x16x32_bf16 v[180:183], v[20:23], v[60:63], v[180:183]
ds_read_b64_tr_b16 v[94:95], v9 offset:46336
buffer_load_dwordx4 v3, s[8:11], s25 offen offset:0 lds
v_mfma_f32_16x16x32_bf16 v[184:187], v[24:27], v[60:63], v[184:187]
ds_read_b64_tr_b16 v[96:97], v10 offset:40960
v_mfma_f32_16x16x32_bf16 v[188:191], v[28:31], v[60:63], v[188:191]
ds_read_b64_tr_b16 v[98:99], v10 offset:41216
v_mfma_f32_16x16x32_bf16 v[192:195], v[16:19], v[64:67], v[192:195]
ds_read_b64_tr_b16 v[100:101], v9 offset:41984
v_mfma_f32_16x16x32_bf16 v[196:199], v[20:23], v[64:67], v[196:199]
ds_read_b64_tr_b16 v[102:103], v9 offset:42240
s_add_u32 m0, s28, 80832
v_mfma_f32_16x16x32_bf16 v[200:203], v[24:27], v[64:67], v[200:203]
buffer_load_dwordx4 v3, s[8:11], s25 offen offset:64 lds
s_add_u32 s25, s25, 196608
v_mfma_f32_16x16x32_bf16 v[204:207], v[28:31], v[64:67], v[204:207]
v_mfma_f32_16x16x32_bf16 v[208:211], v[68:71], v[16:19], v[208:211]
v_mfma_f32_16x16x32_bf16 v[212:215], v[68:71], v[20:23], v[212:215]
v_mfma_f32_16x16x32_bf16 v[216:219], v[68:71], v[24:27], v[216:219]
v_mfma_f32_16x16x32_bf16 v[220:223], v[68:71], v[28:31], v[220:223]
v_mfma_f32_16x16x32_bf16 v[224:227], v[72:75], v[16:19], v[224:227]
v_mfma_f32_16x16x32_bf16 v[228:231], v[72:75], v[20:23], v[228:231]
v_mfma_f32_16x16x32_bf16 v[232:235], v[72:75], v[24:27], v[232:235]
v_mfma_f32_16x16x32_bf16 v[236:239], v[72:75], v[28:31], v[236:239]
s_waitcnt vmcnt(8) lgkmcnt(0)
s_barrier
v_mfma_f32_16x16x32_bf16 v[128:131], v[32:35], v[76:79], v[128:131]
ds_read_b128 v[16:19], v5 offset:0
v_mfma_f32_16x16x32_bf16 v[132:135], v[36:39], v[76:79], v[132:135]
ds_read_b128 v[20:23], v5 offset:1024
v_mfma_f32_16x16x32_bf16 v[136:139], v[40:43], v[76:79], v[136:139]
ds_read_b128 v[24:27], v5 offset:2048
s_add_u32 m0, s27, 104448
v_mfma_f32_16x16x32_bf16 v[140:143], v[44:47], v[76:79], v[140:143]
ds_read_b128 v[28:31], v5 offset:3072
buffer_load_dwordx4 v2, s[16:19], s24 offen sc1 lds
v_mfma_f32_16x16x32_bf16 v[144:147], v[32:35], v[80:83], v[144:147]
ds_read_b64_tr_b16 v[48:49], v7 offset:3072
v_mfma_f32_16x16x32_bf16 v[148:151], v[36:39], v[80:83], v[148:151]
ds_read_b64_tr_b16 v[50:51], v7 offset:3328
v_mfma_f32_16x16x32_bf16 v[152:155], v[40:43], v[80:83], v[152:155]
ds_read_b64_tr_b16 v[52:53], v8 offset:3072
v_mfma_f32_16x16x32_bf16 v[156:159], v[44:47], v[80:83], v[156:159]
ds_read_b64_tr_b16 v[54:55], v8 offset:3328
v_mfma_f32_16x16x32_bf16 v[160:163], v[32:35], v[84:87], v[160:163]
ds_read_b64_tr_b16 v[56:57], v7 offset:5120
buffer_load_dwordx4 v2, s[16:19], s24 offen offset:1024 sc1 lds
s_add_u32 s24, s24, 8192
v_mfma_f32_16x16x32_bf16 v[164:167], v[36:39], v[84:87], v[164:167]
ds_read_b64_tr_b16 v[58:59], v7 offset:5376
v_mfma_f32_16x16x32_bf16 v[168:171], v[40:43], v[84:87], v[168:171]
ds_read_b64_tr_b16 v[60:61], v8 offset:5120
v_mfma_f32_16x16x32_bf16 v[172:175], v[44:47], v[84:87], v[172:175]
ds_read_b64_tr_b16 v[62:63], v8 offset:5376
v_mfma_f32_16x16x32_bf16 v[176:179], v[32:35], v[88:91], v[176:179]
ds_read_b64_tr_b16 v[64:65], v7 offset:11264
s_add_u32 m0, s28, 114688
v_mfma_f32_16x16x32_bf16 v[180:183], v[36:39], v[88:91], v[180:183]
ds_read_b64_tr_b16 v[66:67], v7 offset:11520
buffer_load_dwordx4 v3, s[8:11], s25 offen offset:0 lds
v_mfma_f32_16x16x32_bf16 v[184:187], v[40:43], v[88:91], v[184:187]
ds_read_b64_tr_b16 v[68:69], v8 offset:6144
v_mfma_f32_16x16x32_bf16 v[188:191], v[44:47], v[88:91], v[188:191]
ds_read_b64_tr_b16 v[70:71], v8 offset:6400
v_mfma_f32_16x16x32_bf16 v[192:195], v[32:35], v[92:95], v[192:195]
ds_read_b64_tr_b16 v[72:73], v7 offset:7168
v_mfma_f32_16x16x32_bf16 v[196:199], v[36:39], v[92:95], v[196:199]
ds_read_b64_tr_b16 v[74:75], v7 offset:7424
s_add_u32 m0, s28, 115648
v_mfma_f32_16x16x32_bf16 v[200:203], v[40:43], v[92:95], v[200:203]
buffer_load_dwordx4 v3, s[8:11], s25 offen offset:64 lds
s_add_u32 s25, s25, 196608
v_mfma_f32_16x16x32_bf16 v[204:207], v[44:47], v[92:95], v[204:207]
v_mfma_f32_16x16x32_bf16 v[208:211], v[96:99], v[32:35], v[208:211]
v_mfma_f32_16x16x32_bf16 v[212:215], v[96:99], v[36:39], v[212:215]
v_mfma_f32_16x16x32_bf16 v[216:219], v[96:99], v[40:43], v[216:219]
v_mfma_f32_16x16x32_bf16 v[220:223], v[96:99], v[44:47], v[220:223]
v_mfma_f32_16x16x32_bf16 v[224:227], v[100:103], v[32:35], v[224:227]
v_mfma_f32_16x16x32_bf16 v[228:231], v[100:103], v[36:39], v[228:231]
v_mfma_f32_16x16x32_bf16 v[232:235], v[100:103], v[40:43], v[232:235]
v_mfma_f32_16x16x32_bf16 v[236:239], v[100:103], v[44:47], v[236:239]
s_nop 0
s_mov_b32 s29, 6
L_loop1_1:
s_waitcnt vmcnt(8) lgkmcnt(0)
s_barrier
v_mfma_f32_16x16x32_bf16 v[128:131], v[16:19], v[48:51], v[128:131]
ds_read_b128 v[32:35], v5 offset:34816
v_mfma_f32_16x16x32_bf16 v[132:135], v[20:23], v[48:51], v[132:135]
ds_read_b128 v[36:39], v5 offset:35840
v_mfma_f32_16x16x32_bf16 v[136:139], v[24:27], v[48:51], v[136:139]
ds_read_b128 v[40:43], v5 offset:36864
s_nop 0
s_add_u32 m0, s27, 0
v_mfma_f32_16x16x32_bf16 v[140:143], v[28:31], v[48:51], v[140:143]
ds_read_b128 v[44:47], v5 offset:37888
buffer_load_dwordx4 v2, s[16:19], s24 offen sc1 lds
v_mfma_f32_16x16x32_bf16 v[144:147], v[16:19], v[52:55], v[144:147]
ds_read_b64_tr_b16 v[76:77], v7 offset:37888
v_mfma_f32_16x16x32_bf16 v[148:151], v[20:23], v[52:55], v[148:151]
ds_read_b64_tr_b16 v[78:79], v7 offset:38144
v_mfma_f32_16x16x32_bf16 v[152:155], v[24:27], v[52:55], v[152:155]
ds_read_b64_tr_b16 v[80:81], v8 offset:37888
v_mfma_f32_16x16x32_bf16 v[156:159], v[28:31], v[52:55], v[156:159]
ds_read_b64_tr_b16 v[82:83], v8 offset:38144
v_mfma_f32_16x16x32_bf16 v[160:163], v[16:19], v[56:59], v[160:163]
ds_read_b64_tr_b16 v[84:85], v7 offset:39936
buffer_load_dwordx4 v2, s[16:19], s24 offen offset:1024 sc1 lds
s_add_u32 s24, s24, 8192
v_mfma_f32_16x16x32_bf16 v[164:167], v[20:23], v[56:59], v[164:167]
ds_read_b64_tr_b16 v[86:87], v7 offset:40192
v_mfma_f32_16x16x32_bf16 v[168:171], v[24:27], v[56:59], v[168:171]
ds_read_b64_tr_b16 v[88:89], v8 offset:39936
v_mfma_f32_16x16x32_bf16 v[172:175], v[28:31], v[56:59], v[172:175]
ds_read_b64_tr_b16 v[90:91], v8 offset:40192
v_mfma_f32_16x16x32_bf16 v[176:179], v[16:19], v[60:63], v[176:179]
ds_read_b64_tr_b16 v[92:93], v7 offset:46080
s_add_u32 m0, s28, 10240
v_mfma_f32_16x16x32_bf16 v[180:183], v[20:23], v[60:63], v[180:183]
ds_read_b64_tr_b16 v[94:95], v7 offset:46336
buffer_load_dwordx4 v3, s[8:11], s25 offen offset:0 lds
v_mfma_f32_16x16x32_bf16 v[184:187], v[24:27], v[60:63], v[184:187]
ds_read_b64_tr_b16 v[96:97], v8 offset:40960
v_mfma_f32_16x16x32_bf16 v[188:191], v[28:31], v[60:63], v[188:191]
ds_read_b64_tr_b16 v[98:99], v8 offset:41216
v_mfma_f32_16x16x32_bf16 v[192:195], v[16:19], v[64:67], v[192:195]
ds_read_b64_tr_b16 v[100:101], v7 offset:41984
v_mfma_f32_16x16x32_bf16 v[196:199], v[20:23], v[64:67], v[196:199]
ds_read_b64_tr_b16 v[102:103], v7 offset:42240
s_add_u32 m0, s28, 11200
v_mfma_f32_16x16x32_bf16 v[200:203], v[24:27], v[64:67], v[200:203]
buffer_load_dwordx4 v3, s[8:11], s25 offen offset:64 lds
s_add_u32 s25, s25, 196608
v_mfma_f32_16x16x32_bf16 v[204:207], v[28:31], v[64:67], v[204:207]
v_mfma_f32_16x16x32_bf16 v[208:211], v[68:71], v[16:19], v[208:211]
v_mfma_f32_16x16x32_bf16 v[212:215], v[68:71], v[20:23], v[212:215]
v_mfma_f32_16x16x32_bf16 v[216:219], v[68:71], v[24:27], v[216:219]
v_mfma_f32_16x16x32_bf16 v[220:223], v[68:71], v[28:31], v[220:223]
v_mfma_f32_16x16x32_bf16 v[224:227], v[72:75], v[16:19], v[224:227]
v_mfma_f32_16x16x32_bf16 v[228:231], v[72:75], v[20:23], v[228:231]
v_mfma_f32_16x16x32_bf16 v[232:235], v[72:75], v[24:27], v[232:235]
v_mfma_f32_16x16x32_bf16 v[236:239], v[72:75], v[28:31], v[236:239]
s_waitcnt vmcnt(8) lgkmcnt(0)
s_barrier
v_mfma_f32_16x16x32_bf16 v[128:131], v[32:35], v[76:79], v[128:131]
ds_read_b128 v[16:19], v6 offset:0
v_mfma_f32_16x16x32_bf16 v[132:135], v[36:39], v[76:79], v[132:135]
ds_read_b128 v[20:23], v6 offset:1024
v_mfma_f32_16x16x32_bf16 v[136:139], v[40:43], v[76:79], v[136:139]
ds_read_b128 v[24:27], v6 offset:2048
s_add_u32 m0, s27, 34816
v_mfma_f32_16x16x32_bf16 v[140:143], v[44:47], v[76:79], v[140:143]
ds_read_b128 v[28:31], v6 offset:3072
buffer_load_dwordx4 v2, s[16:19], s24 offen sc1 lds
v_mfma_f32_16x16x32_bf16 v[144:147], v[32:35], v[80:83], v[144:147]
ds_read_b64_tr_b16 v[48:49], v9 offset:3072
v_mfma_f32_16x16x32_bf16 v[148:151], v[36:39], v[80:83], v[148:151]
ds_read_b64_tr_b16 v[50:51], v9 offset:3328
v_mfma_f32_16x16x32_bf16 v[152:155], v[40:43], v[80:83], v[152:155]
ds_read_b64_tr_b16 v[52:53], v10 offset:3072
v_mfma_f32_16x16x32_bf16 v[156:159], v[44:47], v[80:83], v[156:159]
ds_read_b64_tr_b16 v[54:55], v10 offset:3328
v_mfma_f32_16x16x32_bf16 v[160:163], v[32:35], v[84:87], v[160:163]
ds_read_b64_tr_b16 v[56:57], v9 offset:5120
buffer_load_dwordx4 v2, s[16:19], s24 offen offset:1024 sc1 lds
s_add_u32 s24, s24, 8192
v_mfma_f32_16x16x32_bf16 v[164:167], v[36:39], v[84:87], v[164:167]
ds_read_b64_tr_b16 v[58:59], v9 offset:5376
v_mfma_f32_16x16x32_bf16 v[168:171], v[40:43], v[84:87], v[168:171]
ds_read_b64_tr_b16 v[60:61], v10 offset:5120
v_mfma_f32_16x16x32_bf16 v[172:175], v[44:47], v[84:87], v[172:175]
ds_read_b64_tr_b16 v[62:63], v10 offset:5376
v_mfma_f32_16x16x32_bf16 v[176:179], v[32:35], v[88:91], v[176:179]
ds_read_b64_tr_b16 v[64:65], v9 offset:11264
s_add_u32 m0, s28, 45056
v_mfma_f32_16x16x32_bf16 v[180:183], v[36:39], v[88:91], v[180:183]
ds_read_b64_tr_b16 v[66:67], v9 offset:11520
buffer_load_dwordx4 v3, s[8:11], s25 offen offset:0 lds
v_mfma_f32_16x16x32_bf16 v[184:187], v[40:43], v[88:91], v[184:187]
ds_read_b64_tr_b16 v[68:69], v10 offset:6144
v_mfma_f32_16x16x32_bf16 v[188:191], v[44:47], v[88:91], v[188:191]
ds_read_b64_tr_b16 v[70:71], v10 offset:6400
v_mfma_f32_16x16x32_bf16 v[192:195], v[32:35], v[92:95], v[192:195]
ds_read_b64_tr_b16 v[72:73], v9 offset:7168
v_mfma_f32_16x16x32_bf16 v[196:199], v[36:39], v[92:95], v[196:199]
ds_read_b64_tr_b16 v[74:75], v9 offset:7424
s_add_u32 m0, s28, 46016
v_mfma_f32_16x16x32_bf16 v[200:203], v[40:43], v[92:95], v[200:203]
buffer_load_dwordx4 v3, s[8:11], s25 offen offset:64 lds
s_add_u32 s25, s25, 196608
v_mfma_f32_16x16x32_bf16 v[204:207], v[44:47], v[92:95], v[204:207]
v_mfma_f32_16x16x32_bf16 v[208:211], v[96:99], v[32:35], v[208:211]
v_mfma_f32_16x16x32_bf16 v[212:215], v[96:99], v[36:39], v[212:215]
v_mfma_f32_16x16x32_bf16 v[216:219], v[96:99], v[40:43], v[216:219]
v_mfma_f32_16x16x32_bf16 v[220:223], v[96:99], v[44:47], v[220:223]
v_mfma_f32_16x16x32_bf16 v[224:227], v[100:103], v[32:35], v[224:227]
v_mfma_f32_16x16x32_bf16 v[228:231], v[100:103], v[36:39], v[228:231]
v_mfma_f32_16x16x32_bf16 v[232:235], v[100:103], v[40:43], v[232:235]
v_mfma_f32_16x16x32_bf16 v[236:239], v[100:103], v[44:47], v[236:239]
s_waitcnt vmcnt(8) lgkmcnt(0)
s_barrier
v_mfma_f32_16x16x32_bf16 v[128:131], v[16:19], v[48:51], v[128:131]
ds_read_b128 v[32:35], v6 offset:34816
v_mfma_f32_16x16x32_bf16 v[132:135], v[20:23], v[48:51], v[132:135]
ds_read_b128 v[36:39], v6 offset:35840
v_mfma_f32_16x16x32_bf16 v[136:139], v[24:27], v[48:51], v[136:139]
ds_read_b128 v[40:43], v6 offset:36864
s_add_u32 m0, s27, 69632
v_mfma_f32_16x16x32_bf16 v[140:143], v[28:31], v[48:51], v[140:143]
ds_read_b128 v[44:47], v6 offset:37888
buffer_load_dwordx4 v2, s[16:19], s24 offen sc1 lds
v_mfma_f32_16x16x32_bf16 v[144:147], v[16:19], v[52:55], v[144:147]
ds_read_b64_tr_b16 v[76:77], v9 offset:37888
v_mfma_f32_16x16x32_bf16 v[148:151], v[20:23], v[52:55], v[148:151]
ds_read_b64_tr_b16 v[78:79], v9 offset:38144
v_mfma_f32_16x16x32_bf16 v[152:155], v[24:27], v[52:55], v[152:155]
ds_read_b64_tr_b16 v[80:81], v10 offset:37888
v_mfma_f32_16x16x32_bf16 v[156:159], v[28:31], v[52:55], v[156:159]
ds_read_b64_tr_b16 v[82:83], v10 offset:38144
v_mfma_f32_16x16x32_bf16 v[160:163], v[16:19], v[56:59], v[160:163]
ds_read_b64_tr_b16 v[84:85], v9 offset:39936
buffer_load_dwordx4 v2, s[16:19], s24 offen offset:1024 sc1 lds
s_add_u32 s24, s24, 8192
v_mfma_f32_16x16x32_bf16 v[164:167], v[20:23], v[56:59], v[164:167]
ds_read_b64_tr_b16 v[86:87], v9 offset:40192
v_mfma_f32_16x16x32_bf16 v[168:171], v[24:27], v[56:59], v[168:171]
ds_read_b64_tr_b16 v[88:89], v10 offset:39936
v_mfma_f32_16x16x32_bf16 v[172:175], v[28:31], v[56:59], v[172:175]
ds_read_b64_tr_b16 v[90:91], v10 offset:40192
v_mfma_f32_16x16x32_bf16 v[176:179], v[16:19], v[60:63], v[176:179]
ds_read_b64_tr_b16 v[92:93], v9 offset:46080
s_add_u32 m0, s28, 79872
v_mfma_f32_16x16x32_bf16 v[180:183], v[20:23], v[60:63], v[180:183]
ds_read_b64_tr_b16 v[94:95], v9 offset:46336
buffer_load_dwordx4 v3, s[8:11], s25 offen offset:0 lds
v_mfma_f32_16x16x32_bf16 v[184:187], v[24:27], v[60:63], v[184:187]
ds_read_b64_tr_b16 v[96:97], v10 offset:40960
v_mfma_f32_16x16x32_bf16 v[188:191], v[28:31], v[60:63], v[188:191]
ds_read_b64_tr_b16 v[98:99], v10 offset:41216
v_mfma_f32_16x16x32_bf16 v[192:195], v[16:19], v[64:67], v[192:195]
ds_read_b64_tr_b16 v[100:101], v9 offset:41984
v_mfma_f32_16x16x32_bf16 v[196:199], v[20:23], v[64:67], v[196:199]
ds_read_b64_tr_b16 v[102:103], v9 offset:42240
s_add_u32 m0, s28, 80832
v_mfma_f32_16x16x32_bf16 v[200:203], v[24:27], v[64:67], v[200:203]
buffer_load_dwordx4 v3, s[8:11], s25 offen offset:64 lds
s_add_u32 s25, s25, 196608
v_mfma_f32_16x16x32_bf16 v[204:207], v[28:31], v[64:67], v[204:207]
v_mfma_f32_16x16x32_bf16 v[208:211], v[68:71], v[16:19], v[208:211]
v_mfma_f32_16x16x32_bf16 v[212:215], v[68:71], v[20:23], v[212:215]
v_mfma_f32_16x16x32_bf16 v[216:219], v[68:71], v[24:27], v[216:219]
v_mfma_f32_16x16x32_bf16 v[220:223], v[68:71], v[28:31], v[220:223]
v_mfma_f32_16x16x32_bf16 v[224:227], v[72:75], v[16:19], v[224:227]
v_mfma_f32_16x16x32_bf16 v[228:231], v[72:75], v[20:23], v[228:231]
v_mfma_f32_16x16x32_bf16 v[232:235], v[72:75], v[24:27], v[232:235]
v_mfma_f32_16x16x32_bf16 v[236:239], v[72:75], v[28:31], v[236:239]
s_waitcnt vmcnt(8) lgkmcnt(0)
s_barrier
v_mfma_f32_16x16x32_bf16 v[128:131], v[32:35], v[76:79], v[128:131]
ds_read_b128 v[16:19], v5 offset:0
v_mfma_f32_16x16x32_bf16 v[132:135], v[36:39], v[76:79], v[132:135]
ds_read_b128 v[20:23], v5 offset:1024
v_mfma_f32_16x16x32_bf16 v[136:139], v[40:43], v[76:79], v[136:139]
ds_read_b128 v[24:27], v5 offset:2048
s_add_u32 m0, s27, 104448
v_mfma_f32_16x16x32_bf16 v[140:143], v[44:47], v[76:79], v[140:143]
ds_read_b128 v[28:31], v5 offset:3072
buffer_load_dwordx4 v2, s[16:19], s24 offen sc1 lds
v_mfma_f32_16x16x32_bf16 v[144:147], v[32:35], v[80:83], v[144:147]
ds_read_b64_tr_b16 v[48:49], v7 offset:3072
v_mfma_f32_16x16x32_bf16 v[148:151], v[36:39], v[80:83], v[148:151]
ds_read_b64_tr_b16 v[50:51], v7 offset:3328
v_mfma_f32_16x16x32_bf16 v[152:155], v[40:43], v[80:83], v[152:155]
ds_read_b64_tr_b16 v[52:53], v8 offset:3072
v_mfma_f32_16x16x32_bf16 v[156:159], v[44:47], v[80:83], v[156:159]
ds_read_b64_tr_b16 v[54:55], v8 offset:3328
v_mfma_f32_16x16x32_bf16 v[160:163], v[32:35], v[84:87], v[160:163]
ds_read_b64_tr_b16 v[56:57], v7 offset:5120
buffer_load_dwordx4 v2, s[16:19], s24 offen offset:1024 sc1 lds
s_add_u32 s24, s24, 8192
v_mfma_f32_16x16x32_bf16 v[164:167], v[36:39], v[84:87], v[164:167]
ds_read_b64_tr_b16 v[58:59], v7 offset:5376
v_mfma_f32_16x16x32_bf16 v[168:171], v[40:43], v[84:87], v[168:171]
ds_read_b64_tr_b16 v[60:61], v8 offset:5120
v_mfma_f32_16x16x32_bf16 v[172:175], v[44:47], v[84:87], v[172:175]
ds_read_b64_tr_b16 v[62:63], v8 offset:5376
v_mfma_f32_16x16x32_bf16 v[176:179], v[32:35], v[88:91], v[176:179]
ds_read_b64_tr_b16 v[64:65], v7 offset:11264
s_add_u32 m0, s28, 114688
v_mfma_f32_16x16x32_bf16 v[180:183], v[36:39], v[88:91], v[180:183]
ds_read_b64_tr_b16 v[66:67], v7 offset:11520
buffer_load_dwordx4 v3, s[8:11], s25 offen offset:0 lds
v_mfma_f32_16x16x32_bf16 v[184:187], v[40:43], v[88:91], v[184:187]
ds_read_b64_tr_b16 v[68:69], v8 offset:6144
v_mfma_f32_16x16x32_bf16 v[188:191], v[44:47], v[88:91], v[188:191]
ds_read_b64_tr_b16 v[70:71], v8 offset:6400
v_mfma_f32_16x16x32_bf16 v[192:195], v[32:35], v[92:95], v[192:195]
ds_read_b64_tr_b16 v[72:73], v7 offset:7168
v_mfma_f32_16x16x32_bf16 v[196:199], v[36:39], v[92:95], v[196:199]
ds_read_b64_tr_b16 v[74:75], v7 offset:7424
s_add_u32 m0, s28, 115648
v_mfma_f32_16x16x32_bf16 v[200:203], v[40:43], v[92:95], v[200:203]
buffer_load_dwordx4 v3, s[8:11], s25 offen offset:64 lds
s_add_u32 s25, s25, 196608
v_mfma_f32_16x16x32_bf16 v[204:207], v[44:47], v[92:95], v[204:207]
v_mfma_f32_16x16x32_bf16 v[208:211], v[96:99], v[32:35], v[208:211]
v_mfma_f32_16x16x32_bf16 v[212:215], v[96:99], v[36:39], v[212:215]
v_mfma_f32_16x16x32_bf16 v[216:219], v[96:99], v[40:43], v[216:219]
v_mfma_f32_16x16x32_bf16 v[220:223], v[96:99], v[44:47], v[220:223]
v_mfma_f32_16x16x32_bf16 v[224:227], v[100:103], v[32:35], v[224:227]
v_mfma_f32_16x16x32_bf16 v[228:231], v[100:103], v[36:39], v[228:231]
v_mfma_f32_16x16x32_bf16 v[232:235], v[100:103], v[40:43], v[232:235]
v_mfma_f32_16x16x32_bf16 v[236:239], v[100:103], v[44:47], v[236:239]
s_nop 0
s_sub_u32 s29, s29, 1
s_cmp_lg_u32 s29, 0
s_cbranch_scc1 L_loop1_1
s_waitcnt vmcnt(8) lgkmcnt(0)
s_barrier
v_mfma_f32_16x16x32_bf16 v[128:131], v[16:19], v[48:51], v[128:131]
ds_read_b128 v[32:35], v5 offset:34816
v_mfma_f32_16x16x32_bf16 v[132:135], v[20:23], v[48:51], v[132:135]
ds_read_b128 v[36:39], v5 offset:35840
v_mfma_f32_16x16x32_bf16 v[136:139], v[24:27], v[48:51], v[136:139]
ds_read_b128 v[40:43], v5 offset:36864
v_mfma_f32_16x16x32_bf16 v[140:143], v[28:31], v[48:51], v[140:143]
ds_read_b128 v[44:47], v5 offset:37888
v_mfma_f32_16x16x32_bf16 v[144:147], v[16:19], v[52:55], v[144:147]
ds_read_b64_tr_b16 v[76:77], v7 offset:37888
v_mfma_f32_16x16x32_bf16 v[148:151], v[20:23], v[52:55], v[148:151]
ds_read_b64_tr_b16 v[78:79], v7 offset:38144
v_mfma_f32_16x16x32_bf16 v[152:155], v[24:27], v[52:55], v[152:155]
ds_read_b64_tr_b16 v[80:81], v8 offset:37888
v_mfma_f32_16x16x32_bf16 v[156:159], v[28:31], v[52:55], v[156:159]
ds_read_b64_tr_b16 v[82:83], v8 offset:38144
v_mfma_f32_16x16x32_bf16 v[160:163], v[16:19], v[56:59], v[160:163]
ds_read_b64_tr_b16 v[84:85], v7 offset:39936
v_mfma_f32_16x16x32_bf16 v[164:167], v[20:23], v[56:59], v[164:167]
ds_read_b64_tr_b16 v[86:87], v7 offset:40192
v_mfma_f32_16x16x32_bf16 v[168:171], v[24:27], v[56:59], v[168:171]
ds_read_b64_tr_b16 v[88:89], v8 offset:39936
v_mfma_f32_16x16x32_bf16 v[172:175], v[28:31], v[56:59], v[172:175]
ds_read_b64_tr_b16 v[90:91], v8 offset:40192
v_mfma_f32_16x16x32_bf16 v[176:179], v[16:19], v[60:63], v[176:179]
ds_read_b64_tr_b16 v[92:93], v7 offset:46080
v_mfma_f32_16x16x32_bf16 v[180:183], v[20:23], v[60:63], v[180:183]
ds_read_b64_tr_b16 v[94:95], v7 offset:46336
v_mfma_f32_16x16x32_bf16 v[184:187], v[24:27], v[60:63], v[184:187]
ds_read_b64_tr_b16 v[96:97], v8 offset:40960
v_mfma_f32_16x16x32_bf16 v[188:191], v[28:31], v[60:63], v[188:191]
ds_read_b64_tr_b16 v[98:99], v8 offset:41216
v_mfma_f32_16x16x32_bf16 v[192:195], v[16:19], v[64:67], v[192:195]
ds_read_b64_tr_b16 v[100:101], v7 offset:41984
v_mfma_f32_16x16x32_bf16 v[196:199], v[20:23], v[64:67], v[196:199]
ds_read_b64_tr_b16 v[102:103], v7 offset:42240
v_mfma_f32_16x16x32_bf16 v[200:203], v[24:27], v[64:67], v[200:203]
v_mfma_f32_16x16x32_bf16 v[204:207], v[28:31], v[64:67], v[204:207]
v_mfma_f32_16x16x32_bf16 v[208:211], v[68:71], v[16:19], v[208:211]
v_mfma_f32_16x16x32_bf16 v[212:215], v[68:71], v[20:23], v[212:215]
v_mfma_f32_16x16x32_bf16 v[216:219], v[68:71], v[24:27], v[216:219]
v_mfma_f32_16x16x32_bf16 v[220:223], v[68:71], v[28:31], v[220:223]
v_mfma_f32_16x16x32_bf16 v[224:227], v[72:75], v[16:19], v[224:227]
v_mfma_f32_16x16x32_bf16 v[228:231], v[72:75], v[20:23], v[228:231]
v_mfma_f32_16x16x32_bf16 v[232:235], v[72:75], v[24:27], v[232:235]
v_mfma_f32_16x16x32_bf16 v[236:239], v[72:75], v[28:31], v[236:239]
s_waitcnt vmcnt(4) lgkmcnt(0)
s_barrier
v_mfma_f32_16x16x32_bf16 v[128:131], v[32:35], v[76:79], v[128:131]
ds_read_b128 v[16:19], v6 offset:0
v_mfma_f32_16x16x32_bf16 v[132:135], v[36:39], v[76:79], v[132:135]
ds_read_b128 v[20:23], v6 offset:1024
v_mfma_f32_16x16x32_bf16 v[136:139], v[40:43], v[76:79], v[136:139]
ds_read_b128 v[24:27], v6 offset:2048
v_mfma_f32_16x16x32_bf16 v[140:143], v[44:47], v[76:79], v[140:143]
ds_read_b128 v[28:31], v6 offset:3072
v_mfma_f32_16x16x32_bf16 v[144:147], v[32:35], v[80:83], v[144:147]
ds_read_b64_tr_b16 v[48:49], v9 offset:3072
v_mfma_f32_16x16x32_bf16 v[148:151], v[36:39], v[80:83], v[148:151]
ds_read_b64_tr_b16 v[50:51], v9 offset:3328
v_mfma_f32_16x16x32_bf16 v[152:155], v[40:43], v[80:83], v[152:155]
ds_read_b64_tr_b16 v[52:53], v10 offset:3072
v_mfma_f32_16x16x32_bf16 v[156:159], v[44:47], v[80:83], v[156:159]
ds_read_b64_tr_b16 v[54:55], v10 offset:3328
v_mfma_f32_16x16x32_bf16 v[160:163], v[32:35], v[84:87], v[160:163]
ds_read_b64_tr_b16 v[56:57], v9 offset:5120
v_mfma_f32_16x16x32_bf16 v[164:167], v[36:39], v[84:87], v[164:167]
ds_read_b64_tr_b16 v[58:59], v9 offset:5376
v_mfma_f32_16x16x32_bf16 v[168:171], v[40:43], v[84:87], v[168:171]
ds_read_b64_tr_b16 v[60:61], v10 offset:5120
v_mfma_f32_16x16x32_bf16 v[172:175], v[44:47], v[84:87], v[172:175]
ds_read_b64_tr_b16 v[62:63], v10 offset:5376
v_mfma_f32_16x16x32_bf16 v[176:179], v[32:35], v[88:91], v[176:179]
ds_read_b64_tr_b16 v[64:65], v9 offset:11264
v_mfma_f32_16x16x32_bf16 v[180:183], v[36:39], v[88:91], v[180:183]
ds_read_b64_tr_b16 v[66:67], v9 offset:11520
v_mfma_f32_16x16x32_bf16 v[184:187], v[40:43], v[88:91], v[184:187]
ds_read_b64_tr_b16 v[68:69], v10 offset:6144
v_mfma_f32_16x16x32_bf16 v[188:191], v[44:47], v[88:91], v[188:191]
ds_read_b64_tr_b16 v[70:71], v10 offset:6400
v_mfma_f32_16x16x32_bf16 v[192:195], v[32:35], v[92:95], v[192:195]
ds_read_b64_tr_b16 v[72:73], v9 offset:7168
v_mfma_f32_16x16x32_bf16 v[196:199], v[36:39], v[92:95], v[196:199]
ds_read_b64_tr_b16 v[74:75], v9 offset:7424
v_mfma_f32_16x16x32_bf16 v[200:203], v[40:43], v[92:95], v[200:203]
v_mfma_f32_16x16x32_bf16 v[204:207], v[44:47], v[92:95], v[204:207]
v_mfma_f32_16x16x32_bf16 v[208:211], v[96:99], v[32:35], v[208:211]
v_mfma_f32_16x16x32_bf16 v[212:215], v[96:99], v[36:39], v[212:215]
v_mfma_f32_16x16x32_bf16 v[216:219], v[96:99], v[40:43], v[216:219]
v_mfma_f32_16x16x32_bf16 v[220:223], v[96:99], v[44:47], v[220:223]
v_mfma_f32_16x16x32_bf16 v[224:227], v[100:103], v[32:35], v[224:227]
v_mfma_f32_16x16x32_bf16 v[228:231], v[100:103], v[36:39], v[228:231]
v_mfma_f32_16x16x32_bf16 v[232:235], v[100:103], v[40:43], v[232:235]
v_mfma_f32_16x16x32_bf16 v[236:239], v[100:103], v[44:47], v[236:239]
s_waitcnt vmcnt(0) lgkmcnt(0)
s_barrier
v_mfma_f32_16x16x32_bf16 v[128:131], v[16:19], v[48:51], v[128:131]
ds_read_b128 v[32:35], v6 offset:34816
v_mfma_f32_16x16x32_bf16 v[132:135], v[20:23], v[48:51], v[132:135]
ds_read_b128 v[36:39], v6 offset:35840
v_mfma_f32_16x16x32_bf16 v[136:139], v[24:27], v[48:51], v[136:139]
ds_read_b128 v[40:43], v6 offset:36864
v_mfma_f32_16x16x32_bf16 v[140:143], v[28:31], v[48:51], v[140:143]
ds_read_b128 v[44:47], v6 offset:37888
v_mfma_f32_16x16x32_bf16 v[144:147], v[16:19], v[52:55], v[144:147]
ds_read_b64_tr_b16 v[76:77], v9 offset:37888
v_mfma_f32_16x16x32_bf16 v[148:151], v[20:23], v[52:55], v[148:151]
ds_read_b64_tr_b16 v[78:79], v9 offset:38144
v_mfma_f32_16x16x32_bf16 v[152:155], v[24:27], v[52:55], v[152:155]
ds_read_b64_tr_b16 v[80:81], v10 offset:37888
v_mfma_f32_16x16x32_bf16 v[156:159], v[28:31], v[52:55], v[156:159]
ds_read_b64_tr_b16 v[82:83], v10 offset:38144
v_mfma_f32_16x16x32_bf16 v[160:163], v[16:19], v[56:59], v[160:163]
ds_read_b64_tr_b16 v[84:85], v9 offset:39936
v_mfma_f32_16x16x32_bf16 v[164:167], v[20:23], v[56:59], v[164:167]
ds_read_b64_tr_b16 v[86:87], v9 offset:40192
v_mfma_f32_16x16x32_bf16 v[168:171], v[24:27], v[56:59], v[168:171]
ds_read_b64_tr_b16 v[88:89], v10 offset:39936
v_mfma_f32_16x16x32_bf16 v[172:175], v[28:31], v[56:59], v[172:175]
ds_read_b64_tr_b16 v[90:91], v10 offset:40192
v_mfma_f32_16x16x32_bf16 v[176:179], v[16:19], v[60:63], v[176:179]
ds_read_b64_tr_b16 v[92:93], v9 offset:46080
v_mfma_f32_16x16x32_bf16 v[180:183], v[20:23], v[60:63], v[180:183]
ds_read_b64_tr_b16 v[94:95], v9 offset:46336
v_mfma_f32_16x16x32_bf16 v[184:187], v[24:27], v[60:63], v[184:187]
ds_read_b64_tr_b16 v[96:97], v10 offset:40960
v_mfma_f32_16x16x32_bf16 v[188:191], v[28:31], v[60:63], v[188:191]
ds_read_b64_tr_b16 v[98:99], v10 offset:41216
v_mfma_f32_16x16x32_bf16 v[192:195], v[16:19], v[64:67], v[192:195]
ds_read_b64_tr_b16 v[100:101], v9 offset:41984
v_mfma_f32_16x16x32_bf16 v[196:199], v[20:23], v[64:67], v[196:199]
ds_read_b64_tr_b16 v[102:103], v9 offset:42240
v_mfma_f32_16x16x32_bf16 v[200:203], v[24:27], v[64:67], v[200:203]
v_mfma_f32_16x16x32_bf16 v[204:207], v[28:31], v[64:67], v[204:207]
v_mfma_f32_16x16x32_bf16 v[208:211], v[68:71], v[16:19], v[208:211]
v_mfma_f32_16x16x32_bf16 v[212:215], v[68:71], v[20:23], v[212:215]
v_mfma_f32_16x16x32_bf16 v[216:219], v[68:71], v[24:27], v[216:219]
v_mfma_f32_16x16x32_bf16 v[220:223], v[68:71], v[28:31], v[220:223]
v_mfma_f32_16x16x32_bf16 v[224:227], v[72:75], v[16:19], v[224:227]
v_mfma_f32_16x16x32_bf16 v[228:231], v[72:75], v[20:23], v[228:231]
v_mfma_f32_16x16x32_bf16 v[232:235], v[72:75], v[24:27], v[232:235]
v_mfma_f32_16x16x32_bf16 v[236:239], v[72:75], v[28:31], v[236:239]
s_lshl_b32 s24, s21, 19
s_lshl_b32 s36, s20, 17
s_add_u32 s24, s24, s36
s_lshl_b32 s27, s20, 12
s_waitcnt lgkmcnt(0)
s_barrier
v_mfma_f32_16x16x32_bf16 v[128:131], v[32:35], v[76:79], v[128:131]
s_nop 0
s_add_u32 m0, s27, 0
v_mfma_f32_16x16x32_bf16 v[132:135], v[36:39], v[76:79], v[132:135]
buffer_load_dwordx4 v112, s[56:59], s24 offen offset:0 lds
v_mfma_f32_16x16x32_bf16 v[136:139], v[40:43], v[76:79], v[136:139]
v_mfma_f32_16x16x32_bf16 v[140:143], v[44:47], v[76:79], v[140:143]
buffer_load_dwordx4 v113, s[56:59], s24 offen offset:1024 lds
v_mfma_f32_16x16x32_bf16 v[144:147], v[32:35], v[80:83], v[144:147]
v_mfma_f32_16x16x32_bf16 v[148:151], v[36:39], v[80:83], v[148:151]
buffer_load_dwordx4 v114, s[56:59], s24 offen offset:2048 lds
v_mfma_f32_16x16x32_bf16 v[152:155], v[40:43], v[80:83], v[152:155]
v_mfma_f32_16x16x32_bf16 v[156:159], v[44:47], v[80:83], v[156:159]
buffer_load_dwordx4 v115, s[56:59], s24 offen offset:3072 lds
s_add_u32 s24, s24, 128
v_mfma_f32_16x16x32_bf16 v[160:163], v[32:35], v[84:87], v[160:163]
s_add_u32 m0, s27, 30720
v_mfma_f32_16x16x32_bf16 v[164:167], v[36:39], v[84:87], v[164:167]
buffer_load_dwordx4 v112, s[56:59], s24 offen offset:0 lds
v_mfma_f32_16x16x32_bf16 v[168:171], v[40:43], v[84:87], v[168:171]
v_mfma_f32_16x16x32_bf16 v[172:175], v[44:47], v[84:87], v[172:175]
buffer_load_dwordx4 v113, s[56:59], s24 offen offset:1024 lds
v_mfma_f32_16x16x32_bf16 v[176:179], v[32:35], v[88:91], v[176:179]
v_mfma_f32_16x16x32_bf16 v[180:183], v[36:39], v[88:91], v[180:183]
buffer_load_dwordx4 v114, s[56:59], s24 offen offset:2048 lds
v_mfma_f32_16x16x32_bf16 v[184:187], v[40:43], v[88:91], v[184:187]
v_mfma_f32_16x16x32_bf16 v[188:191], v[44:47], v[88:91], v[188:191]
buffer_load_dwordx4 v115, s[56:59], s24 offen offset:3072 lds
s_add_u32 s24, s24, 128
v_mfma_f32_16x16x32_bf16 v[192:195], v[32:35], v[92:95], v[192:195]
s_add_u32 m0, s27, 61440
v_mfma_f32_16x16x32_bf16 v[196:199], v[36:39], v[92:95], v[196:199]
buffer_load_dwordx4 v112, s[56:59], s24 offen offset:0 lds
v_mfma_f32_16x16x32_bf16 v[200:203], v[40:43], v[92:95], v[200:203]
v_mfma_f32_16x16x32_bf16 v[204:207], v[44:47], v[92:95], v[204:207]
buffer_load_dwordx4 v113, s[56:59], s24 offen offset:1024 lds
v_mfma_f32_16x16x32_bf16 v[208:211], v[96:99], v[32:35], v[208:211]
v_mfma_f32_16x16x32_bf16 v[212:215], v[96:99], v[36:39], v[212:215]
buffer_load_dwordx4 v114, s[56:59], s24 offen offset:2048 lds
v_mfma_f32_16x16x32_bf16 v[216:219], v[96:99], v[40:43], v[216:219]
v_mfma_f32_16x16x32_bf16 v[220:223], v[96:99], v[44:47], v[220:223]
buffer_load_dwordx4 v115, s[56:59], s24 offen offset:3072 lds
s_add_u32 s24, s24, 128
v_mfma_f32_16x16x32_bf16 v[224:227], v[100:103], v[32:35], v[224:227]
s_add_u32 m0, s27, 92160
v_mfma_f32_16x16x32_bf16 v[228:231], v[100:103], v[36:39], v[228:231]
buffer_load_dwordx4 v112, s[56:59], s24 offen offset:0 lds
v_mfma_f32_16x16x32_bf16 v[232:235], v[100:103], v[40:43], v[232:235]
v_mfma_f32_16x16x32_bf16 v[236:239], v[100:103], v[44:47], v[236:239]
buffer_load_dwordx4 v113, s[56:59], s24 offen offset:1024 lds
buffer_load_dwordx4 v114, s[56:59], s24 offen offset:2048 lds
buffer_load_dwordx4 v115, s[56:59], s24 offen offset:3072 lds
s_add_u32 s24, s24, 128
s_mov_b32 s42, 0xbdd2d3e8
s_mov_b32 s43, 0xbdd2d3e8
s_mov_b32 s44, 0x3f800000
s_mov_b32 s45, 0x3f800000
s_mov_b32 s46, 0x3fb8aa3b
s_mov_b32 s47, 0x3fb8aa3b
s_mov_b32 s48, 0x358637bd
s_mov_b32 s49, 0x358637bd
v_mov_b32 v12, 0xc0135761
v_mov_b32 v13, 0xc0135761
v_and_b32_e64 v1, 63, v0
v_bfe_u32 v2, v1, 3, 1
v_lshlrev_b32_e64 v2, 9, v2
v_bfe_u32 v3, v1, 2, 1
v_lshl_add_u32 v2, v3, 7, v2
v_lshrrev_b32 v3, 4, v1
v_lshlrev_b32_e64 v5, 5, v3
s_lshl_b32 s30, s23, 8
s_add_u32 s30, s30, 151552
v_add_u32 v5, s30, v5
v_add_u32_e64 v2, v2, v5
s_lshl_b32 s30, s23, 11
s_add_u32 s30, s30, 122880
v_add_u32_e64 v6, s30, v11
v_pk_mul_f32 v[104:105], v[192:193], v[192:193]
v_pk_mul_f32 v[106:107], v[194:195], v[194:195]
v_pk_mul_f32 v[108:109], v[196:197], v[196:197]
v_pk_mul_f32 v[110:111], v[198:199], v[198:199]
v_pk_fma_f32 v[104:105], v[104:105], s[42:43], v[12:13]
v_pk_fma_f32 v[106:107], v[106:107], s[42:43], v[12:13]
v_pk_fma_f32 v[108:109], v[108:109], s[42:43], v[12:13]
v_pk_fma_f32 v[110:111], v[110:111], s[42:43], v[12:13]
v_pk_mul_f32 v[104:105], v[104:105], v[192:193]
v_pk_mul_f32 v[106:107], v[106:107], v[194:195]
v_pk_mul_f32 v[108:109], v[108:109], v[196:197]
v_pk_mul_f32 v[110:111], v[110:111], v[198:199]
v_exp_f32 v104, v104
v_exp_f32 v105, v105
v_exp_f32 v106, v106
v_exp_f32 v107, v107
v_exp_f32 v108, v108
v_exp_f32 v109, v109
v_exp_f32 v110, v110
v_exp_f32 v111, v111
v_pk_add_f32 v[104:105], v[104:105], s[44:45]
v_pk_add_f32 v[106:107], v[106:107], s[44:45]
v_pk_add_f32 v[108:109], v[108:109], s[44:45]
v_pk_add_f32 v[110:111], v[110:111], s[44:45]
v_rcp_f32 v104, v104
v_rcp_f32 v105, v105
v_rcp_f32 v106, v106
v_rcp_f32 v107, v107
v_rcp_f32 v108, v108
v_rcp_f32 v109, v109
v_rcp_f32 v110, v110
v_rcp_f32 v111, v111
v_pk_mul_f32 v[192:193], v[192:193], v[104:105]
v_pk_mul_f32 v[194:195], v[194:195], v[106:107]
v_pk_mul_f32 v[196:197], v[196:197], v[108:109]
v_pk_mul_f32 v[198:199], v[198:199], v[110:111]
v_pk_mul_f32 v[32:33], v[192:193], v[192:193]
v_pk_mul_f32 v[34:35], v[194:195], v[194:195]
v_pk_mul_f32 v[36:37], v[196:197], v[196:197]
v_pk_mul_f32 v[38:39], v[198:199], v[198:199]
v_pk_mul_f32 v[104:105], v[200:201], v[200:201]
v_pk_mul_f32 v[106:107], v[202:203], v[202:203]
v_pk_mul_f32 v[108:109], v[204:205], v[204:205]
v_pk_mul_f32 v[110:111], v[206:207], v[206:207]
v_pk_fma_f32 v[104:105], v[104:105], s[42:43], v[12:13]
v_pk_fma_f32 v[106:107], v[106:107], s[42:43], v[12:13]
v_pk_fma_f32 v[108:109], v[108:109], s[42:43], v[12:13]
v_pk_fma_f32 v[110:111], v[110:111], s[42:43], v[12:13]
v_pk_mul_f32 v[104:105], v[104:105], v[200:201]
v_pk_mul_f32 v[106:107], v[106:107], v[202:203]
v_pk_mul_f32 v[108:109], v[108:109], v[204:205]
v_pk_mul_f32 v[110:111], v[110:111], v[206:207]
v_exp_f32 v104, v104
v_exp_f32 v105, v105
v_exp_f32 v106, v106
v_exp_f32 v107, v107
v_exp_f32 v108, v108
v_exp_f32 v109, v109
v_exp_f32 v110, v110
v_exp_f32 v111, v111
v_pk_add_f32 v[104:105], v[104:105], s[44:45]
v_pk_add_f32 v[106:107], v[106:107], s[44:45]
v_pk_add_f32 v[108:109], v[108:109], s[44:45]
v_pk_add_f32 v[110:111], v[110:111], s[44:45]
v_rcp_f32 v104, v104
v_rcp_f32 v105, v105
v_rcp_f32 v106, v106
v_rcp_f32 v107, v107
v_rcp_f32 v108, v108
v_rcp_f32 v109, v109
v_rcp_f32 v110, v110
v_rcp_f32 v111, v111
v_pk_mul_f32 v[200:201], v[200:201], v[104:105]
v_pk_mul_f32 v[202:203], v[202:203], v[106:107]
v_pk_mul_f32 v[204:205], v[204:205], v[108:109]
v_pk_mul_f32 v[206:207], v[206:207], v[110:111]
v_pk_mul_f32 v[40:41], v[200:201], v[200:201]
v_pk_mul_f32 v[42:43], v[202:203], v[202:203]
v_pk_mul_f32 v[44:45], v[204:205], v[204:205]
v_pk_mul_f32 v[46:47], v[206:207], v[206:207]
s_nop 0
s_nop 1
v_add_f32_dpp v16, v192, v192 row_ror:8 row_mask:0xf bank_mask:0x3
v_add_f32_dpp v17, v193, v193 row_ror:8 row_mask:0xf bank_mask:0x3
v_add_f32_dpp v18, v194, v194 row_ror:8 row_mask:0xf bank_mask:0x3
v_add_f32_dpp v19, v195, v195 row_ror:8 row_mask:0xf bank_mask:0x3
v_add_f32_dpp v20, v196, v196 row_ror:8 row_mask:0xf bank_mask:0x3
v_add_f32_dpp v21, v197, v197 row_ror:8 row_mask:0xf bank_mask:0x3
v_add_f32_dpp v22, v198, v198 row_ror:8 row_mask:0xf bank_mask:0x3
v_add_f32_dpp v23, v199, v199 row_ror:8 row_mask:0xf bank_mask:0x3
v_add_f32_dpp v24, v200, v200 row_ror:8 row_mask:0xf bank_mask:0x3
v_add_f32_dpp v25, v201, v201 row_ror:8 row_mask:0xf bank_mask:0x3
v_add_f32_dpp v26, v202, v202 row_ror:8 row_mask:0xf bank_mask:0x3
v_add_f32_dpp v27, v203, v203 row_ror:8 row_mask:0xf bank_mask:0x3
v_add_f32_dpp v28, v204, v204 row_ror:8 row_mask:0xf bank_mask:0x3
v_add_f32_dpp v29, v205, v205 row_ror:8 row_mask:0xf bank_mask:0x3
v_add_f32_dpp v30, v206, v206 row_ror:8 row_mask:0xf bank_mask:0x3
v_add_f32_dpp v31, v207, v207 row_ror:8 row_mask:0xf bank_mask:0x3
v_add_f32_dpp v16, v32, v32 row_ror:8 row_mask:0xf bank_mask:0xc
v_add_f32_dpp v17, v33, v33 row_ror:8 row_mask:0xf bank_mask:0xc
v_add_f32_dpp v18, v34, v34 row_ror:8 row_mask:0xf bank_mask:0xc
v_add_f32_dpp v19, v35, v35 row_ror:8 row_mask:0xf bank_mask:0xc
v_add_f32_dpp v20, v36, v36 row_ror:8 row_mask:0xf bank_mask:0xc
v_add_f32_dpp v21, v37, v37 row_ror:8 row_mask:0xf bank_mask:0xc
v_add_f32_dpp v22, v38, v38 row_ror:8 row_mask:0xf bank_mask:0xc
v_add_f32_dpp v23, v39, v39 row_ror:8 row_mask:0xf bank_mask:0xc
v_add_f32_dpp v24, v40, v40 row_ror:8 row_mask:0xf bank_mask:0xc
v_add_f32_dpp v25, v41, v41 row_ror:8 row_mask:0xf bank_mask:0xc
v_add_f32_dpp v26, v42, v42 row_ror:8 row_mask:0xf bank_mask:0xc
v_add_f32_dpp v27, v43, v43 row_ror:8 row_mask:0xf bank_mask:0xc
v_add_f32_dpp v28, v44, v44 row_ror:8 row_mask:0xf bank_mask:0xc
v_add_f32_dpp v29, v45, v45 row_ror:8 row_mask:0xf bank_mask:0xc
v_add_f32_dpp v30, v46, v46 row_ror:8 row_mask:0xf bank_mask:0xc
v_add_f32_dpp v31, v47, v47 row_ror:8 row_mask:0xf bank_mask:0xc
v_add_f32_dpp v16, v16, v16 row_shl:4 row_mask:0xf bank_mask:0x5
v_add_f32_dpp v17, v17, v17 row_shl:4 row_mask:0xf bank_mask:0x5
v_add_f32_dpp v18, v18, v18 row_shl:4 row_mask:0xf bank_mask:0x5
v_add_f32_dpp v19, v19, v19 row_shl:4 row_mask:0xf bank_mask:0x5
v_add_f32_dpp v20, v20, v20 row_shl:4 row_mask:0xf bank_mask:0x5
v_add_f32_dpp v21, v21, v21 row_shl:4 row_mask:0xf bank_mask:0x5
v_add_f32_dpp v22, v22, v22 row_shl:4 row_mask:0xf bank_mask:0x5
v_add_f32_dpp v23, v23, v23 row_shl:4 row_mask:0xf bank_mask:0x5
v_add_f32_dpp v16, v24, v24 row_shr:4 row_mask:0xf bank_mask:0xa
v_add_f32_dpp v17, v25, v25 row_shr:4 row_mask:0xf bank_mask:0xa
v_add_f32_dpp v18, v26, v26 row_shr:4 row_mask:0xf bank_mask:0xa
v_add_f32_dpp v19, v27, v27 row_shr:4 row_mask:0xf bank_mask:0xa
v_add_f32_dpp v20, v28, v28 row_shr:4 row_mask:0xf bank_mask:0xa
v_add_f32_dpp v21, v29, v29 row_shr:4 row_mask:0xf bank_mask:0xa
v_add_f32_dpp v22, v30, v30 row_shr:4 row_mask:0xf bank_mask:0xa
v_add_f32_dpp v23, v31, v31 row_shr:4 row_mask:0xf bank_mask:0xa
v_add_f32_dpp v16, v16, v16 quad_perm:[1,0,3,2] row_mask:0xf bank_mask:0xf
v_add_f32_dpp v17, v17, v17 quad_perm:[1,0,3,2] row_mask:0xf bank_mask:0xf
v_add_f32_dpp v18, v18, v18 quad_perm:[1,0,3,2] row_mask:0xf bank_mask:0xf
v_add_f32_dpp v19, v19, v19 quad_perm:[1,0,3,2] row_mask:0xf bank_mask:0xf
v_add_f32_dpp v20, v20, v20 quad_perm:[1,0,3,2] row_mask:0xf bank_mask:0xf
v_add_f32_dpp v21, v21, v21 quad_perm:[1,0,3,2] row_mask:0xf bank_mask:0xf
v_add_f32_dpp v22, v22, v22 quad_perm:[1,0,3,2] row_mask:0xf bank_mask:0xf
v_add_f32_dpp v23, v23, v23 quad_perm:[1,0,3,2] row_mask:0xf bank_mask:0xf
v_add_f32_dpp v16, v16, v16 quad_perm:[2,3,0,1] row_mask:0xf bank_mask:0xf
v_add_f32_dpp v17, v17, v17 quad_perm:[2,3,0,1] row_mask:0xf bank_mask:0xf
v_add_f32_dpp v18, v18, v18 quad_perm:[2,3,0,1] row_mask:0xf bank_mask:0xf
v_add_f32_dpp v19, v19, v19 quad_perm:[2,3,0,1] row_mask:0xf bank_mask:0xf
v_add_f32_dpp v20, v20, v20 quad_perm:[2,3,0,1] row_mask:0xf bank_mask:0xf
v_add_f32_dpp v21, v21, v21 quad_perm:[2,3,0,1] row_mask:0xf bank_mask:0xf
v_add_f32_dpp v22, v22, v22 quad_perm:[2,3,0,1] row_mask:0xf bank_mask:0xf
v_add_f32_dpp v23, v23, v23 quad_perm:[2,3,0,1] row_mask:0xf bank_mask:0xf
s_mov_b32 s30, 0x11111111
s_mov_b32 s31, 0x11111111
s_mov_b64 exec, s[30:31]
ds_write_b128 v2, v[16:19] offset:1024
ds_write_b128 v2, v[20:23] offset:1040
s_mov_b64 exec, -1
s_waitcnt lgkmcnt(0)
s_barrier
v_mov_b32 v48, 0x3f803f80
v_mov_b32 v49, 0x3f803f80
v_mov_b32 v50, 0x3f803f80
v_mov_b32 v51, 0x3f803f80
v_cvt_pk_bf16_f32 v32, v160, v161
v_cvt_pk_bf16_f32 v33, v162, v163
v_cvt_pk_bf16_f32 v34, v164, v165
v_cvt_pk_bf16_f32 v35, v166, v167
v_cvt_pk_bf16_f32 v36, v168, v169
v_cvt_pk_bf16_f32 v37, v170, v171
v_cvt_pk_bf16_f32 v38, v172, v173
v_cvt_pk_bf16_f32 v39, v174, v175
v_cvt_pk_bf16_f32 v40, v176, v177
v_cvt_pk_bf16_f32 v41, v178, v179
v_cvt_pk_bf16_f32 v42, v180, v181
v_cvt_pk_bf16_f32 v43, v182, v183
v_cvt_pk_bf16_f32 v44, v184, v185
v_cvt_pk_bf16_f32 v45, v186, v187
v_cvt_pk_bf16_f32 v46, v188, v189
v_cvt_pk_bf16_f32 v47, v190, v191
v_pk_mul_f32 v[104:105], v[128:129], s[46:47]
v_pk_mul_f32 v[106:107], v[130:131], s[46:47]
v_pk_mul_f32 v[108:109], v[132:133], s[46:47]
v_pk_mul_f32 v[110:111], v[134:135], s[46:47]
v_max_f32 v128, 0, v128
v_max_f32 v129, 0, v129
v_max_f32 v130, 0, v130
v_max_f32 v131, 0, v131
v_max_f32 v132, 0, v132
v_max_f32 v133, 0, v133
v_max_f32 v134, 0, v134
v_max_f32 v135, 0, v135
v_exp_f32_e64 v104, v104 clamp
v_exp_f32_e64 v105, v105 clamp
v_exp_f32_e64 v106, v106 clamp
v_exp_f32_e64 v107, v107 clamp
v_exp_f32_e64 v108, v108 clamp
v_exp_f32_e64 v109, v109 clamp
v_exp_f32_e64 v110, v110 clamp
v_exp_f32_e64 v111, v111 clamp
v_pk_add_f32 v[128:129], v[128:129], s[48:49]
v_pk_add_f32 v[130:131], v[130:131], s[48:49]
v_pk_add_f32 v[132:133], v[132:133], s[48:49]
v_pk_add_f32 v[134:135], v[134:135], s[48:49]
v_pk_add_f32 v[128:129], v[128:129], v[104:105]
v_pk_add_f32 v[130:131], v[130:131], v[106:107]
v_pk_add_f32 v[132:133], v[132:133], v[108:109]
v_pk_add_f32 v[134:135], v[134:135], v[110:111]
v_cvt_pk_bf16_f32 v16, v128, v129
v_cvt_pk_bf16_f32 v17, v130, v131
v_cvt_pk_bf16_f32 v18, v132, v133
v_cvt_pk_bf16_f32 v19, v134, v135
v_pk_mul_f32 v[104:105], v[136:137], s[46:47]
v_pk_mul_f32 v[106:107], v[138:139], s[46:47]
v_pk_mul_f32 v[108:109], v[140:141], s[46:47]
v_pk_mul_f32 v[110:111], v[142:143], s[46:47]
v_max_f32 v136, 0, v136
v_max_f32 v137, 0, v137
v_max_f32 v138, 0, v138
v_max_f32 v139, 0, v139
v_max_f32 v140, 0, v140
v_max_f32 v141, 0, v141
v_max_f32 v142, 0, v142
v_max_f32 v143, 0, v143
v_exp_f32_e64 v104, v104 clamp
v_exp_f32_e64 v105, v105 clamp
v_exp_f32_e64 v106, v106 clamp
v_exp_f32_e64 v107, v107 clamp
v_exp_f32_e64 v108, v108 clamp
v_exp_f32_e64 v109, v109 clamp
v_exp_f32_e64 v110, v110 clamp
v_exp_f32_e64 v111, v111 clamp
v_pk_add_f32 v[136:137], v[136:137], s[48:49]
v_pk_add_f32 v[138:139], v[138:139], s[48:49]
v_pk_add_f32 v[140:141], v[140:141], s[48:49]
v_pk_add_f32 v[142:143], v[142:143], s[48:49]
v_pk_add_f32 v[136:137], v[136:137], v[104:105]
v_pk_add_f32 v[138:139], v[138:139], v[106:107]
v_pk_add_f32 v[140:141], v[140:141], v[108:109]
v_pk_add_f32 v[142:143], v[142:143], v[110:111]
v_cvt_pk_bf16_f32 v20, v136, v137
v_cvt_pk_bf16_f32 v21, v138, v139
v_cvt_pk_bf16_f32 v22, v140, v141
v_cvt_pk_bf16_f32 v23, v142, v143
v_pk_mul_f32 v[104:105], v[144:145], s[46:47]
v_pk_mul_f32 v[106:107], v[146:147], s[46:47]
v_pk_mul_f32 v[108:109], v[148:149], s[46:47]
v_pk_mul_f32 v[110:111], v[150:151], s[46:47]
v_max_f32 v144, 0, v144
v_max_f32 v145, 0, v145
v_max_f32 v146, 0, v146
v_max_f32 v147, 0, v147
v_max_f32 v148, 0, v148
v_max_f32 v149, 0, v149
v_max_f32 v150, 0, v150
v_max_f32 v151, 0, v151
v_exp_f32_e64 v104, v104 clamp
v_exp_f32_e64 v105, v105 clamp
v_exp_f32_e64 v106, v106 clamp
v_exp_f32_e64 v107, v107 clamp
v_exp_f32_e64 v108, v108 clamp
v_exp_f32_e64 v109, v109 clamp
v_exp_f32_e64 v110, v110 clamp
v_exp_f32_e64 v111, v111 clamp
v_pk_add_f32 v[144:145], v[144:145], s[48:49]
v_pk_add_f32 v[146:147], v[146:147], s[48:49]
v_pk_add_f32 v[148:149], v[148:149], s[48:49]
v_pk_add_f32 v[150:151], v[150:151], s[48:49]
v_pk_add_f32 v[144:145], v[144:145], v[104:105]
v_pk_add_f32 v[146:147], v[146:147], v[106:107]
v_pk_add_f32 v[148:149], v[148:149], v[108:109]
v_pk_add_f32 v[150:151], v[150:151], v[110:111]
v_cvt_pk_bf16_f32 v24, v144, v145
v_cvt_pk_bf16_f32 v25, v146, v147
v_cvt_pk_bf16_f32 v26, v148, v149
v_cvt_pk_bf16_f32 v27, v150, v151
v_pk_mul_f32 v[104:105], v[152:153], s[46:47]
v_pk_mul_f32 v[106:107], v[154:155], s[46:47]
v_pk_mul_f32 v[108:109], v[156:157], s[46:47]
v_pk_mul_f32 v[110:111], v[158:159], s[46:47]
v_max_f32 v152, 0, v152
v_max_f32 v153, 0, v153
v_max_f32 v154, 0, v154
v_max_f32 v155, 0, v155
v_max_f32 v156, 0, v156
v_max_f32 v157, 0, v157
v_max_f32 v158, 0, v158
v_max_f32 v159, 0, v159
v_exp_f32_e64 v104, v104 clamp
v_exp_f32_e64 v105, v105 clamp
v_exp_f32_e64 v106, v106 clamp
v_exp_f32_e64 v107, v107 clamp
v_exp_f32_e64 v108, v108 clamp
v_exp_f32_e64 v109, v109 clamp
v_exp_f32_e64 v110, v110 clamp
v_exp_f32_e64 v111, v111 clamp
v_pk_add_f32 v[152:153], v[152:153], s[48:49]
v_pk_add_f32 v[154:155], v[154:155], s[48:49]
v_pk_add_f32 v[156:157], v[156:157], s[48:49]
v_pk_add_f32 v[158:159], v[158:159], s[48:49]
v_pk_add_f32 v[152:153], v[152:153], v[104:105]
v_pk_add_f32 v[154:155], v[154:155], v[106:107]
v_pk_add_f32 v[156:157], v[156:157], v[108:109]
v_pk_add_f32 v[158:159], v[158:159], v[110:111]
v_cvt_pk_bf16_f32 v28, v152, v153
v_cvt_pk_bf16_f32 v29, v154, v155
v_cvt_pk_bf16_f32 v30, v156, v157
v_cvt_pk_bf16_f32 v31, v158, v159
s_nop 0
s_nop 1
v_mfma_f32_16x16x32_bf16 v[56:59], v[16:19], v[32:35], 0
v_mfma_f32_16x16x32_bf16 v[60:63], v[24:27], v[32:35], 0
v_mfma_f32_16x16x32_bf16 v[64:67], v[16:19], v[40:43], 0
v_mfma_f32_16x16x32_bf16 v[68:71], v[24:27], v[40:43], 0
v_mfma_f32_16x16x32_bf16 v[72:75], v[16:19], v[48:51], 0
v_mfma_f32_16x16x32_bf16 v[76:79], v[24:27], v[48:51], 0
v_mfma_f32_16x16x32_bf16 v[56:59], v[20:23], v[36:39], v[56:59]
v_mfma_f32_16x16x32_bf16 v[60:63], v[28:31], v[36:39], v[60:63]
v_mfma_f32_16x16x32_bf16 v[64:67], v[20:23], v[44:47], v[64:67]
v_mfma_f32_16x16x32_bf16 v[68:71], v[28:31], v[44:47], v[68:71]
v_mfma_f32_16x16x32_bf16 v[72:75], v[20:23], v[48:51], v[72:75]
v_mfma_f32_16x16x32_bf16 v[76:79], v[28:31], v[48:51], v[76:79]
s_lshl_b32 s30, s100, 1
s_add_u32 s30, s30, 1
s_lshl_b32 s30, s30, 5
s_lshl_b32 s31, s21, 1
s_add_u32 s30, s30, s31
s_add_u32 s30, s30, s23
s_mul_i32 s30, s30, 6144
s_add_u32 s30, s30, 37748736
s_add_u32 s31, s30, 4096
s_nop 0
s_nop 7
buffer_store_dwordx4 v[56:59], v11, s[16:19], s30 offen offset:0 sc1
buffer_store_dwordx4 v[60:63], v11, s[16:19], s30 offen offset:1024 sc1
buffer_store_dwordx4 v[64:67], v11, s[16:19], s30 offen offset:2048 sc1
buffer_store_dwordx4 v[68:71], v11, s[16:19], s30 offen offset:3072 sc1
buffer_store_dwordx4 v[72:75], v11, s[16:19], s31 offen offset:0 sc1
buffer_store_dwordx4 v[76:79], v11, s[16:19], s31 offen offset:1024 sc1
s_nop 0
s_barrier
ds_read_b128 v[16:19], v5 offset:4096
ds_read_b128 v[32:35], v5 offset:4608
ds_read_b128 v[20:23], v5 offset:4112
ds_read_b128 v[36:39], v5 offset:4624
ds_read_b128 v[24:27], v5 offset:4224
ds_read_b128 v[40:43], v5 offset:4736
ds_read_b128 v[28:31], v5 offset:4240
ds_read_b128 v[44:47], v5 offset:4752
s_lshl_b32 s32, s22, 6
s_lshl_b32 s33, s21, 2
s_add_u32 s32, s32, s33
s_lshl_b32 s33, s23, 1
s_add_u32 s32, s32, s33
s_mul_i32 s32, s32, 7168
s_add_u32 s32, s32, 16777216
s_waitcnt lgkmcnt(0)
v_pk_fma_f32 v[192:193], v[192:193], v[16:17], v[32:33]
v_pk_fma_f32 v[194:195], v[194:195], v[18:19], v[34:35]
v_pk_fma_f32 v[196:197], v[196:197], v[20:21], v[36:37]
v_pk_fma_f32 v[198:199], v[198:199], v[22:23], v[38:39]
s_add_u32 s33, s32, 2048
v_cvt_pk_bf16_f32 v80, v192, v193
v_cvt_pk_bf16_f32 v81, v194, v195
v_cvt_pk_bf16_f32 v82, v196, v197
v_cvt_pk_bf16_f32 v83, v198, v199
buffer_store_dwordx4 v[80:83], v11, s[16:19], s33 offen sc1
v_pk_fma_f32 v[200:201], v[200:201], v[24:25], v[40:41]
v_pk_fma_f32 v[202:203], v[202:203], v[26:27], v[42:43]
v_pk_fma_f32 v[204:205], v[204:205], v[28:29], v[44:45]
v_pk_fma_f32 v[206:207], v[206:207], v[30:31], v[46:47]
s_add_u32 s33, s32, 9216
v_cvt_pk_bf16_f32 v84, v200, v201
v_cvt_pk_bf16_f32 v85, v202, v203
v_cvt_pk_bf16_f32 v86, v204, v205
v_cvt_pk_bf16_f32 v87, v206, v207
buffer_store_dwordx4 v[84:87], v11, s[16:19], s33 offen sc1
v_pk_mul_f32 v[104:105], v[208:209], v[208:209]
v_pk_mul_f32 v[106:107], v[210:211], v[210:211]
v_pk_mul_f32 v[108:109], v[212:213], v[212:213]
v_pk_mul_f32 v[110:111], v[214:215], v[214:215]
v_pk_fma_f32 v[104:105], v[104:105], s[42:43], v[12:13]
v_pk_fma_f32 v[106:107], v[106:107], s[42:43], v[12:13]
v_pk_fma_f32 v[108:109], v[108:109], s[42:43], v[12:13]
v_pk_fma_f32 v[110:111], v[110:111], s[42:43], v[12:13]
v_pk_mul_f32 v[104:105], v[104:105], v[208:209]
v_pk_mul_f32 v[106:107], v[106:107], v[210:211]
v_pk_mul_f32 v[108:109], v[108:109], v[212:213]
v_pk_mul_f32 v[110:111], v[110:111], v[214:215]
v_exp_f32 v104, v104
v_exp_f32 v105, v105
v_exp_f32 v106, v106
v_exp_f32 v107, v107
v_exp_f32 v108, v108
v_exp_f32 v109, v109
v_exp_f32 v110, v110
v_exp_f32 v111, v111
v_pk_add_f32 v[104:105], v[104:105], s[44:45]
v_pk_add_f32 v[106:107], v[106:107], s[44:45]
v_pk_add_f32 v[108:109], v[108:109], s[44:45]
v_pk_add_f32 v[110:111], v[110:111], s[44:45]
v_rcp_f32 v104, v104
v_rcp_f32 v105, v105
v_rcp_f32 v106, v106
v_rcp_f32 v107, v107
v_rcp_f32 v108, v108
v_rcp_f32 v109, v109
v_rcp_f32 v110, v110
v_rcp_f32 v111, v111
v_pk_mul_f32 v[208:209], v[208:209], v[104:105]
v_pk_mul_f32 v[210:211], v[210:211], v[106:107]
v_pk_mul_f32 v[212:213], v[212:213], v[108:109]
v_pk_mul_f32 v[214:215], v[214:215], v[110:111]
v_cvt_pk_bf16_f32 v96, v208, v209
v_cvt_pk_bf16_f32 v97, v210, v211
v_cvt_pk_bf16_f32 v98, v212, v213
v_cvt_pk_bf16_f32 v99, v214, v215
ds_write_b128 v6, v[96:99] offset:4096
v_pk_mul_f32 v[104:105], v[216:217], v[216:217]
v_pk_mul_f32 v[106:107], v[218:219], v[218:219]
v_pk_mul_f32 v[108:109], v[220:221], v[220:221]
v_pk_mul_f32 v[110:111], v[222:223], v[222:223]
v_pk_fma_f32 v[104:105], v[104:105], s[42:43], v[12:13]
v_pk_fma_f32 v[106:107], v[106:107], s[42:43], v[12:13]
v_pk_fma_f32 v[108:109], v[108:109], s[42:43], v[12:13]
v_pk_fma_f32 v[110:111], v[110:111], s[42:43], v[12:13]
v_pk_mul_f32 v[104:105], v[104:105], v[216:217]
v_pk_mul_f32 v[106:107], v[106:107], v[218:219]
v_pk_mul_f32 v[108:109], v[108:109], v[220:221]
v_pk_mul_f32 v[110:111], v[110:111], v[222:223]
v_exp_f32 v104, v104
v_exp_f32 v105, v105
v_exp_f32 v106, v106
v_exp_f32 v107, v107
v_exp_f32 v108, v108
v_exp_f32 v109, v109
v_exp_f32 v110, v110
v_exp_f32 v111, v111
v_pk_add_f32 v[104:105], v[104:105], s[44:45]
v_pk_add_f32 v[106:107], v[106:107], s[44:45]
v_pk_add_f32 v[108:109], v[108:109], s[44:45]
v_pk_add_f32 v[110:111], v[110:111], s[44:45]
v_rcp_f32 v104, v104
v_rcp_f32 v105, v105
v_rcp_f32 v106, v106
v_rcp_f32 v107, v107
v_rcp_f32 v108, v108
v_rcp_f32 v109, v109
v_rcp_f32 v110, v110
v_rcp_f32 v111, v111
v_pk_mul_f32 v[216:217], v[216:217], v[104:105]
v_pk_mul_f32 v[218:219], v[218:219], v[106:107]
v_pk_mul_f32 v[220:221], v[220:221], v[108:109]
v_pk_mul_f32 v[222:223], v[222:223], v[110:111]
v_cvt_pk_bf16_f32 v100, v216, v217
v_cvt_pk_bf16_f32 v101, v218, v219
v_cvt_pk_bf16_f32 v102, v220, v221
v_cvt_pk_bf16_f32 v103, v222, v223
ds_write_b128 v6, v[100:103] offset:5120
s_waitcnt vmcnt(0)
s_barrier
v_pk_mul_f32 v[104:105], v[224:225], v[224:225]
v_pk_mul_f32 v[106:107], v[226:227], v[226:227]
v_pk_mul_f32 v[108:109], v[228:229], v[228:229]
v_pk_mul_f32 v[110:111], v[230:231], v[230:231]
v_pk_fma_f32 v[104:105], v[104:105], s[42:43], v[12:13]
v_pk_fma_f32 v[106:107], v[106:107], s[42:43], v[12:13]
v_pk_fma_f32 v[108:109], v[108:109], s[42:43], v[12:13]
v_pk_fma_f32 v[110:111], v[110:111], s[42:43], v[12:13]
v_pk_mul_f32 v[104:105], v[104:105], v[224:225]
v_pk_mul_f32 v[106:107], v[106:107], v[226:227]
v_pk_mul_f32 v[108:109], v[108:109], v[228:229]
v_pk_mul_f32 v[110:111], v[110:111], v[230:231]
v_exp_f32 v104, v104
v_exp_f32 v105, v105
v_exp_f32 v106, v106
v_exp_f32 v107, v107
v_exp_f32 v108, v108
v_exp_f32 v109, v109
v_exp_f32 v110, v110
v_exp_f32 v111, v111
v_pk_add_f32 v[104:105], v[104:105], s[44:45]
v_pk_add_f32 v[106:107], v[106:107], s[44:45]
v_pk_add_f32 v[108:109], v[108:109], s[44:45]
v_pk_add_f32 v[110:111], v[110:111], s[44:45]
v_rcp_f32 v104, v104
v_rcp_f32 v105, v105
v_rcp_f32 v106, v106
v_rcp_f32 v107, v107
v_rcp_f32 v108, v108
v_rcp_f32 v109, v109
v_rcp_f32 v110, v110
v_rcp_f32 v111, v111
v_pk_mul_f32 v[224:225], v[224:225], v[104:105]
v_pk_mul_f32 v[226:227], v[226:227], v[106:107]
v_pk_mul_f32 v[228:229], v[228:229], v[108:109]
v_pk_mul_f32 v[230:231], v[230:231], v[110:111]
v_cvt_pk_bf16_f32 v96, v224, v225
v_cvt_pk_bf16_f32 v97, v226, v227
v_cvt_pk_bf16_f32 v98, v228, v229
v_cvt_pk_bf16_f32 v99, v230, v231
ds_write_b128 v6, v[96:99] offset:8192
v_pk_mul_f32 v[104:105], v[232:233], v[232:233]
v_pk_mul_f32 v[106:107], v[234:235], v[234:235]
v_pk_mul_f32 v[108:109], v[236:237], v[236:237]
v_pk_mul_f32 v[110:111], v[238:239], v[238:239]
v_pk_fma_f32 v[104:105], v[104:105], s[42:43], v[12:13]
v_pk_fma_f32 v[106:107], v[106:107], s[42:43], v[12:13]
v_pk_fma_f32 v[108:109], v[108:109], s[42:43], v[12:13]
v_pk_fma_f32 v[110:111], v[110:111], s[42:43], v[12:13]
v_pk_mul_f32 v[104:105], v[104:105], v[232:233]
v_pk_mul_f32 v[106:107], v[106:107], v[234:235]
v_pk_mul_f32 v[108:109], v[108:109], v[236:237]
v_pk_mul_f32 v[110:111], v[110:111], v[238:239]
v_exp_f32 v104, v104
v_exp_f32 v105, v105
v_exp_f32 v106, v106
v_exp_f32 v107, v107
v_exp_f32 v108, v108
v_exp_f32 v109, v109
v_exp_f32 v110, v110
v_exp_f32 v111, v111
v_pk_add_f32 v[104:105], v[104:105], s[44:45]
v_pk_add_f32 v[106:107], v[106:107], s[44:45]
v_pk_add_f32 v[108:109], v[108:109], s[44:45]
v_pk_add_f32 v[110:111], v[110:111], s[44:45]
v_rcp_f32 v104, v104
v_rcp_f32 v105, v105
v_rcp_f32 v106, v106
v_rcp_f32 v107, v107
v_rcp_f32 v108, v108
v_rcp_f32 v109, v109
v_rcp_f32 v110, v110
v_rcp_f32 v111, v111
v_pk_mul_f32 v[232:233], v[232:233], v[104:105]
v_pk_mul_f32 v[234:235], v[234:235], v[106:107]
v_pk_mul_f32 v[236:237], v[236:237], v[108:109]
v_pk_mul_f32 v[238:239], v[238:239], v[110:111]
v_cvt_pk_bf16_f32 v100, v232, v233
v_cvt_pk_bf16_f32 v101, v234, v235
v_cvt_pk_bf16_f32 v102, v236, v237
v_cvt_pk_bf16_f32 v103, v238, v239
ds_write_b128 v6, v[100:103] offset:9216
L_r0:
s_and_b32 s23, s20, 3
s_cmp_ge_u32 s20, 3
s_cselect_b32 s36, 1, 0
s_mul_i32 s37, s36, 3
s_sub_u32 s37, s20, s37
s_lshl_b32 s38, s100, 1
s_add_u32 s38, s38, s36
s_mul_i32 s39, s21, 24
s_lshl_b32 s37, s37, 3
s_add_u32 s39, s39, s37
v_lshrrev_b32 v17, 3, v1
v_add_u32 v17, s39, v17
v_and_b32_e64 v18, 7, v1
v_mul_u32_u24 v18, 24576, v18
v_lshl_add_u32 v18, v17, 4, v18
s_mul_i32 s39, s38, 196608
s_add_u32 s39, s39, 37748736
s_waitcnt lgkmcnt(0)
s_barrier
buffer_load_dwordx4 v[72:75], v18, s[16:19], s39 offen sc1
s_add_u32 s39, s39, 6144
buffer_load_dwordx4 v[76:79], v18, s[16:19], s39 offen sc1
s_add_u32 s39, s39, 6144
buffer_load_dwordx4 v[80:83], v18, s[16:19], s39 offen sc1
s_add_u32 s39, s39, 6144
buffer_load_dwordx4 v[84:87], v18, s[16:19], s39 offen sc1
s_nop 0
s_barrier
ds_read_b128 v[24:27], v116 offset:0
ds_read_b128 v[28:31], v116 offset:2048
ds_read_b128 v[40:43], v121 offset:0
ds_read_b128 v[44:47], v121 offset:1024
ds_read_b128 v[48:51], v121 offset:2048
ds_read_b128 v[52:55], v121 offset:3072
s_nop 0
s_waitcnt lgkmcnt(0)
ds_read_b128 v[32:35], v117 offset:0
v_mfma_f32_16x16x32_bf16 v[128:131], v[40:43], v[24:27], 0
ds_read_b128 v[36:39], v117 offset:2048
v_mfma_f32_16x16x32_bf16 v[132:135], v[40:43], v[28:31], 0
ds_read_b128 v[56:59], v121 offset:7168
v_mfma_f32_16x16x32_bf16 v[136:139], v[44:47], v[24:27], 0
ds_read_b128 v[60:63], v121 offset:8192
v_mfma_f32_16x16x32_bf16 v[140:143], v[44:47], v[28:31], 0
ds_read_b128 v[64:67], v121 offset:9216
v_mfma_f32_16x16x32_bf16 v[144:147], v[48:51], v[24:27], 0
ds_read_b128 v[68:71], v121 offset:10240
v_mfma_f32_16x16x32_bf16 v[148:151], v[48:51], v[28:31], 0
v_mfma_f32_16x16x32_bf16 v[152:155], v[52:55], v[24:27], 0
v_mfma_f32_16x16x32_bf16 v[156:159], v[52:55], v[28:31], 0
s_nop 0
s_mov_b32 s29, 7
L_loop2_0:
s_waitcnt vmcnt(8) lgkmcnt(0)
s_barrier
ds_read_b128 v[24:27], v116 offset:30720
v_mfma_f32_16x16x32_bf16 v[128:131], v[56:59], v[32:35], v[128:131]
ds_read_b128 v[28:31], v116 offset:32768
s_nop 0
s_add_u32 m0, s27, 0
v_mfma_f32_16x16x32_bf16 v[132:135], v[56:59], v[36:39], v[132:135]
ds_read_b128 v[40:43], v121 offset:30720
buffer_load_dwordx4 v112, s[56:59], s24 offen offset:0 lds
v_mfma_f32_16x16x32_bf16 v[136:139], v[60:63], v[32:35], v[136:139]
ds_read_b128 v[44:47], v121 offset:31744
buffer_load_dwordx4 v113, s[56:59], s24 offen offset:1024 lds
v_mfma_f32_16x16x32_bf16 v[140:143], v[60:63], v[36:39], v[140:143]
ds_read_b128 v[48:51], v121 offset:32768
v_mfma_f32_16x16x32_bf16 v[144:147], v[64:67], v[32:35], v[144:147]
ds_read_b128 v[52:55], v121 offset:33792
v_mfma_f32_16x16x32_bf16 v[148:151], v[64:67], v[36:39], v[148:151]
v_mfma_f32_16x16x32_bf16 v[152:155], v[68:71], v[32:35], v[152:155]
v_mfma_f32_16x16x32_bf16 v[156:159], v[68:71], v[36:39], v[156:159]
s_nop 0
s_waitcnt lgkmcnt(0)
ds_read_b128 v[32:35], v117 offset:30720
v_mfma_f32_16x16x32_bf16 v[128:131], v[40:43], v[24:27], v[128:131]
ds_read_b128 v[36:39], v117 offset:32768
v_mfma_f32_16x16x32_bf16 v[132:135], v[40:43], v[28:31], v[132:135]
ds_read_b128 v[56:59], v121 offset:37888
buffer_load_dwordx4 v114, s[56:59], s24 offen offset:2048 lds
v_mfma_f32_16x16x32_bf16 v[136:139], v[44:47], v[24:27], v[136:139]
ds_read_b128 v[60:63], v121 offset:38912
buffer_load_dwordx4 v115, s[56:59], s24 offen offset:3072 lds
s_add_u32 s24, s24, 128
v_mfma_f32_16x16x32_bf16 v[140:143], v[44:47], v[28:31], v[140:143]
ds_read_b128 v[64:67], v121 offset:39936
v_mfma_f32_16x16x32_bf16 v[144:147], v[48:51], v[24:27], v[144:147]
ds_read_b128 v[68:71], v121 offset:40960
v_mfma_f32_16x16x32_bf16 v[148:151], v[48:51], v[28:31], v[148:151]
v_mfma_f32_16x16x32_bf16 v[152:155], v[52:55], v[24:27], v[152:155]
v_mfma_f32_16x16x32_bf16 v[156:159], v[52:55], v[28:31], v[156:159]
s_waitcnt vmcnt(8) lgkmcnt(0)
s_barrier
ds_read_b128 v[24:27], v118 offset:0
v_mfma_f32_16x16x32_bf16 v[128:131], v[56:59], v[32:35], v[128:131]
ds_read_b128 v[28:31], v118 offset:2048
s_add_u32 m0, s27, 30720
v_mfma_f32_16x16x32_bf16 v[132:135], v[56:59], v[36:39], v[132:135]
ds_read_b128 v[40:43], v122 offset:0
buffer_load_dwordx4 v112, s[56:59], s24 offen offset:0 lds
v_mfma_f32_16x16x32_bf16 v[136:139], v[60:63], v[32:35], v[136:139]
ds_read_b128 v[44:47], v122 offset:1024
buffer_load_dwordx4 v113, s[56:59], s24 offen offset:1024 lds
v_mfma_f32_16x16x32_bf16 v[140:143], v[60:63], v[36:39], v[140:143]
ds_read_b128 v[48:51], v122 offset:2048
v_mfma_f32_16x16x32_bf16 v[144:147], v[64:67], v[32:35], v[144:147]
ds_read_b128 v[52:55], v122 offset:3072
v_mfma_f32_16x16x32_bf16 v[148:151], v[64:67], v[36:39], v[148:151]
v_mfma_f32_16x16x32_bf16 v[152:155], v[68:71], v[32:35], v[152:155]
v_mfma_f32_16x16x32_bf16 v[156:159], v[68:71], v[36:39], v[156:159]
s_nop 0
s_waitcnt lgkmcnt(0)
ds_read_b128 v[32:35], v119 offset:0
v_mfma_f32_16x16x32_bf16 v[128:131], v[40:43], v[24:27], v[128:131]
ds_read_b128 v[36:39], v119 offset:2048
v_mfma_f32_16x16x32_bf16 v[132:135], v[40:43], v[28:31], v[132:135]
ds_read_b128 v[56:59], v122 offset:7168
buffer_load_dwordx4 v114, s[56:59], s24 offen offset:2048 lds
v_mfma_f32_16x16x32_bf16 v[136:139], v[44:47], v[24:27], v[136:139]
ds_read_b128 v[60:63], v122 offset:8192
buffer_load_dwordx4 v115, s[56:59], s24 offen offset:3072 lds
s_add_u32 s24, s24, 128
v_mfma_f32_16x16x32_bf16 v[140:143], v[44:47], v[28:31], v[140:143]
ds_read_b128 v[64:67], v122 offset:9216
v_mfma_f32_16x16x32_bf16 v[144:147], v[48:51], v[24:27], v[144:147]
ds_read_b128 v[68:71], v122 offset:10240
v_mfma_f32_16x16x32_bf16 v[148:151], v[48:51], v[28:31], v[148:151]
v_mfma_f32_16x16x32_bf16 v[152:155], v[52:55], v[24:27], v[152:155]
v_mfma_f32_16x16x32_bf16 v[156:159], v[52:55], v[28:31], v[156:159]
s_waitcnt vmcnt(8) lgkmcnt(0)
s_barrier
ds_read_b128 v[24:27], v118 offset:30720
v_mfma_f32_16x16x32_bf16 v[128:131], v[56:59], v[32:35], v[128:131]
ds_read_b128 v[28:31], v118 offset:32768
s_add_u32 m0, s27, 61440
v_mfma_f32_16x16x32_bf16 v[132:135], v[56:59], v[36:39], v[132:135]
ds_read_b128 v[40:43], v122 offset:30720
buffer_load_dwordx4 v112, s[56:59], s24 offen offset:0 lds
v_mfma_f32_16x16x32_bf16 v[136:139], v[60:63], v[32:35], v[136:139]
ds_read_b128 v[44:47], v122 offset:31744
buffer_load_dwordx4 v113, s[56:59], s24 offen offset:1024 lds
v_mfma_f32_16x16x32_bf16 v[140:143], v[60:63], v[36:39], v[140:143]
ds_read_b128 v[48:51], v122 offset:32768
v_mfma_f32_16x16x32_bf16 v[144:147], v[64:67], v[32:35], v[144:147]
ds_read_b128 v[52:55], v122 offset:33792
v_mfma_f32_16x16x32_bf16 v[148:151], v[64:67], v[36:39], v[148:151]
v_mfma_f32_16x16x32_bf16 v[152:155], v[68:71], v[32:35], v[152:155]
v_mfma_f32_16x16x32_bf16 v[156:159], v[68:71], v[36:39], v[156:159]
s_nop 0
s_waitcnt lgkmcnt(0)
ds_read_b128 v[32:35], v119 offset:30720
v_mfma_f32_16x16x32_bf16 v[128:131], v[40:43], v[24:27], v[128:131]
ds_read_b128 v[36:39], v119 offset:32768
v_mfma_f32_16x16x32_bf16 v[132:135], v[40:43], v[28:31], v[132:135]
ds_read_b128 v[56:59], v122 offset:37888
buffer_load_dwordx4 v114, s[56:59], s24 offen offset:2048 lds
v_mfma_f32_16x16x32_bf16 v[136:139], v[44:47], v[24:27], v[136:139]
ds_read_b128 v[60:63], v122 offset:38912
buffer_load_dwordx4 v115, s[56:59], s24 offen offset:3072 lds
s_add_u32 s24, s24, 128
v_mfma_f32_16x16x32_bf16 v[140:143], v[44:47], v[28:31], v[140:143]
ds_read_b128 v[64:67], v122 offset:39936
v_mfma_f32_16x16x32_bf16 v[144:147], v[48:51], v[24:27], v[144:147]
ds_read_b128 v[68:71], v122 offset:40960
v_mfma_f32_16x16x32_bf16 v[148:151], v[48:51], v[28:31], v[148:151]
v_mfma_f32_16x16x32_bf16 v[152:155], v[52:55], v[24:27], v[152:155]
v_mfma_f32_16x16x32_bf16 v[156:159], v[52:55], v[28:31], v[156:159]
s_waitcnt vmcnt(8) lgkmcnt(0)
s_barrier
ds_read_b128 v[24:27], v116 offset:0
v_mfma_f32_16x16x32_bf16 v[128:131], v[56:59], v[32:35], v[128:131]
ds_read_b128 v[28:31], v116 offset:2048
s_add_u32 m0, s27, 92160
v_mfma_f32_16x16x32_bf16 v[132:135], v[56:59], v[36:39], v[132:135]
ds_read_b128 v[40:43], v121 offset:0
buffer_load_dwordx4 v112, s[56:59], s24 offen offset:0 lds
v_mfma_f32_16x16x32_bf16 v[136:139], v[60:63], v[32:35], v[136:139]
ds_read_b128 v[44:47], v121 offset:1024
buffer_load_dwordx4 v113, s[56:59], s24 offen offset:1024 lds
v_mfma_f32_16x16x32_bf16 v[140:143], v[60:63], v[36:39], v[140:143]
ds_read_b128 v[48:51], v121 offset:2048
v_mfma_f32_16x16x32_bf16 v[144:147], v[64:67], v[32:35], v[144:147]
ds_read_b128 v[52:55], v121 offset:3072
v_mfma_f32_16x16x32_bf16 v[148:151], v[64:67], v[36:39], v[148:151]
v_mfma_f32_16x16x32_bf16 v[152:155], v[68:71], v[32:35], v[152:155]
v_mfma_f32_16x16x32_bf16 v[156:159], v[68:71], v[36:39], v[156:159]
s_nop 0
s_waitcnt lgkmcnt(0)
ds_read_b128 v[32:35], v117 offset:0
v_mfma_f32_16x16x32_bf16 v[128:131], v[40:43], v[24:27], v[128:131]
ds_read_b128 v[36:39], v117 offset:2048
v_mfma_f32_16x16x32_bf16 v[132:135], v[40:43], v[28:31], v[132:135]
ds_read_b128 v[56:59], v121 offset:7168
buffer_load_dwordx4 v114, s[56:59], s24 offen offset:2048 lds
v_mfma_f32_16x16x32_bf16 v[136:139], v[44:47], v[24:27], v[136:139]
ds_read_b128 v[60:63], v121 offset:8192
buffer_load_dwordx4 v115, s[56:59], s24 offen offset:3072 lds
s_add_u32 s24, s24, 128
v_mfma_f32_16x16x32_bf16 v[140:143], v[44:47], v[28:31], v[140:143]
ds_read_b128 v[64:67], v121 offset:9216
v_mfma_f32_16x16x32_bf16 v[144:147], v[48:51], v[24:27], v[144:147]
ds_read_b128 v[68:71], v121 offset:10240
v_mfma_f32_16x16x32_bf16 v[148:151], v[48:51], v[28:31], v[148:151]
v_mfma_f32_16x16x32_bf16 v[152:155], v[52:55], v[24:27], v[152:155]
v_mfma_f32_16x16x32_bf16 v[156:159], v[52:55], v[28:31], v[156:159]
s_sub_u32 s29, s29, 1
s_cmp_eq_u32 s29, 6
s_cbranch_scc1 L_side0_6
s_cmp_lg_u32 s29, 0
s_cbranch_scc1 L_loop2_0
v_and_b32 v12, 63, v0
s_lshl_b32 s27, s20, 10
v_add_u32 v224, s27, v11
s_lshr_b32 s38, s20, 1
s_lshl_b32 s39, s38, 11
s_and_b32 s30, s20, 1
s_lshl_b32 s31, s30, 3
s_add_u32 s39, s39, s31
v_add_u32 v225, s39, v11
v_lshrrev_b32_e64 v13, 3, v12
v_bfe_u32 v14, v12, 4, 2
v_lshlrev_b32 v14, 1, v14
v_and_b32 v15, 7, v12
v_xor_b32 v14, v14, v15
v_lshlrev_b32 v14, 4, v14
v_lshl_add_u32 v226, v13, 11, v14
s_lshl_b32 s39, s20, 14
v_add_u32 v226, s39, v226
v_bfe_u32 v13, v12, 2, 3
v_lshrrev_b32 v14, 5, v12
v_lshlrev_b32 v14, 10, v14
v_lshl_add_u32 v14, v13, 7, v14
v_lshrrev_b32_e64 v13, 1, v13
v_lshl_add_u32 v14, v13, 5, v14
v_and_b32_e64 v15, 3, v12
v_lshl_add_u32 v227, v15, 3, v14
v_xor_b32 v228, 32, v227
v_xor_b32 v229, 64, v227
v_xor_b32 v230, 96, v227
v_bfe_u32 v13, v12, 2, 2
v_lshl_add_u32 v13, v13, 3, v15
v_lshlrev_b32_e64 v231, 11, v13
v_bfe_u32 v13, v12, 4, 1
v_lshl_add_u32 v231, v13, 5, v231
v_lshrrev_b32_e64 v13, 5, v12
v_lshl_add_u32 v231, v13, 4, v231
s_lshl_b32 s26, s50, 7
s_lshl_b32 s38, s38, 5
s_add_u32 s26, s26, s38
s_lshl_b32 s30, s30, 2
s_add_u32 s26, s26, s30
s_lshl_b32 s26, s26, 11
s_lshl_b32 s40, s51, 7
s_add_u32 s26, s26, s40
s_mul_i32 s24, s50, 720896
s_add_u32 s24, s24, 25165824
s_mov_b32 s25, s40
s_lshl_b32 s41, s50, 11
s_add_u32 s41, s41, 47218688
s_lshr_b32 s30, s2, 3
s_lshl_b32 s30, s30, 3
s_add_u32 s30, s30, s20
s_lshl_b32 s30, s30, 13
s_and_b32 s31, s51, 8
s_add_u32 s31, s31, 3
s_lshl_b32 s31, s31, 7
s_add_u32 s30, s30, s31
v_lshlrev_b32 v232, 11, v12
v_add_u32 v232, s30, v232
v_cmp_gt_u32 vcc, 4, v12
v_bfrev_b32 v233, 1
v_cndmask_b32 v232, v233, v232, vcc
v_mov_b32 v20, 0
v_lshlrev_b32_e64 v21, 3, v11
s_mov_b64 exec, 0xffff
buffer_load_dword v20, v21, s[16:19], s41 offen sc1
s_mov_b64 exec, -1
s_lshl_b32 s30, s21, 8
s_lshl_b32 s31, s23, 6
s_add_u32 s30, s30, s31
buffer_load_ushort v88, v120, s[60:63], s30 offen
buffer_load_ushort v90, v120, s[60:63], s30 offen offset:8
s_lshl_b32 s30, s23, 10
s_add_u32 s30, s30, 122880
v_add_u32 v16, s30, v11
buffer_load_dword v233, v232, s[64:67], 0 offen
s_waitcnt vmcnt(12) lgkmcnt(0)
s_barrier
ds_read_b128 v[24:27], v116 offset:30720
v_mfma_f32_16x16x32_bf16 v[128:131], v[56:59], v[32:35], v[128:131]
ds_read_b128 v[28:31], v116 offset:32768
v_mfma_f32_16x16x32_bf16 v[132:135], v[56:59], v[36:39], v[132:135]
ds_read_b128 v[40:43], v121 offset:30720
v_mfma_f32_16x16x32_bf16 v[136:139], v[60:63], v[32:35], v[136:139]
ds_read_b128 v[44:47], v121 offset:31744
v_mfma_f32_16x16x32_bf16 v[140:143], v[60:63], v[36:39], v[140:143]
ds_read_b128 v[48:51], v121 offset:32768
v_mfma_f32_16x16x32_bf16 v[144:147], v[64:67], v[32:35], v[144:147]
ds_read_b128 v[52:55], v121 offset:33792
v_mfma_f32_16x16x32_bf16 v[148:151], v[64:67], v[36:39], v[148:151]
v_mfma_f32_16x16x32_bf16 v[152:155], v[68:71], v[32:35], v[152:155]
v_mfma_f32_16x16x32_bf16 v[156:159], v[68:71], v[36:39], v[156:159]
s_nop 0
s_waitcnt lgkmcnt(0)
ds_read_b128 v[32:35], v117 offset:30720
v_mfma_f32_16x16x32_bf16 v[128:131], v[40:43], v[24:27], v[128:131]
ds_read_b128 v[36:39], v117 offset:32768
v_mfma_f32_16x16x32_bf16 v[132:135], v[40:43], v[28:31], v[132:135]
ds_read_b128 v[56:59], v121 offset:37888
v_mfma_f32_16x16x32_bf16 v[136:139], v[44:47], v[24:27], v[136:139]
ds_read_b128 v[60:63], v121 offset:38912
v_mfma_f32_16x16x32_bf16 v[140:143], v[44:47], v[28:31], v[140:143]
ds_read_b128 v[64:67], v121 offset:39936
v_mfma_f32_16x16x32_bf16 v[144:147], v[48:51], v[24:27], v[144:147]
ds_read_b128 v[68:71], v121 offset:40960
v_mfma_f32_16x16x32_bf16 v[148:151], v[48:51], v[28:31], v[148:151]
v_mfma_f32_16x16x32_bf16 v[152:155], v[52:55], v[24:27], v[152:155]
v_mfma_f32_16x16x32_bf16 v[156:159], v[52:55], v[28:31], v[156:159]
s_waitcnt vmcnt(8) lgkmcnt(0)
s_barrier
ds_read_b128 v[24:27], v118 offset:0
v_mfma_f32_16x16x32_bf16 v[128:131], v[56:59], v[32:35], v[128:131]
ds_read_b128 v[28:31], v118 offset:2048
v_mfma_f32_16x16x32_bf16 v[132:135], v[56:59], v[36:39], v[132:135]
ds_read_b128 v[40:43], v122 offset:0
v_mfma_f32_16x16x32_bf16 v[136:139], v[60:63], v[32:35], v[136:139]
ds_read_b128 v[44:47], v122 offset:1024
v_mfma_f32_16x16x32_bf16 v[140:143], v[60:63], v[36:39], v[140:143]
ds_read_b128 v[48:51], v122 offset:2048
v_mfma_f32_16x16x32_bf16 v[144:147], v[64:67], v[32:35], v[144:147]
ds_read_b128 v[52:55], v122 offset:3072
v_mfma_f32_16x16x32_bf16 v[148:151], v[64:67], v[36:39], v[148:151]
v_mfma_f32_16x16x32_bf16 v[152:155], v[68:71], v[32:35], v[152:155]
v_mfma_f32_16x16x32_bf16 v[156:159], v[68:71], v[36:39], v[156:159]
s_nop 0
s_waitcnt lgkmcnt(0)
ds_read_b128 v[32:35], v119 offset:0
v_mfma_f32_16x16x32_bf16 v[128:131], v[40:43], v[24:27], v[128:131]
ds_read_b128 v[36:39], v119 offset:2048
v_mfma_f32_16x16x32_bf16 v[132:135], v[40:43], v[28:31], v[132:135]
ds_read_b128 v[56:59], v122 offset:7168
v_mfma_f32_16x16x32_bf16 v[136:139], v[44:47], v[24:27], v[136:139]
ds_read_b128 v[60:63], v122 offset:8192
v_mfma_f32_16x16x32_bf16 v[140:143], v[44:47], v[28:31], v[140:143]
ds_read_b128 v[64:67], v122 offset:9216
v_mfma_f32_16x16x32_bf16 v[144:147], v[48:51], v[24:27], v[144:147]
ds_read_b128 v[68:71], v122 offset:10240
v_mfma_f32_16x16x32_bf16 v[148:151], v[48:51], v[28:31], v[148:151]
v_mfma_f32_16x16x32_bf16 v[152:155], v[52:55], v[24:27], v[152:155]
v_mfma_f32_16x16x32_bf16 v[156:159], v[52:55], v[28:31], v[156:159]
s_waitcnt vmcnt(3) lgkmcnt(0)
s_mov_b32 s36, 0
s_branch L_pollc_12
L_poll_10:
v_mov_b32 v20, 0
v_lshlrev_b32_e64 v21, 3, v11
s_mov_b64 exec, 0xffff
buffer_load_dword v20, v21, s[16:19], s41 offen sc1
s_mov_b64 exec, -1
s_waitcnt vmcnt(0)
L_pollc_12:
v_cmp_eq_u32 vcc, -1, v20
s_add_u32 s36, s36, 1
s_cmp_ge_u32 s36, 6000
s_cbranch_scc1 L_pollx_11
s_cmp_lg_u64 vcc, 0
s_cbranch_scc1 L_poll_10
L_pollx_11:
s_barrier
ds_read_b128 v[24:27], v118 offset:30720
v_mfma_f32_16x16x32_bf16 v[128:131], v[56:59], v[32:35], v[128:131]
ds_read_b128 v[28:31], v118 offset:32768
s_nop 0
s_add_u32 m0, s27, 0
v_mfma_f32_16x16x32_bf16 v[132:135], v[56:59], v[36:39], v[132:135]
ds_read_b128 v[40:43], v122 offset:30720
buffer_load_dwordx4 v226, s[64:67], s25 offen lds
s_add_u32 s25, s25, 131072
v_mfma_f32_16x16x32_bf16 v[136:139], v[60:63], v[32:35], v[136:139]
ds_read_b128 v[44:47], v122 offset:31744
v_mfma_f32_16x16x32_bf16 v[140:143], v[60:63], v[36:39], v[140:143]
ds_read_b128 v[48:51], v122 offset:32768
buffer_load_dwordx4 v[160:163], v224, s[16:19], s24 offen sc1
s_add_u32 s24, s24, 8192
v_mfma_f32_16x16x32_bf16 v[144:147], v[64:67], v[32:35], v[144:147]
ds_read_b128 v[52:55], v122 offset:33792
v_mfma_f32_16x16x32_bf16 v[148:151], v[64:67], v[36:39], v[148:151]
buffer_load_dwordx4 v[164:167], v224, s[16:19], s24 offen sc1
s_add_u32 s24, s24, 8192
v_mfma_f32_16x16x32_bf16 v[152:155], v[68:71], v[32:35], v[152:155]
v_mfma_f32_16x16x32_bf16 v[156:159], v[68:71], v[36:39], v[156:159]
s_nop 0
s_waitcnt lgkmcnt(0)
ds_read_b128 v[32:35], v119 offset:30720
v_mfma_f32_16x16x32_bf16 v[128:131], v[40:43], v[24:27], v[128:131]
ds_read_b128 v[36:39], v119 offset:32768
s_add_u32 m0, s27, 8192
v_mfma_f32_16x16x32_bf16 v[132:135], v[40:43], v[28:31], v[132:135]
ds_read_b128 v[56:59], v122 offset:37888
buffer_load_dwordx4 v226, s[64:67], s25 offen lds
s_add_u32 s25, s25, 131072
v_mfma_f32_16x16x32_bf16 v[136:139], v[44:47], v[24:27], v[136:139]
ds_read_b128 v[60:63], v122 offset:38912
v_mfma_f32_16x16x32_bf16 v[140:143], v[44:47], v[28:31], v[140:143]
ds_read_b128 v[64:67], v122 offset:39936
buffer_load_dwordx4 v[168:171], v224, s[16:19], s24 offen sc1
s_add_u32 s24, s24, 8192
v_mfma_f32_16x16x32_bf16 v[144:147], v[48:51], v[24:27], v[144:147]
ds_read_b128 v[68:71], v122 offset:40960
v_mfma_f32_16x16x32_bf16 v[148:151], v[48:51], v[28:31], v[148:151]
buffer_load_dwordx4 v[172:175], v224, s[16:19], s24 offen sc1
s_add_u32 s24, s24, 8192
v_mfma_f32_16x16x32_bf16 v[152:155], v[52:55], v[24:27], v[152:155]
v_mfma_f32_16x16x32_bf16 v[156:159], v[52:55], v[28:31], v[156:159]
s_nop 0
s_waitcnt lgkmcnt(0)
v_mfma_f32_16x16x32_bf16 v[128:131], v[56:59], v[32:35], v[128:131]
s_add_u32 m0, s27, 16384
v_mfma_f32_16x16x32_bf16 v[132:135], v[56:59], v[36:39], v[132:135]
buffer_load_dwordx4 v226, s[64:67], s25 offen lds
s_add_u32 s25, s25, 131072
v_mfma_f32_16x16x32_bf16 v[136:139], v[60:63], v[32:35], v[136:139]
v_mfma_f32_16x16x32_bf16 v[140:143], v[60:63], v[36:39], v[140:143]
buffer_load_dwordx4 v[176:179], v224, s[16:19], s24 offen sc1
s_add_u32 s24, s24, 8192
v_mfma_f32_16x16x32_bf16 v[144:147], v[64:67], v[32:35], v[144:147]
v_mfma_f32_16x16x32_bf16 v[148:151], v[64:67], v[36:39], v[148:151]
buffer_load_dwordx4 v[180:183], v224, s[16:19], s24 offen sc1
s_add_u32 s24, s24, 8192
v_mfma_f32_16x16x32_bf16 v[152:155], v[68:71], v[32:35], v[152:155]
v_mfma_f32_16x16x32_bf16 v[156:159], v[68:71], v[36:39], v[156:159]
ds_read_b128 v[72:75], v16 offset:0
ds_read_b128 v[76:79], v16 offset:4096
ds_read_b128 v[80:83], v16 offset:8192
ds_read_b128 v[84:87], v16 offset:12288
s_mov_b32 s33, 0xffff0000
s_mul_i32 s30, s21, 720896
s_lshl_b32 s31, s23, 11
s_add_u32 s30, s30, s31
s_add_u32 s30, s30, 25427968
s_lshr_b32 s32, s22, 1
s_mul_i32 s32, s32, 57344
s_add_u32 s30, s30, s32
s_and_b32 s34, s22, 1
s_lshl_b32 s35, s34, 15
s_add_u32 s35, s35, s30
s_add_u32 s39, s35, 8192
s_waitcnt vmcnt(10)
v_lshlrev_b32 v88, 16, v88
v_lshlrev_b32 v90, 16, v90
v_mov_b32 v89, v88
v_mov_b32 v91, v90
s_waitcnt lgkmcnt(0)
v_lshlrev_b32 v92, 16, v72
v_and_b32 v93, s33, v72
v_lshlrev_b32 v94, 16, v73
v_and_b32_e64 v95, s33, v73
v_pk_add_f32 v[128:129], v[128:129], v[88:89]
v_pk_add_f32 v[130:131], v[130:131], v[88:89]
v_pk_mul_f32 v[128:129], v[128:129], v[92:93]
v_pk_mul_f32 v[130:131], v[130:131], v[94:95]
v_lshlrev_b32 v96, 16, v74
v_and_b32 v97, s33, v74
v_lshlrev_b32 v98, 16, v75
v_and_b32 v99, s33, v75
v_pk_add_f32 v[132:133], v[132:133], v[90:91]
v_pk_add_f32 v[134:135], v[134:135], v[90:91]
v_pk_mul_f32 v[132:133], v[132:133], v[96:97]
v_pk_mul_f32 v[134:135], v[134:135], v[98:99]
v_lshlrev_b32 v92, 16, v76
v_and_b32 v93, s33, v76
v_lshlrev_b32 v94, 16, v77
v_and_b32 v95, s33, v77
v_pk_add_f32 v[136:137], v[136:137], v[88:89]
v_pk_add_f32 v[138:139], v[138:139], v[88:89]
v_pk_mul_f32 v[136:137], v[136:137], v[92:93]
v_pk_mul_f32 v[138:139], v[138:139], v[94:95]
v_lshlrev_b32 v96, 16, v78
v_and_b32 v97, s33, v78
v_lshlrev_b32 v98, 16, v79
v_and_b32 v99, s33, v79
v_pk_add_f32 v[140:141], v[140:141], v[90:91]
v_pk_add_f32 v[142:143], v[142:143], v[90:91]
v_pk_mul_f32 v[140:141], v[140:141], v[96:97]
v_pk_mul_f32 v[142:143], v[142:143], v[98:99]
v_cvt_pk_bf16_f32 v48, v128, v129
v_cvt_pk_bf16_f32 v49, v130, v131
v_cvt_pk_bf16_f32 v50, v136, v137
v_cvt_pk_bf16_f32 v51, v138, v139
buffer_store_dwordx4 v[48:51], v11, s[16:19], s35 offen offset:0 sc1
v_cvt_pk_bf16_f32 v52, v132, v133
v_cvt_pk_bf16_f32 v53, v134, v135
v_cvt_pk_bf16_f32 v54, v140, v141
v_cvt_pk_bf16_f32 v55, v142, v143
buffer_store_dwordx4 v[52:55], v11, s[16:19], s35 offen offset:1024 sc1
v_lshlrev_b32 v92, 16, v80
v_and_b32 v93, s33, v80
v_lshlrev_b32 v94, 16, v81
v_and_b32 v95, s33, v81
v_pk_add_f32 v[144:145], v[144:145], v[88:89]
v_pk_add_f32 v[146:147], v[146:147], v[88:89]
v_pk_mul_f32 v[144:145], v[144:145], v[92:93]
v_pk_mul_f32 v[146:147], v[146:147], v[94:95]
v_lshlrev_b32 v96, 16, v82
v_and_b32 v97, s33, v82
v_lshlrev_b32 v98, 16, v83
v_and_b32 v99, s33, v83
v_pk_add_f32 v[148:149], v[148:149], v[90:91]
v_pk_add_f32 v[150:151], v[150:151], v[90:91]
v_pk_mul_f32 v[148:149], v[148:149], v[96:97]
v_pk_mul_f32 v[150:151], v[150:151], v[98:99]
v_lshlrev_b32 v92, 16, v84
v_and_b32 v93, s33, v84
v_lshlrev_b32 v94, 16, v85
v_and_b32 v95, s33, v85
v_pk_add_f32 v[152:153], v[152:153], v[88:89]
v_pk_add_f32 v[154:155], v[154:155], v[88:89]
v_pk_mul_f32 v[152:153], v[152:153], v[92:93]
v_pk_mul_f32 v[154:155], v[154:155], v[94:95]
v_lshlrev_b32 v96, 16, v86
v_and_b32 v97, s33, v86
v_lshlrev_b32 v98, 16, v87
v_and_b32 v99, s33, v87
v_pk_add_f32 v[156:157], v[156:157], v[90:91]
v_pk_add_f32 v[158:159], v[158:159], v[90:91]
v_pk_mul_f32 v[156:157], v[156:157], v[96:97]
v_pk_mul_f32 v[158:159], v[158:159], v[98:99]
v_cvt_pk_bf16_f32 v56, v144, v145
v_cvt_pk_bf16_f32 v57, v146, v147
v_cvt_pk_bf16_f32 v58, v152, v153
v_cvt_pk_bf16_f32 v59, v154, v155
buffer_store_dwordx4 v[56:59], v11, s[16:19], s39 offen offset:0 sc1
v_cvt_pk_bf16_f32 v60, v148, v149
v_cvt_pk_bf16_f32 v61, v150, v151
v_cvt_pk_bf16_f32 v62, v156, v157
v_cvt_pk_bf16_f32 v63, v158, v159
buffer_store_dwordx4 v[60:63], v11, s[16:19], s39 offen offset:1024 sc1
s_branch L_stage3
L_side0_6:
v_lshrrev_b32 v18, 7, v17
v_lshlrev_b32 v18, 10, v18
v_and_b32 v19, 63, v17
v_lshl_add_u32 v18, v19, 4, v18
v_bfe_u32 v19, v17, 6, 1
v_lshl_add_u32 v18, v19, 3, v18
s_mul_i32 s37, s38, 3072
s_add_u32 s37, s37, 46137344
v_pk_add_f32 v[72:73], v[72:73], v[76:77]
v_pk_add_f32 v[80:81], v[80:81], v[84:85]
v_pk_add_f32 v[74:75], v[74:75], v[78:79]
v_pk_add_f32 v[82:83], v[82:83], v[86:87]
v_pk_add_f32 v[72:73], v[72:73], v[80:81]
v_pk_add_f32 v[74:75], v[74:75], v[82:83]
s_nop 0
s_nop 1
v_add_f32_dpp v72, v72, v72 row_half_mirror row_mask:0xf bank_mask:0xf
v_add_f32_dpp v73, v73, v73 row_half_mirror row_mask:0xf bank_mask:0xf
v_add_f32_dpp v74, v74, v74 row_half_mirror row_mask:0xf bank_mask:0xf
v_add_f32_dpp v75, v75, v75 row_half_mirror row_mask:0xf bank_mask:0xf
s_nop 0
s_nop 1
v_add_f32_dpp v72, v72, v72 quad_perm:[1,0,3,2] row_mask:0xf bank_mask:0xf
v_add_f32_dpp v73, v73, v73 quad_perm:[1,0,3,2] row_mask:0xf bank_mask:0xf
v_add_f32_dpp v74, v74, v74 quad_perm:[1,0,3,2] row_mask:0xf bank_mask:0xf
v_add_f32_dpp v75, v75, v75 quad_perm:[1,0,3,2] row_mask:0xf bank_mask:0xf
s_nop 0
s_nop 1
v_add_f32_dpp v72, v72, v72 quad_perm:[2,3,0,1] row_mask:0xf bank_mask:0xf
v_add_f32_dpp v73, v73, v73 quad_perm:[2,3,0,1] row_mask:0xf bank_mask:0xf
v_add_f32_dpp v74, v74, v74 quad_perm:[2,3,0,1] row_mask:0xf bank_mask:0xf
v_add_f32_dpp v75, v75, v75 quad_perm:[2,3,0,1] row_mask:0xf bank_mask:0xf
v_cvt_pk_bf16_f32 v72, v72, v73
v_cvt_pk_bf16_f32 v73, v74, v75
s_mov_b32 s36, 0x01010101
s_mov_b32 exec_lo, s36
s_mov_b32 exec_hi, s36
buffer_store_dwordx2 v[72:73], v18, s[16:19], s37 offen sc1
s_mov_b64 exec, -1
s_branch L_loop2_0
L_g2:
s_lshl_b32 s24, s21, 18
s_lshl_b32 s25, s100, 7
s_mul_i32 s26, s22, 224
s_lshl_b32 s27, s20, 11
s_mul_i32 s28, s23, 13312
s_lshr_b32 s30, s22, 1
s_and_b32 s31, s22, 1
s_add_u32 m0, s28, 14336
s_nop 0
buffer_load_dwordx4 v4, s[12:15], s26 offen offset:0 lds
s_add_u32 m0, s28, 15296
s_nop 0
buffer_load_dwordx4 v4, s[12:15], s26 offen offset:64 lds
s_add_u32 m0, s28, 16256
s_nop 0
buffer_load_dwordx4 v4, s[12:15], s26 offen offset:128 lds
s_add_u32 m0, s28, 17408
s_nop 0
buffer_load_dwordx4 v15, s[12:15], s26 offen offset:0 lds
s_add_u32 s26, s26, 229376
s_add_u32 m0, s28, 49152
s_nop 0
buffer_load_dwordx4 v4, s[12:15], s26 offen offset:0 lds
s_add_u32 m0, s28, 50112
s_nop 0
buffer_load_dwordx4 v4, s[12:15], s26 offen offset:64 lds
s_add_u32 m0, s28, 51072
s_nop 0
buffer_load_dwordx4 v4, s[12:15], s26 offen offset:128 lds
s_add_u32 m0, s28, 52224
s_nop 0
buffer_load_dwordx4 v15, s[12:15], s26 offen offset:0 lds
s_add_u32 s26, s26, 229376
s_lshl_b32 s32, s21, 18
s_lshl_b32 s33, s30, 10
s_add_u32 s32, s32, s33
s_lshl_b32 s33, s31, 7
s_add_u32 s32, s32, s33
s_lshl_b32 s33, s20, 15
s_add_u32 s32, s32, s33
s_add_u32 s33, s32, 16384
s_mov_b32 s36, 0xffff0000
s_waitcnt vmcnt(8)
v_lshlrev_b32 v32, 16, v16
v_and_b32 v33, s36, v16
v_lshlrev_b32 v34, 16, v17
v_and_b32 v35, s36, v17
v_lshlrev_b32 v36, 16, v18
v_and_b32 v37, s36, v18
v_lshlrev_b32 v38, 16, v19
v_and_b32 v39, s36, v19
v_lshlrev_b32 v40, 16, v20
v_and_b32 v41, s36, v20
v_lshlrev_b32 v42, 16, v21
v_and_b32 v43, s36, v21
v_lshlrev_b32 v44, 16, v22
v_and_b32 v45, s36, v22
v_lshlrev_b32 v46, 16, v23
v_and_b32_e64 v47, s36, v23
v_pk_add_f32 v[66:67], v[32:33], v[34:35]
v_pk_mul_f32 v[68:69], v[32:33], v[32:33]
v_pk_fma_f32 v[68:69], v[34:35], v[34:35], v[68:69]
v_pk_add_f32 v[66:67], v[66:67], v[36:37]
v_pk_fma_f32 v[68:69], v[36:37], v[36:37], v[68:69]
v_pk_add_f32 v[66:67], v[66:67], v[38:39]
v_pk_fma_f32 v[68:69], v[38:39], v[38:39], v[68:69]
v_pk_add_f32 v[66:67], v[66:67], v[40:41]
v_pk_fma_f32 v[68:69], v[40:41], v[40:41], v[68:69]
v_pk_add_f32 v[66:67], v[66:67], v[42:43]
v_pk_fma_f32 v[68:69], v[42:43], v[42:43], v[68:69]
v_pk_add_f32 v[66:67], v[66:67], v[44:45]
v_pk_fma_f32 v[68:69], v[44:45], v[44:45], v[68:69]
v_pk_add_f32 v[66:67], v[66:67], v[46:47]
v_pk_fma_f32 v[68:69], v[46:47], v[46:47], v[68:69]
v_add_f32 v66, v66, v67
v_add_f32_e64 v67, v68, v69
s_nop 1
v_add_f32_dpp v66, v66, v66 row_ror:8 row_mask:0xf bank_mask:0xf
v_add_f32_dpp v67, v67, v67 row_ror:8 row_mask:0xf bank_mask:0xf
v_mov_b32 v68, v66
v_mov_b32 v69, v67
s_nop 1
v_permlane16_swap_b32 v68, v66
v_permlane16_swap_b32 v69, v67
s_nop 1
v_pk_add_f32 v[66:67], v[66:67], v[68:69]
v_mov_b32 v68, v66
v_mov_b32 v69, v67
s_nop 1
v_permlane32_swap_b32 v68, v66
v_permlane32_swap_b32 v69, v67
s_nop 1
v_pk_add_f32 v[66:67], v[66:67], v[68:69]
s_mov_b64 exec, 0xff
ds_write_b64 v62, v[66:67]
s_nop 0
s_mov_b64 exec, -1
s_waitcnt lgkmcnt(0)
s_barrier
ds_read_b128 v[16:19], v63 offset:0
ds_read_b128 v[20:23], v63 offset:16
ds_read_b128 v[24:27], v63 offset:32
ds_read_b128 v[28:31], v63 offset:48
s_nop 0
s_waitcnt lgkmcnt(0)
v_pk_add_f32 v[16:17], v[16:17], v[24:25]
v_pk_add_f32 v[18:19], v[18:19], v[26:27]
v_pk_add_f32 v[20:21], v[20:21], v[28:29]
v_pk_add_f32 v[22:23], v[22:23], v[30:31]
v_pk_add_f32 v[16:17], v[16:17], v[20:21]
v_pk_add_f32 v[18:19], v[18:19], v[22:23]
v_pk_add_f32 v[16:17], v[16:17], v[18:19]
v_mul_f32 v16, 0x3a800000, v16
v_mul_f32 v17, 0x3a800000, v17
v_fma_f32 v17, -v16, v16, v17
v_max_f32_e64 v17, 0, v17
v_add_f32 v17, 0x3727c5ac, v17
v_rsq_f32 v18, v17
v_mul_f32 v16, -1.0, v16
v_mov_b32 v17, v16
v_mov_b32 v19, v18
v_pk_add_f32 v[32:33], v[32:33], v[16:17]
v_pk_add_f32 v[34:35], v[34:35], v[16:17]
v_pk_add_f32 v[36:37], v[36:37], v[16:17]
v_pk_add_f32 v[38:39], v[38:39], v[16:17]
v_pk_add_f32 v[40:41], v[40:41], v[16:17]
v_pk_add_f32 v[42:43], v[42:43], v[16:17]
v_pk_add_f32 v[44:45], v[44:45], v[16:17]
v_pk_add_f32 v[46:47], v[46:47], v[16:17]
v_pk_mul_f32 v[32:33], v[32:33], v[18:19]
v_pk_mul_f32 v[34:35], v[34:35], v[18:19]
v_pk_mul_f32 v[36:37], v[36:37], v[18:19]
v_pk_mul_f32 v[38:39], v[38:39], v[18:19]
v_pk_mul_f32 v[40:41], v[40:41], v[18:19]
v_pk_mul_f32 v[42:43], v[42:43], v[18:19]
v_pk_mul_f32 v[44:45], v[44:45], v[18:19]
v_pk_mul_f32 v[46:47], v[46:47], v[18:19]
v_cvt_pk_bf16_f32 v20, v32, v33
v_cvt_pk_bf16_f32 v21, v34, v35
v_cvt_pk_bf16_f32 v22, v36, v37
v_cvt_pk_bf16_f32 v23, v38, v39
v_cvt_pk_bf16_f32 v24, v40, v41
v_cvt_pk_bf16_f32 v25, v42, v43
v_cvt_pk_bf16_f32 v26, v44, v45
v_cvt_pk_bf16_f32 v27, v46, v47
buffer_store_dwordx4 v[20:23], v65, s[16:19], s32 offen sc1
buffer_store_dwordx4 v[24:27], v65, s[16:19], s33 offen sc1
s_lshl_b32 s30, s21, 4
s_waitcnt vmcnt(0)
s_barrier
s_add_u32 m0, s28, 83968
s_nop 0
buffer_load_dwordx4 v4, s[12:15], s26 offen offset:0 lds
s_add_u32 m0, s28, 84928
s_nop 0
buffer_load_dwordx4 v4, s[12:15], s26 offen offset:64 lds
s_add_u32 m0, s28, 85888
s_nop 0
buffer_load_dwordx4 v4, s[12:15], s26 offen offset:128 lds
s_add_u32 m0, s28, 87040
s_nop 0
buffer_load_dwordx4 v15, s[12:15], s26 offen offset:0 lds
s_add_u32 s26, s26, 229376
s_add_u32 m0, s28, 118784
s_nop 0
buffer_load_dwordx4 v4, s[12:15], s26 offen offset:0 lds
s_add_u32 m0, s28, 119744
s_nop 0
buffer_load_dwordx4 v4, s[12:15], s26 offen offset:64 lds
s_add_u32 m0, s28, 120704
s_nop 0
buffer_load_dwordx4 v4, s[12:15], s26 offen offset:128 lds
s_add_u32 m0, s28, 121856
s_nop 0
buffer_load_dwordx4 v15, s[12:15], s26 offen offset:0 lds
s_add_u32 s26, s26, 229376
s_cmp_lg_u32 s23, 0
s_cbranch_scc1 L_t_13
s_add_u32 s76, s8, 786432
s_addc_u32 s77, s9, 0
s_and_b32 s77, s77, 0xffff
s_mov_b32 s78, 5505024
s_mov_b32 s79, 0x00020000
s_mov_b32 s3, 786432
s_and_b32 s46, s21, 7
s_lshl_b32 s46, s46, 4
v_and_b32 v124, 15, v12
v_add_u32 v124, s46, v124
v_mul_u32_u24 v124, 6144, v124
v_lshrrev_b32_e64 v125, 4, v12
v_lshl_add_u32 v124, v125, 11, v124
s_lshl_b32 s46, s101, 7
s_lshl_b32 s47, s100, 7
v_mov_b32 v125, s47
v_mov_b32 v126, s46
v_cmp_gt_u32 vcc, 16, v12
v_cndmask_b32 v125, v125, v126, vcc
v_add_u32 v124, v124, v125
v_cmp_gt_u32 vcc, 48, v12
v_bfrev_b32 v126, 2
v_cndmask_b32_e64 v124, v126, v124, vcc
s_branch L_t_14
L_t_13:
s_add_u32 s76, s12, 917504
s_nop 0
s_addc_u32 s77, s13, 0
s_and_b32 s77, s77, 0xffff
s_mov_b32 s78, 6422528
s_mov_b32 s79, 0x00020000
s_mov_b32 s3, 917504
s_and_b32 s46, s21, 7
s_lshl_b32 s46, s46, 4
v_and_b32 v124, 15, v12
v_add_u32 v124, s46, v124
v_mul_u32_u24 v124, 7168, v124
v_lshrrev_b32 v125, 4, v12
v_lshlrev_b32 v125, 7, v125
v_min_u32 v125, 220, v125
s_mul_i32 s46, s22, 224
v_add_u32 v125, s46, v125
v_add_u32 v124, v124, v125
v_cmp_gt_u32 vcc, 48, v12
v_bfrev_b32 v126, 2
v_cndmask_b32_e64 v124, v126, v124, vcc
v_add_u32 v126, 3584, v124
L_t_14:
buffer_load_dword v125, v124, s[76:79], 0 offen
v_add_u32_e64 v124, s3, v124
buffer_load_dword v125, v126, s[76:79], 0 offen
v_add_u32 v126, s3, v126
v_lshrrev_b32 v13, 3, v12
v_lshrrev_b32 v14, 5, v12
v_and_b32 v123, 3, v13
v_lshl_add_u32 v14, v14, 3, v123
v_lshlrev_b32 v14, 12, v14
v_lshrrev_b32 v13, 4, v12
v_and_b32 v123, 7, v12
v_xor_b32 v13, v13, v123
v_lshl_add_u32 v112, v13, 4, v14
v_xor_b32_e64 v113, 64, v112
v_add_u32 v114, 14336, v112
v_add_u32 v115, 78848, v113
v_add_u32 v113, 64512, v113
v_and_b32 v13, 15, v12
v_lshrrev_b32 v14, 1, v13
v_lshrrev_b32 v123, 4, v12
v_xor_b32 v14, v14, v123
v_lshlrev_b32_e64 v14, 4, v14
v_lshl_add_u32 v116, v13, 7, v14
s_and_b32 s36, s20, 3
s_lshl_b32 s36, s36, 12
v_add_u32 v116, s36, v116
v_xor_b32 v117, 64, v116
v_add_u32 v118, 61440, v116
v_add_u32 v119, 61440, v117
s_lshr_b32 s36, s20, 2
s_lshl_b32 s36, s36, 12
s_add_u32 s36, s36, 16384
v_add_u32_e64 v121, s36, v11
v_add_u32 v122, 61440, v121
v_bfe_u32 v13, v12, 2, 2
v_and_b32_e64 v14, 3, v12
v_lshl_add_u32 v13, v13, 3, v14
v_lshlrev_b32 v120, 1, v13
s_barrier
s_waitcnt vmcnt(14)
s_barrier
ds_read_b128 v[16:19], v5 offset:0
ds_read_b128 v[20:23], v5 offset:1024
ds_read_b128 v[24:27], v5 offset:2048
ds_read_b128 v[28:31], v5 offset:3072
ds_read_b64_tr_b16 v[48:49], v7 offset:0
ds_read_b64_tr_b16 v[50:51], v7 offset:256
ds_read_b64_tr_b16 v[52:53], v8 offset:0
ds_read_b64_tr_b16 v[54:55], v8 offset:256
ds_read_b64_tr_b16 v[56:57], v8 offset:11264
ds_read_b64_tr_b16 v[58:59], v8 offset:11520
ds_read_b64_tr_b16 v[60:61], v7 offset:12288
ds_read_b64_tr_b16 v[62:63], v7 offset:12544
ds_read_b64_tr_b16 v[64:65], v8 offset:7168
ds_read_b64_tr_b16 v[66:67], v8 offset:7424
ds_read_b64_tr_b16 v[68:69], v7 offset:8192
ds_read_b64_tr_b16 v[70:71], v7 offset:8448
s_bfe_u32 s41, s2, 0x20003
s_waitcnt vmcnt(10) lgkmcnt(0)
s_barrier
v_mfma_f32_16x16x32_bf16 v[128:131], v[48:51], v[16:19], 0
ds_read_b128 v[32:35], v5 offset:34816
v_mfma_f32_16x16x32_bf16 v[132:135], v[48:51], v[20:23], 0
ds_read_b128 v[36:39], v5 offset:35840
v_mfma_f32_16x16x32_bf16 v[136:139], v[48:51], v[24:27], 0
ds_read_b128 v[40:43], v5 offset:36864
s_add_u32 m0, s28, 14336
v_mfma_f32_16x16x32_bf16 v[140:143], v[48:51], v[28:31], 0
ds_read_b128 v[44:47], v5 offset:37888
buffer_load_dwordx4 v4, s[12:15], s26 offen offset:0 lds
v_mfma_f32_16x16x32_bf16 v[144:147], v[52:55], v[16:19], 0
ds_read_b64_tr_b16 v[76:77], v7 offset:34816
v_mfma_f32_16x16x32_bf16 v[148:151], v[52:55], v[20:23], 0
ds_read_b64_tr_b16 v[78:79], v7 offset:35072
v_mfma_f32_16x16x32_bf16 v[152:155], v[52:55], v[24:27], 0
ds_read_b64_tr_b16 v[80:81], v8 offset:34816
v_mfma_f32_16x16x32_bf16 v[156:159], v[52:55], v[28:31], 0
ds_read_b64_tr_b16 v[82:83], v8 offset:35072
s_add_u32 m0, s28, 15296
v_mfma_f32_16x16x32_bf16 v[160:163], v[16:19], v[56:59], 0
ds_read_b64_tr_b16 v[84:85], v8 offset:46080
buffer_load_dwordx4 v4, s[12:15], s26 offen offset:64 lds
v_mfma_f32_16x16x32_bf16 v[164:167], v[20:23], v[56:59], 0
ds_read_b64_tr_b16 v[86:87], v8 offset:46336
v_mfma_f32_16x16x32_bf16 v[168:171], v[24:27], v[56:59], 0
ds_read_b64_tr_b16 v[88:89], v7 offset:47104
v_mfma_f32_16x16x32_bf16 v[172:175], v[28:31], v[56:59], 0
ds_read_b64_tr_b16 v[90:91], v7 offset:47360
v_mfma_f32_16x16x32_bf16 v[176:179], v[16:19], v[60:63], 0
ds_read_b64_tr_b16 v[92:93], v8 offset:41984
s_add_u32 m0, s28, 16256
v_mfma_f32_16x16x32_bf16 v[180:183], v[20:23], v[60:63], 0
ds_read_b64_tr_b16 v[94:95], v8 offset:42240
buffer_load_dwordx4 v4, s[12:15], s26 offen offset:128 lds
v_mfma_f32_16x16x32_bf16 v[184:187], v[24:27], v[60:63], 0
ds_read_b64_tr_b16 v[96:97], v7 offset:43008
v_mfma_f32_16x16x32_bf16 v[188:191], v[28:31], v[60:63], 0
ds_read_b64_tr_b16 v[98:99], v7 offset:43264
v_mfma_f32_16x16x32_bf16 v[192:195], v[64:67], v[16:19], 0
v_mfma_f32_16x16x32_bf16 v[196:199], v[64:67], v[20:23], 0
s_add_u32 m0, s28, 17408
v_mfma_f32_16x16x32_bf16 v[200:203], v[64:67], v[24:27], 0
buffer_load_dwordx4 v15, s[12:15], s26 offen offset:0 lds
s_add_u32 s26, s26, 229376
v_mfma_f32_16x16x32_bf16 v[204:207], v[64:67], v[28:31], 0
v_mfma_f32_16x16x32_bf16 v[208:211], v[68:71], v[16:19], 0
v_mfma_f32_16x16x32_bf16 v[212:215], v[68:71], v[20:23], 0
v_mfma_f32_16x16x32_bf16 v[216:219], v[68:71], v[24:27], 0
v_mfma_f32_16x16x32_bf16 v[220:223], v[68:71], v[28:31], 0
s_cmp_eq_u32 s41, 0
s_cselect_b32 s40, 0, 0x40000000
v_or_b32 v240, s40, v124
v_or_b32 v241, s40, v126
buffer_load_dword v125, v240, s[76:79], 0 offen
buffer_load_dword v125, v241, s[76:79], 0 offen
s_waitcnt vmcnt(12) lgkmcnt(0)
s_barrier
v_mfma_f32_16x16x32_bf16 v[128:131], v[76:79], v[32:35], v[128:131]
ds_read_b128 v[16:19], v6 offset:0
v_mfma_f32_16x16x32_bf16 v[132:135], v[76:79], v[36:39], v[132:135]
ds_read_b128 v[20:23], v6 offset:1024
v_mfma_f32_16x16x32_bf16 v[136:139], v[76:79], v[40:43], v[136:139]
ds_read_b128 v[24:27], v6 offset:2048
s_add_u32 m0, s28, 49152
v_mfma_f32_16x16x32_bf16 v[140:143], v[76:79], v[44:47], v[140:143]
ds_read_b128 v[28:31], v6 offset:3072
buffer_load_dwordx4 v4, s[12:15], s26 offen offset:0 lds
v_mfma_f32_16x16x32_bf16 v[144:147], v[80:83], v[32:35], v[144:147]
ds_read_b64_tr_b16 v[48:49], v9 offset:0
v_mfma_f32_16x16x32_bf16 v[148:151], v[80:83], v[36:39], v[148:151]
ds_read_b64_tr_b16 v[50:51], v9 offset:256
v_mfma_f32_16x16x32_bf16 v[152:155], v[80:83], v[40:43], v[152:155]
ds_read_b64_tr_b16 v[52:53], v10 offset:0
v_mfma_f32_16x16x32_bf16 v[156:159], v[80:83], v[44:47], v[156:159]
ds_read_b64_tr_b16 v[54:55], v10 offset:256
s_add_u32 m0, s28, 50112
v_mfma_f32_16x16x32_bf16 v[160:163], v[32:35], v[84:87], v[160:163]
ds_read_b64_tr_b16 v[56:57], v10 offset:11264
buffer_load_dwordx4 v4, s[12:15], s26 offen offset:64 lds
v_mfma_f32_16x16x32_bf16 v[164:167], v[36:39], v[84:87], v[164:167]
ds_read_b64_tr_b16 v[58:59], v10 offset:11520
v_mfma_f32_16x16x32_bf16 v[168:171], v[40:43], v[84:87], v[168:171]
ds_read_b64_tr_b16 v[60:61], v9 offset:12288
v_mfma_f32_16x16x32_bf16 v[172:175], v[44:47], v[84:87], v[172:175]
ds_read_b64_tr_b16 v[62:63], v9 offset:12544
v_mfma_f32_16x16x32_bf16 v[176:179], v[32:35], v[88:91], v[176:179]
ds_read_b64_tr_b16 v[64:65], v10 offset:7168
s_add_u32 m0, s28, 51072
v_mfma_f32_16x16x32_bf16 v[180:183], v[36:39], v[88:91], v[180:183]
ds_read_b64_tr_b16 v[66:67], v10 offset:7424
buffer_load_dwordx4 v4, s[12:15], s26 offen offset:128 lds
v_mfma_f32_16x16x32_bf16 v[184:187], v[40:43], v[88:91], v[184:187]
ds_read_b64_tr_b16 v[68:69], v9 offset:8192
v_mfma_f32_16x16x32_bf16 v[188:191], v[44:47], v[88:91], v[188:191]
ds_read_b64_tr_b16 v[70:71], v9 offset:8448
v_mfma_f32_16x16x32_bf16 v[192:195], v[92:95], v[32:35], v[192:195]
v_mfma_f32_16x16x32_bf16 v[196:199], v[92:95], v[36:39], v[196:199]
s_add_u32 m0, s28, 52224
v_mfma_f32_16x16x32_bf16 v[200:203], v[92:95], v[40:43], v[200:203]
buffer_load_dwordx4 v15, s[12:15], s26 offen offset:0 lds
s_add_u32 s26, s26, 229376
v_mfma_f32_16x16x32_bf16 v[204:207], v[92:95], v[44:47], v[204:207]
v_mfma_f32_16x16x32_bf16 v[208:211], v[96:99], v[32:35], v[208:211]
v_mfma_f32_16x16x32_bf16 v[212:215], v[96:99], v[36:39], v[212:215]
v_mfma_f32_16x16x32_bf16 v[216:219], v[96:99], v[40:43], v[216:219]
v_mfma_f32_16x16x32_bf16 v[220:223], v[96:99], v[44:47], v[220:223]
s_cmp_eq_u32 s41, 1
s_cselect_b32 s40, 0, 0x40000000
v_or_b32 v240, s40, v124
v_or_b32 v241, s40, v126
buffer_load_dword v125, v240, s[76:79], 0 offen
buffer_load_dword v125, v241, s[76:79], 0 offen
s_waitcnt vmcnt(14) lgkmcnt(0)
s_barrier
v_mfma_f32_16x16x32_bf16 v[128:131], v[48:51], v[16:19], v[128:131]
ds_read_b128 v[32:35], v6 offset:34816
v_mfma_f32_16x16x32_bf16 v[132:135], v[48:51], v[20:23], v[132:135]
ds_read_b128 v[36:39], v6 offset:35840
v_mfma_f32_16x16x32_bf16 v[136:139], v[48:51], v[24:27], v[136:139]
ds_read_b128 v[40:43], v6 offset:36864
s_add_u32 m0, s28, 83968
v_mfma_f32_16x16x32_bf16 v[140:143], v[48:51], v[28:31], v[140:143]
ds_read_b128 v[44:47], v6 offset:37888
buffer_load_dwordx4 v4, s[12:15], s26 offen offset:0 lds
v_mfma_f32_16x16x32_bf16 v[144:147], v[52:55], v[16:19], v[144:147]
ds_read_b64_tr_b16 v[76:77], v9 offset:34816
v_mfma_f32_16x16x32_bf16 v[148:151], v[52:55], v[20:23], v[148:151]
ds_read_b64_tr_b16 v[78:79], v9 offset:35072
v_mfma_f32_16x16x32_bf16 v[152:155], v[52:55], v[24:27], v[152:155]
ds_read_b64_tr_b16 v[80:81], v10 offset:34816
v_mfma_f32_16x16x32_bf16 v[156:159], v[52:55], v[28:31], v[156:159]
ds_read_b64_tr_b16 v[82:83], v10 offset:35072
s_add_u32 m0, s28, 84928
v_mfma_f32_16x16x32_bf16 v[160:163], v[16:19], v[56:59], v[160:163]
ds_read_b64_tr_b16 v[84:85], v10 offset:46080
buffer_load_dwordx4 v4, s[12:15], s26 offen offset:64 lds
v_mfma_f32_16x16x32_bf16 v[164:167], v[20:23], v[56:59], v[164:167]
ds_read_b64_tr_b16 v[86:87], v10 offset:46336
v_mfma_f32_16x16x32_bf16 v[168:171], v[24:27], v[56:59], v[168:171]
ds_read_b64_tr_b16 v[88:89], v9 offset:47104
v_mfma_f32_16x16x32_bf16 v[172:175], v[28:31], v[56:59], v[172:175]
ds_read_b64_tr_b16 v[90:91], v9 offset:47360
v_mfma_f32_16x16x32_bf16 v[176:179], v[16:19], v[60:63], v[176:179]
ds_read_b64_tr_b16 v[92:93], v10 offset:41984
s_add_u32 m0, s28, 85888
v_mfma_f32_16x16x32_bf16 v[180:183], v[20:23], v[60:63], v[180:183]
ds_read_b64_tr_b16 v[94:95], v10 offset:42240
buffer_load_dwordx4 v4, s[12:15], s26 offen offset:128 lds
v_mfma_f32_16x16x32_bf16 v[184:187], v[24:27], v[60:63], v[184:187]
ds_read_b64_tr_b16 v[96:97], v9 offset:43008
v_mfma_f32_16x16x32_bf16 v[188:191], v[28:31], v[60:63], v[188:191]
ds_read_b64_tr_b16 v[98:99], v9 offset:43264
v_mfma_f32_16x16x32_bf16 v[192:195], v[64:67], v[16:19], v[192:195]
v_mfma_f32_16x16x32_bf16 v[196:199], v[64:67], v[20:23], v[196:199]
s_add_u32 m0, s28, 87040
v_mfma_f32_16x16x32_bf16 v[200:203], v[64:67], v[24:27], v[200:203]
buffer_load_dwordx4 v15, s[12:15], s26 offen offset:0 lds
s_add_u32 s26, s26, 229376
v_mfma_f32_16x16x32_bf16 v[204:207], v[64:67], v[28:31], v[204:207]
v_mfma_f32_16x16x32_bf16 v[208:211], v[68:71], v[16:19], v[208:211]
v_mfma_f32_16x16x32_bf16 v[212:215], v[68:71], v[20:23], v[212:215]
v_mfma_f32_16x16x32_bf16 v[216:219], v[68:71], v[24:27], v[216:219]
v_mfma_f32_16x16x32_bf16 v[220:223], v[68:71], v[28:31], v[220:223]
s_cmp_eq_u32 s41, 2
s_cselect_b32 s40, 0, 0x40000000
v_or_b32 v240, s40, v124
v_or_b32 v241, s40, v126
buffer_load_dword v125, v240, s[76:79], 0 offen
buffer_load_dword v125, v241, s[76:79], 0 offen
s_waitcnt vmcnt(14) lgkmcnt(0)
s_barrier
v_mfma_f32_16x16x32_bf16 v[128:131], v[76:79], v[32:35], v[128:131]
ds_read_b128 v[16:19], v5 offset:0
v_mfma_f32_16x16x32_bf16 v[132:135], v[76:79], v[36:39], v[132:135]
ds_read_b128 v[20:23], v5 offset:1024
v_mfma_f32_16x16x32_bf16 v[136:139], v[76:79], v[40:43], v[136:139]
ds_read_b128 v[24:27], v5 offset:2048
s_add_u32 m0, s28, 118784
v_mfma_f32_16x16x32_bf16 v[140:143], v[76:79], v[44:47], v[140:143]
ds_read_b128 v[28:31], v5 offset:3072
buffer_load_dwordx4 v4, s[12:15], s26 offen offset:0 lds
v_mfma_f32_16x16x32_bf16 v[144:147], v[80:83], v[32:35], v[144:147]
ds_read_b64_tr_b16 v[48:49], v7 offset:0
v_mfma_f32_16x16x32_bf16 v[148:151], v[80:83], v[36:39], v[148:151]
ds_read_b64_tr_b16 v[50:51], v7 offset:256
v_mfma_f32_16x16x32_bf16 v[152:155], v[80:83], v[40:43], v[152:155]
ds_read_b64_tr_b16 v[52:53], v8 offset:0
v_mfma_f32_16x16x32_bf16 v[156:159], v[80:83], v[44:47], v[156:159]
ds_read_b64_tr_b16 v[54:55], v8 offset:256
s_add_u32 m0, s28, 119744
v_mfma_f32_16x16x32_bf16 v[160:163], v[32:35], v[84:87], v[160:163]
ds_read_b64_tr_b16 v[56:57], v8 offset:11264
buffer_load_dwordx4 v4, s[12:15], s26 offen offset:64 lds
v_mfma_f32_16x16x32_bf16 v[164:167], v[36:39], v[84:87], v[164:167]
ds_read_b64_tr_b16 v[58:59], v8 offset:11520
v_mfma_f32_16x16x32_bf16 v[168:171], v[40:43], v[84:87], v[168:171]
ds_read_b64_tr_b16 v[60:61], v7 offset:12288
v_mfma_f32_16x16x32_bf16 v[172:175], v[44:47], v[84:87], v[172:175]
ds_read_b64_tr_b16 v[62:63], v7 offset:12544
v_mfma_f32_16x16x32_bf16 v[176:179], v[32:35], v[88:91], v[176:179]
ds_read_b64_tr_b16 v[64:65], v8 offset:7168
s_add_u32 m0, s28, 120704
v_mfma_f32_16x16x32_bf16 v[180:183], v[36:39], v[88:91], v[180:183]
ds_read_b64_tr_b16 v[66:67], v8 offset:7424
buffer_load_dwordx4 v4, s[12:15], s26 offen offset:128 lds
v_mfma_f32_16x16x32_bf16 v[184:187], v[40:43], v[88:91], v[184:187]
ds_read_b64_tr_b16 v[68:69], v7 offset:8192
v_mfma_f32_16x16x32_bf16 v[188:191], v[44:47], v[88:91], v[188:191]
ds_read_b64_tr_b16 v[70:71], v7 offset:8448
v_mfma_f32_16x16x32_bf16 v[192:195], v[92:95], v[32:35], v[192:195]
v_mfma_f32_16x16x32_bf16 v[196:199], v[92:95], v[36:39], v[196:199]
s_add_u32 m0, s28, 121856
v_mfma_f32_16x16x32_bf16 v[200:203], v[92:95], v[40:43], v[200:203]
buffer_load_dwordx4 v15, s[12:15], s26 offen offset:0 lds
s_add_u32 s26, s26, 229376
v_mfma_f32_16x16x32_bf16 v[204:207], v[92:95], v[44:47], v[204:207]
v_mfma_f32_16x16x32_bf16 v[208:211], v[96:99], v[32:35], v[208:211]
v_mfma_f32_16x16x32_bf16 v[212:215], v[96:99], v[36:39], v[212:215]
v_mfma_f32_16x16x32_bf16 v[216:219], v[96:99], v[40:43], v[216:219]
v_mfma_f32_16x16x32_bf16 v[220:223], v[96:99], v[44:47], v[220:223]
s_cmp_eq_u32 s41, 3
s_cselect_b32 s40, 0, 0x40000000
v_or_b32 v240, s40, v124
v_or_b32 v241, s40, v126
buffer_load_dword v125, v240, s[76:79], 0 offen
buffer_load_dword v125, v241, s[76:79], 0 offen
v_add_u32 v124, s3, v124
v_add_u32_e64 v126, s3, v126
s_mov_b32 s29, 6
L_loop1_2:
s_waitcnt vmcnt(14) lgkmcnt(0)
s_barrier
v_mfma_f32_16x16x32_bf16 v[128:131], v[48:51], v[16:19], v[128:131]
ds_read_b128 v[32:35], v5 offset:34816
v_mfma_f32_16x16x32_bf16 v[132:135], v[48:51], v[20:23], v[132:135]
ds_read_b128 v[36:39], v5 offset:35840
v_mfma_f32_16x16x32_bf16 v[136:139], v[48:51], v[24:27], v[136:139]
ds_read_b128 v[40:43], v5 offset:36864
s_add_u32 m0, s28, 14336
v_mfma_f32_16x16x32_bf16 v[140:143], v[48:51], v[28:31], v[140:143]
ds_read_b128 v[44:47], v5 offset:37888
buffer_load_dwordx4 v4, s[12:15], s26 offen offset:0 lds
v_mfma_f32_16x16x32_bf16 v[144:147], v[52:55], v[16:19], v[144:147]
ds_read_b64_tr_b16 v[76:77], v7 offset:34816
v_mfma_f32_16x16x32_bf16 v[148:151], v[52:55], v[20:23], v[148:151]
ds_read_b64_tr_b16 v[78:79], v7 offset:35072
v_mfma_f32_16x16x32_bf16 v[152:155], v[52:55], v[24:27], v[152:155]
ds_read_b64_tr_b16 v[80:81], v8 offset:34816
v_mfma_f32_16x16x32_bf16 v[156:159], v[52:55], v[28:31], v[156:159]
ds_read_b64_tr_b16 v[82:83], v8 offset:35072
s_add_u32 m0, s28, 15296
v_mfma_f32_16x16x32_bf16 v[160:163], v[16:19], v[56:59], v[160:163]
ds_read_b64_tr_b16 v[84:85], v8 offset:46080
buffer_load_dwordx4 v4, s[12:15], s26 offen offset:64 lds
v_mfma_f32_16x16x32_bf16 v[164:167], v[20:23], v[56:59], v[164:167]
ds_read_b64_tr_b16 v[86:87], v8 offset:46336
v_mfma_f32_16x16x32_bf16 v[168:171], v[24:27], v[56:59], v[168:171]
ds_read_b64_tr_b16 v[88:89], v7 offset:47104
v_mfma_f32_16x16x32_bf16 v[172:175], v[28:31], v[56:59], v[172:175]
ds_read_b64_tr_b16 v[90:91], v7 offset:47360
v_mfma_f32_16x16x32_bf16 v[176:179], v[16:19], v[60:63], v[176:179]
ds_read_b64_tr_b16 v[92:93], v8 offset:41984
s_add_u32 m0, s28, 16256
v_mfma_f32_16x16x32_bf16 v[180:183], v[20:23], v[60:63], v[180:183]
ds_read_b64_tr_b16 v[94:95], v8 offset:42240
buffer_load_dwordx4 v4, s[12:15], s26 offen offset:128 lds
v_mfma_f32_16x16x32_bf16 v[184:187], v[24:27], v[60:63], v[184:187]
ds_read_b64_tr_b16 v[96:97], v7 offset:43008
v_mfma_f32_16x16x32_bf16 v[188:191], v[28:31], v[60:63], v[188:191]
ds_read_b64_tr_b16 v[98:99], v7 offset:43264
v_mfma_f32_16x16x32_bf16 v[192:195], v[64:67], v[16:19], v[192:195]
v_mfma_f32_16x16x32_bf16 v[196:199], v[64:67], v[20:23], v[196:199]
s_add_u32 m0, s28, 17408
v_mfma_f32_16x16x32_bf16 v[200:203], v[64:67], v[24:27], v[200:203]
buffer_load_dwordx4 v15, s[12:15], s26 offen offset:0 lds
s_add_u32 s26, s26, 229376
v_mfma_f32_16x16x32_bf16 v[204:207], v[64:67], v[28:31], v[204:207]
v_mfma_f32_16x16x32_bf16 v[208:211], v[68:71], v[16:19], v[208:211]
v_mfma_f32_16x16x32_bf16 v[212:215], v[68:71], v[20:23], v[212:215]
v_mfma_f32_16x16x32_bf16 v[216:219], v[68:71], v[24:27], v[216:219]
v_mfma_f32_16x16x32_bf16 v[220:223], v[68:71], v[28:31], v[220:223]
s_cmp_eq_u32 s41, 0
s_cselect_b32 s40, 0, 0x40000000
v_or_b32 v240, s40, v124
v_or_b32 v241, s40, v126
buffer_load_dword v125, v240, s[76:79], 0 offen
buffer_load_dword v125, v241, s[76:79], 0 offen
s_waitcnt vmcnt(14) lgkmcnt(0)
s_barrier
v_mfma_f32_16x16x32_bf16 v[128:131], v[76:79], v[32:35], v[128:131]
ds_read_b128 v[16:19], v6 offset:0
v_mfma_f32_16x16x32_bf16 v[132:135], v[76:79], v[36:39], v[132:135]
ds_read_b128 v[20:23], v6 offset:1024
v_mfma_f32_16x16x32_bf16 v[136:139], v[76:79], v[40:43], v[136:139]
ds_read_b128 v[24:27], v6 offset:2048
s_add_u32 m0, s28, 49152
v_mfma_f32_16x16x32_bf16 v[140:143], v[76:79], v[44:47], v[140:143]
ds_read_b128 v[28:31], v6 offset:3072
buffer_load_dwordx4 v4, s[12:15], s26 offen offset:0 lds
v_mfma_f32_16x16x32_bf16 v[144:147], v[80:83], v[32:35], v[144:147]
ds_read_b64_tr_b16 v[48:49], v9 offset:0
v_mfma_f32_16x16x32_bf16 v[148:151], v[80:83], v[36:39], v[148:151]
ds_read_b64_tr_b16 v[50:51], v9 offset:256
v_mfma_f32_16x16x32_bf16 v[152:155], v[80:83], v[40:43], v[152:155]
ds_read_b64_tr_b16 v[52:53], v10 offset:0
v_mfma_f32_16x16x32_bf16 v[156:159], v[80:83], v[44:47], v[156:159]
ds_read_b64_tr_b16 v[54:55], v10 offset:256
s_add_u32 m0, s28, 50112
v_mfma_f32_16x16x32_bf16 v[160:163], v[32:35], v[84:87], v[160:163]
ds_read_b64_tr_b16 v[56:57], v10 offset:11264
buffer_load_dwordx4 v4, s[12:15], s26 offen offset:64 lds
v_mfma_f32_16x16x32_bf16 v[164:167], v[36:39], v[84:87], v[164:167]
ds_read_b64_tr_b16 v[58:59], v10 offset:11520
v_mfma_f32_16x16x32_bf16 v[168:171], v[40:43], v[84:87], v[168:171]
ds_read_b64_tr_b16 v[60:61], v9 offset:12288
v_mfma_f32_16x16x32_bf16 v[172:175], v[44:47], v[84:87], v[172:175]
ds_read_b64_tr_b16 v[62:63], v9 offset:12544
v_mfma_f32_16x16x32_bf16 v[176:179], v[32:35], v[88:91], v[176:179]
ds_read_b64_tr_b16 v[64:65], v10 offset:7168
s_add_u32 m0, s28, 51072
v_mfma_f32_16x16x32_bf16 v[180:183], v[36:39], v[88:91], v[180:183]
ds_read_b64_tr_b16 v[66:67], v10 offset:7424
buffer_load_dwordx4 v4, s[12:15], s26 offen offset:128 lds
v_mfma_f32_16x16x32_bf16 v[184:187], v[40:43], v[88:91], v[184:187]
ds_read_b64_tr_b16 v[68:69], v9 offset:8192
v_mfma_f32_16x16x32_bf16 v[188:191], v[44:47], v[88:91], v[188:191]
ds_read_b64_tr_b16 v[70:71], v9 offset:8448
v_mfma_f32_16x16x32_bf16 v[192:195], v[92:95], v[32:35], v[192:195]
v_mfma_f32_16x16x32_bf16 v[196:199], v[92:95], v[36:39], v[196:199]
s_add_u32 m0, s28, 52224
v_mfma_f32_16x16x32_bf16 v[200:203], v[92:95], v[40:43], v[200:203]
buffer_load_dwordx4 v15, s[12:15], s26 offen offset:0 lds
s_add_u32 s26, s26, 229376
v_mfma_f32_16x16x32_bf16 v[204:207], v[92:95], v[44:47], v[204:207]
v_mfma_f32_16x16x32_bf16 v[208:211], v[96:99], v[32:35], v[208:211]
v_mfma_f32_16x16x32_bf16 v[212:215], v[96:99], v[36:39], v[212:215]
v_mfma_f32_16x16x32_bf16 v[216:219], v[96:99], v[40:43], v[216:219]
v_mfma_f32_16x16x32_bf16 v[220:223], v[96:99], v[44:47], v[220:223]
s_cmp_eq_u32 s41, 1
s_cselect_b32 s40, 0, 0x40000000
v_or_b32 v240, s40, v124
v_or_b32 v241, s40, v126
buffer_load_dword v125, v240, s[76:79], 0 offen
buffer_load_dword v125, v241, s[76:79], 0 offen
s_waitcnt vmcnt(14) lgkmcnt(0)
s_barrier
v_mfma_f32_16x16x32_bf16 v[128:131], v[48:51], v[16:19], v[128:131]
ds_read_b128 v[32:35], v6 offset:34816
v_mfma_f32_16x16x32_bf16 v[132:135], v[48:51], v[20:23], v[132:135]
ds_read_b128 v[36:39], v6 offset:35840
v_mfma_f32_16x16x32_bf16 v[136:139], v[48:51], v[24:27], v[136:139]
ds_read_b128 v[40:43], v6 offset:36864
s_add_u32 m0, s28, 83968
v_mfma_f32_16x16x32_bf16 v[140:143], v[48:51], v[28:31], v[140:143]
ds_read_b128 v[44:47], v6 offset:37888
buffer_load_dwordx4 v4, s[12:15], s26 offen offset:0 lds
v_mfma_f32_16x16x32_bf16 v[144:147], v[52:55], v[16:19], v[144:147]
ds_read_b64_tr_b16 v[76:77], v9 offset:34816
v_mfma_f32_16x16x32_bf16 v[148:151], v[52:55], v[20:23], v[148:151]
ds_read_b64_tr_b16 v[78:79], v9 offset:35072
v_mfma_f32_16x16x32_bf16 v[152:155], v[52:55], v[24:27], v[152:155]
ds_read_b64_tr_b16 v[80:81], v10 offset:34816
v_mfma_f32_16x16x32_bf16 v[156:159], v[52:55], v[28:31], v[156:159]
ds_read_b64_tr_b16 v[82:83], v10 offset:35072
s_add_u32 m0, s28, 84928
v_mfma_f32_16x16x32_bf16 v[160:163], v[16:19], v[56:59], v[160:163]
ds_read_b64_tr_b16 v[84:85], v10 offset:46080
buffer_load_dwordx4 v4, s[12:15], s26 offen offset:64 lds
v_mfma_f32_16x16x32_bf16 v[164:167], v[20:23], v[56:59], v[164:167]
ds_read_b64_tr_b16 v[86:87], v10 offset:46336
v_mfma_f32_16x16x32_bf16 v[168:171], v[24:27], v[56:59], v[168:171]
ds_read_b64_tr_b16 v[88:89], v9 offset:47104
v_mfma_f32_16x16x32_bf16 v[172:175], v[28:31], v[56:59], v[172:175]
ds_read_b64_tr_b16 v[90:91], v9 offset:47360
v_mfma_f32_16x16x32_bf16 v[176:179], v[16:19], v[60:63], v[176:179]
ds_read_b64_tr_b16 v[92:93], v10 offset:41984
s_add_u32 m0, s28, 85888
v_mfma_f32_16x16x32_bf16 v[180:183], v[20:23], v[60:63], v[180:183]
ds_read_b64_tr_b16 v[94:95], v10 offset:42240
buffer_load_dwordx4 v4, s[12:15], s26 offen offset:128 lds
v_mfma_f32_16x16x32_bf16 v[184:187], v[24:27], v[60:63], v[184:187]
ds_read_b64_tr_b16 v[96:97], v9 offset:43008
v_mfma_f32_16x16x32_bf16 v[188:191], v[28:31], v[60:63], v[188:191]
ds_read_b64_tr_b16 v[98:99], v9 offset:43264
v_mfma_f32_16x16x32_bf16 v[192:195], v[64:67], v[16:19], v[192:195]
v_mfma_f32_16x16x32_bf16 v[196:199], v[64:67], v[20:23], v[196:199]
s_add_u32 m0, s28, 87040
v_mfma_f32_16x16x32_bf16 v[200:203], v[64:67], v[24:27], v[200:203]
buffer_load_dwordx4 v15, s[12:15], s26 offen offset:0 lds
s_add_u32 s26, s26, 229376
v_mfma_f32_16x16x32_bf16 v[204:207], v[64:67], v[28:31], v[204:207]
v_mfma_f32_16x16x32_bf16 v[208:211], v[68:71], v[16:19], v[208:211]
v_mfma_f32_16x16x32_bf16 v[212:215], v[68:71], v[20:23], v[212:215]
v_mfma_f32_16x16x32_bf16 v[216:219], v[68:71], v[24:27], v[216:219]
v_mfma_f32_16x16x32_bf16 v[220:223], v[68:71], v[28:31], v[220:223]
s_cmp_eq_u32 s41, 2
s_cselect_b32 s40, 0, 0x40000000
v_or_b32 v240, s40, v124
v_or_b32 v241, s40, v126
buffer_load_dword v125, v240, s[76:79], 0 offen
buffer_load_dword v125, v241, s[76:79], 0 offen
s_waitcnt vmcnt(14) lgkmcnt(0)
s_barrier
v_mfma_f32_16x16x32_bf16 v[128:131], v[76:79], v[32:35], v[128:131]
ds_read_b128 v[16:19], v5 offset:0
v_mfma_f32_16x16x32_bf16 v[132:135], v[76:79], v[36:39], v[132:135]
ds_read_b128 v[20:23], v5 offset:1024
v_mfma_f32_16x16x32_bf16 v[136:139], v[76:79], v[40:43], v[136:139]
ds_read_b128 v[24:27], v5 offset:2048
s_add_u32 m0, s28, 118784
v_mfma_f32_16x16x32_bf16 v[140:143], v[76:79], v[44:47], v[140:143]
ds_read_b128 v[28:31], v5 offset:3072
buffer_load_dwordx4 v4, s[12:15], s26 offen offset:0 lds
v_mfma_f32_16x16x32_bf16 v[144:147], v[80:83], v[32:35], v[144:147]
ds_read_b64_tr_b16 v[48:49], v7 offset:0
v_mfma_f32_16x16x32_bf16 v[148:151], v[80:83], v[36:39], v[148:151]
ds_read_b64_tr_b16 v[50:51], v7 offset:256
v_mfma_f32_16x16x32_bf16 v[152:155], v[80:83], v[40:43], v[152:155]
ds_read_b64_tr_b16 v[52:53], v8 offset:0
v_mfma_f32_16x16x32_bf16 v[156:159], v[80:83], v[44:47], v[156:159]
ds_read_b64_tr_b16 v[54:55], v8 offset:256
s_add_u32 m0, s28, 119744
v_mfma_f32_16x16x32_bf16 v[160:163], v[32:35], v[84:87], v[160:163]
ds_read_b64_tr_b16 v[56:57], v8 offset:11264
buffer_load_dwordx4 v4, s[12:15], s26 offen offset:64 lds
v_mfma_f32_16x16x32_bf16 v[164:167], v[36:39], v[84:87], v[164:167]
ds_read_b64_tr_b16 v[58:59], v8 offset:11520
v_mfma_f32_16x16x32_bf16 v[168:171], v[40:43], v[84:87], v[168:171]
ds_read_b64_tr_b16 v[60:61], v7 offset:12288
v_mfma_f32_16x16x32_bf16 v[172:175], v[44:47], v[84:87], v[172:175]
ds_read_b64_tr_b16 v[62:63], v7 offset:12544
v_mfma_f32_16x16x32_bf16 v[176:179], v[32:35], v[88:91], v[176:179]
ds_read_b64_tr_b16 v[64:65], v8 offset:7168
s_add_u32 m0, s28, 120704
v_mfma_f32_16x16x32_bf16 v[180:183], v[36:39], v[88:91], v[180:183]
ds_read_b64_tr_b16 v[66:67], v8 offset:7424
buffer_load_dwordx4 v4, s[12:15], s26 offen offset:128 lds
v_mfma_f32_16x16x32_bf16 v[184:187], v[40:43], v[88:91], v[184:187]
ds_read_b64_tr_b16 v[68:69], v7 offset:8192
v_mfma_f32_16x16x32_bf16 v[188:191], v[44:47], v[88:91], v[188:191]
ds_read_b64_tr_b16 v[70:71], v7 offset:8448
v_mfma_f32_16x16x32_bf16 v[192:195], v[92:95], v[32:35], v[192:195]
v_mfma_f32_16x16x32_bf16 v[196:199], v[92:95], v[36:39], v[196:199]
s_add_u32 m0, s28, 121856
v_mfma_f32_16x16x32_bf16 v[200:203], v[92:95], v[40:43], v[200:203]
buffer_load_dwordx4 v15, s[12:15], s26 offen offset:0 lds
s_add_u32 s26, s26, 229376
v_mfma_f32_16x16x32_bf16 v[204:207], v[92:95], v[44:47], v[204:207]
v_mfma_f32_16x16x32_bf16 v[208:211], v[96:99], v[32:35], v[208:211]
v_mfma_f32_16x16x32_bf16 v[212:215], v[96:99], v[36:39], v[212:215]
v_mfma_f32_16x16x32_bf16 v[216:219], v[96:99], v[40:43], v[216:219]
v_mfma_f32_16x16x32_bf16 v[220:223], v[96:99], v[44:47], v[220:223]
s_cmp_eq_u32 s41, 3
s_cselect_b32 s40, 0, 0x40000000
v_or_b32 v240, s40, v124
v_or_b32 v241, s40, v126
buffer_load_dword v125, v240, s[76:79], 0 offen
buffer_load_dword v125, v241, s[76:79], 0 offen
v_add_u32 v124, s3, v124
v_add_u32_e64 v126, s3, v126
s_sub_u32 s29, s29, 1
s_cmp_lg_u32 s29, 0
s_cbranch_scc1 L_loop1_2
s_waitcnt vmcnt(8) lgkmcnt(0)
s_barrier
v_mfma_f32_16x16x32_bf16 v[128:131], v[48:51], v[16:19], v[128:131]
ds_read_b128 v[32:35], v5 offset:34816
v_mfma_f32_16x16x32_bf16 v[132:135], v[48:51], v[20:23], v[132:135]
ds_read_b128 v[36:39], v5 offset:35840
v_mfma_f32_16x16x32_bf16 v[136:139], v[48:51], v[24:27], v[136:139]
ds_read_b128 v[40:43], v5 offset:36864
v_mfma_f32_16x16x32_bf16 v[140:143], v[48:51], v[28:31], v[140:143]
ds_read_b128 v[44:47], v5 offset:37888
v_mfma_f32_16x16x32_bf16 v[144:147], v[52:55], v[16:19], v[144:147]
ds_read_b64_tr_b16 v[76:77], v7 offset:34816
v_mfma_f32_16x16x32_bf16 v[148:151], v[52:55], v[20:23], v[148:151]
ds_read_b64_tr_b16 v[78:79], v7 offset:35072
v_mfma_f32_16x16x32_bf16 v[152:155], v[52:55], v[24:27], v[152:155]
ds_read_b64_tr_b16 v[80:81], v8 offset:34816
v_mfma_f32_16x16x32_bf16 v[156:159], v[52:55], v[28:31], v[156:159]
ds_read_b64_tr_b16 v[82:83], v8 offset:35072
v_mfma_f32_16x16x32_bf16 v[160:163], v[16:19], v[56:59], v[160:163]
ds_read_b64_tr_b16 v[84:85], v8 offset:46080
v_mfma_f32_16x16x32_bf16 v[164:167], v[20:23], v[56:59], v[164:167]
ds_read_b64_tr_b16 v[86:87], v8 offset:46336
v_mfma_f32_16x16x32_bf16 v[168:171], v[24:27], v[56:59], v[168:171]
ds_read_b64_tr_b16 v[88:89], v7 offset:47104
v_mfma_f32_16x16x32_bf16 v[172:175], v[28:31], v[56:59], v[172:175]
ds_read_b64_tr_b16 v[90:91], v7 offset:47360
v_mfma_f32_16x16x32_bf16 v[176:179], v[16:19], v[60:63], v[176:179]
ds_read_b64_tr_b16 v[92:93], v8 offset:41984
v_mfma_f32_16x16x32_bf16 v[180:183], v[20:23], v[60:63], v[180:183]
ds_read_b64_tr_b16 v[94:95], v8 offset:42240
v_mfma_f32_16x16x32_bf16 v[184:187], v[24:27], v[60:63], v[184:187]
ds_read_b64_tr_b16 v[96:97], v7 offset:43008
v_mfma_f32_16x16x32_bf16 v[188:191], v[28:31], v[60:63], v[188:191]
ds_read_b64_tr_b16 v[98:99], v7 offset:43264
v_mfma_f32_16x16x32_bf16 v[192:195], v[64:67], v[16:19], v[192:195]
v_mfma_f32_16x16x32_bf16 v[196:199], v[64:67], v[20:23], v[196:199]
v_mfma_f32_16x16x32_bf16 v[200:203], v[64:67], v[24:27], v[200:203]
v_mfma_f32_16x16x32_bf16 v[204:207], v[64:67], v[28:31], v[204:207]
v_mfma_f32_16x16x32_bf16 v[208:211], v[68:71], v[16:19], v[208:211]
v_mfma_f32_16x16x32_bf16 v[212:215], v[68:71], v[20:23], v[212:215]
v_mfma_f32_16x16x32_bf16 v[216:219], v[68:71], v[24:27], v[216:219]
v_mfma_f32_16x16x32_bf16 v[220:223], v[68:71], v[28:31], v[220:223]
s_waitcnt vmcnt(4) lgkmcnt(0)
s_barrier
v_mfma_f32_16x16x32_bf16 v[128:131], v[76:79], v[32:35], v[128:131]
ds_read_b128 v[16:19], v6 offset:0
v_mfma_f32_16x16x32_bf16 v[132:135], v[76:79], v[36:39], v[132:135]
ds_read_b128 v[20:23], v6 offset:1024
v_mfma_f32_16x16x32_bf16 v[136:139], v[76:79], v[40:43], v[136:139]
ds_read_b128 v[24:27], v6 offset:2048
v_mfma_f32_16x16x32_bf16 v[140:143], v[76:79], v[44:47], v[140:143]
ds_read_b128 v[28:31], v6 offset:3072
v_mfma_f32_16x16x32_bf16 v[144:147], v[80:83], v[32:35], v[144:147]
ds_read_b64_tr_b16 v[48:49], v9 offset:0
v_mfma_f32_16x16x32_bf16 v[148:151], v[80:83], v[36:39], v[148:151]
ds_read_b64_tr_b16 v[50:51], v9 offset:256
v_mfma_f32_16x16x32_bf16 v[152:155], v[80:83], v[40:43], v[152:155]
ds_read_b64_tr_b16 v[52:53], v10 offset:0
v_mfma_f32_16x16x32_bf16 v[156:159], v[80:83], v[44:47], v[156:159]
ds_read_b64_tr_b16 v[54:55], v10 offset:256
v_mfma_f32_16x16x32_bf16 v[160:163], v[32:35], v[84:87], v[160:163]
ds_read_b64_tr_b16 v[56:57], v10 offset:11264
v_mfma_f32_16x16x32_bf16 v[164:167], v[36:39], v[84:87], v[164:167]
ds_read_b64_tr_b16 v[58:59], v10 offset:11520
v_mfma_f32_16x16x32_bf16 v[168:171], v[40:43], v[84:87], v[168:171]
ds_read_b64_tr_b16 v[60:61], v9 offset:12288
v_mfma_f32_16x16x32_bf16 v[172:175], v[44:47], v[84:87], v[172:175]
ds_read_b64_tr_b16 v[62:63], v9 offset:12544
v_mfma_f32_16x16x32_bf16 v[176:179], v[32:35], v[88:91], v[176:179]
ds_read_b64_tr_b16 v[64:65], v10 offset:7168
v_mfma_f32_16x16x32_bf16 v[180:183], v[36:39], v[88:91], v[180:183]
ds_read_b64_tr_b16 v[66:67], v10 offset:7424
v_mfma_f32_16x16x32_bf16 v[184:187], v[40:43], v[88:91], v[184:187]
ds_read_b64_tr_b16 v[68:69], v9 offset:8192
v_mfma_f32_16x16x32_bf16 v[188:191], v[44:47], v[88:91], v[188:191]
ds_read_b64_tr_b16 v[70:71], v9 offset:8448
v_mfma_f32_16x16x32_bf16 v[192:195], v[92:95], v[32:35], v[192:195]
v_mfma_f32_16x16x32_bf16 v[196:199], v[92:95], v[36:39], v[196:199]
v_mfma_f32_16x16x32_bf16 v[200:203], v[92:95], v[40:43], v[200:203]
v_mfma_f32_16x16x32_bf16 v[204:207], v[92:95], v[44:47], v[204:207]
v_mfma_f32_16x16x32_bf16 v[208:211], v[96:99], v[32:35], v[208:211]
v_mfma_f32_16x16x32_bf16 v[212:215], v[96:99], v[36:39], v[212:215]
v_mfma_f32_16x16x32_bf16 v[216:219], v[96:99], v[40:43], v[216:219]
v_mfma_f32_16x16x32_bf16 v[220:223], v[96:99], v[44:47], v[220:223]
s_waitcnt vmcnt(0) lgkmcnt(0)
s_barrier
v_mfma_f32_16x16x32_bf16 v[128:131], v[48:51], v[16:19], v[128:131]
ds_read_b128 v[32:35], v6 offset:34816
v_mfma_f32_16x16x32_bf16 v[132:135], v[48:51], v[20:23], v[132:135]
ds_read_b128 v[36:39], v6 offset:35840
v_mfma_f32_16x16x32_bf16 v[136:139], v[48:51], v[24:27], v[136:139]
ds_read_b128 v[40:43], v6 offset:36864
v_mfma_f32_16x16x32_bf16 v[140:143], v[48:51], v[28:31], v[140:143]
ds_read_b128 v[44:47], v6 offset:37888
v_mfma_f32_16x16x32_bf16 v[144:147], v[52:55], v[16:19], v[144:147]
ds_read_b64_tr_b16 v[76:77], v9 offset:34816
v_mfma_f32_16x16x32_bf16 v[148:151], v[52:55], v[20:23], v[148:151]
ds_read_b64_tr_b16 v[78:79], v9 offset:35072
v_mfma_f32_16x16x32_bf16 v[152:155], v[52:55], v[24:27], v[152:155]
ds_read_b64_tr_b16 v[80:81], v10 offset:34816
v_mfma_f32_16x16x32_bf16 v[156:159], v[52:55], v[28:31], v[156:159]
ds_read_b64_tr_b16 v[82:83], v10 offset:35072
v_mfma_f32_16x16x32_bf16 v[160:163], v[16:19], v[56:59], v[160:163]
ds_read_b64_tr_b16 v[84:85], v10 offset:46080
v_mfma_f32_16x16x32_bf16 v[164:167], v[20:23], v[56:59], v[164:167]
ds_read_b64_tr_b16 v[86:87], v10 offset:46336
v_mfma_f32_16x16x32_bf16 v[168:171], v[24:27], v[56:59], v[168:171]
ds_read_b64_tr_b16 v[88:89], v9 offset:47104
v_mfma_f32_16x16x32_bf16 v[172:175], v[28:31], v[56:59], v[172:175]
ds_read_b64_tr_b16 v[90:91], v9 offset:47360
v_mfma_f32_16x16x32_bf16 v[176:179], v[16:19], v[60:63], v[176:179]
ds_read_b64_tr_b16 v[92:93], v10 offset:41984
v_mfma_f32_16x16x32_bf16 v[180:183], v[20:23], v[60:63], v[180:183]
ds_read_b64_tr_b16 v[94:95], v10 offset:42240
v_mfma_f32_16x16x32_bf16 v[184:187], v[24:27], v[60:63], v[184:187]
ds_read_b64_tr_b16 v[96:97], v9 offset:43008
v_mfma_f32_16x16x32_bf16 v[188:191], v[28:31], v[60:63], v[188:191]
ds_read_b64_tr_b16 v[98:99], v9 offset:43264
v_mfma_f32_16x16x32_bf16 v[192:195], v[64:67], v[16:19], v[192:195]
v_mfma_f32_16x16x32_bf16 v[196:199], v[64:67], v[20:23], v[196:199]
v_mfma_f32_16x16x32_bf16 v[200:203], v[64:67], v[24:27], v[200:203]
v_mfma_f32_16x16x32_bf16 v[204:207], v[64:67], v[28:31], v[204:207]
v_mfma_f32_16x16x32_bf16 v[208:211], v[68:71], v[16:19], v[208:211]
v_mfma_f32_16x16x32_bf16 v[212:215], v[68:71], v[20:23], v[212:215]
v_mfma_f32_16x16x32_bf16 v[216:219], v[68:71], v[24:27], v[216:219]
v_mfma_f32_16x16x32_bf16 v[220:223], v[68:71], v[28:31], v[220:223]
s_waitcnt lgkmcnt(0)
s_barrier
v_mfma_f32_16x16x32_bf16 v[128:131], v[76:79], v[32:35], v[128:131]
v_mfma_f32_16x16x32_bf16 v[132:135], v[76:79], v[36:39], v[132:135]
v_mfma_f32_16x16x32_bf16 v[136:139], v[76:79], v[40:43], v[136:139]
v_mfma_f32_16x16x32_bf16 v[140:143], v[76:79], v[44:47], v[140:143]
v_mfma_f32_16x16x32_bf16 v[144:147], v[80:83], v[32:35], v[144:147]
v_mfma_f32_16x16x32_bf16 v[148:151], v[80:83], v[36:39], v[148:151]
v_mfma_f32_16x16x32_bf16 v[152:155], v[80:83], v[40:43], v[152:155]
v_mfma_f32_16x16x32_bf16 v[156:159], v[80:83], v[44:47], v[156:159]
v_mfma_f32_16x16x32_bf16 v[160:163], v[32:35], v[84:87], v[160:163]
v_mfma_f32_16x16x32_bf16 v[164:167], v[36:39], v[84:87], v[164:167]
v_mfma_f32_16x16x32_bf16 v[168:171], v[40:43], v[84:87], v[168:171]
v_mfma_f32_16x16x32_bf16 v[172:175], v[44:47], v[84:87], v[172:175]
v_mfma_f32_16x16x32_bf16 v[176:179], v[32:35], v[88:91], v[176:179]
v_mfma_f32_16x16x32_bf16 v[180:183], v[36:39], v[88:91], v[180:183]
v_mfma_f32_16x16x32_bf16 v[184:187], v[40:43], v[88:91], v[184:187]
v_mfma_f32_16x16x32_bf16 v[188:191], v[44:47], v[88:91], v[188:191]
v_mfma_f32_16x16x32_bf16 v[192:195], v[92:95], v[32:35], v[192:195]
v_mfma_f32_16x16x32_bf16 v[196:199], v[92:95], v[36:39], v[196:199]
v_mfma_f32_16x16x32_bf16 v[200:203], v[92:95], v[40:43], v[200:203]
v_mfma_f32_16x16x32_bf16 v[204:207], v[92:95], v[44:47], v[204:207]
v_mfma_f32_16x16x32_bf16 v[208:211], v[96:99], v[32:35], v[208:211]
v_mfma_f32_16x16x32_bf16 v[212:215], v[96:99], v[36:39], v[212:215]
v_mfma_f32_16x16x32_bf16 v[216:219], v[96:99], v[40:43], v[216:219]
v_mfma_f32_16x16x32_bf16 v[220:223], v[96:99], v[44:47], v[220:223]
s_mov_b32 s42, 0xbdd2d3e8
s_mov_b32 s43, 0xbdd2d3e8
s_mov_b32 s44, 0x3f800000
s_mov_b32 s45, 0x3f800000
s_mov_b32 s46, 0x3fb8aa3b
s_mov_b32 s47, 0x3fb8aa3b
s_mov_b32 s48, 0x358637bd
s_mov_b32 s49, 0x358637bd
v_mov_b32 v12, 0xc0135761
v_mov_b32 v13, 0xc0135761
v_and_b32_e64 v1, 63, v0
v_bfe_u32 v2, v1, 3, 1
v_lshlrev_b32_e64 v2, 9, v2
v_bfe_u32 v3, v1, 2, 1
v_lshl_add_u32 v2, v3, 7, v2
v_lshrrev_b32 v3, 4, v1
v_lshlrev_b32_e64 v5, 5, v3
s_lshl_b32 s30, s23, 8
s_add_u32 s30, s30, 151552
v_add_u32 v5, s30, v5
v_add_u32 v2, v2, v5
s_lshl_b32 s30, s23, 6
v_add_u32 v4, s30, v1
v_lshlrev_b32_e64 v3, 2, v4
v_add_u32 v3, 151552, v3
v_lshlrev_b32 v4, 3, v4
s_lshl_b32 s30, s23, 11
s_add_u32 s30, s30, 122880
v_add_u32_e64 v6, s30, v11
v_pk_mul_f32 v[104:105], v[160:161], v[160:161]
v_pk_mul_f32 v[106:107], v[162:163], v[162:163]
v_pk_mul_f32 v[108:109], v[164:165], v[164:165]
v_pk_mul_f32 v[110:111], v[166:167], v[166:167]
v_pk_fma_f32 v[104:105], v[104:105], s[42:43], v[12:13]
v_pk_fma_f32 v[106:107], v[106:107], s[42:43], v[12:13]
v_pk_fma_f32 v[108:109], v[108:109], s[42:43], v[12:13]
v_pk_fma_f32 v[110:111], v[110:111], s[42:43], v[12:13]
v_pk_mul_f32 v[104:105], v[104:105], v[160:161]
v_pk_mul_f32 v[106:107], v[106:107], v[162:163]
v_pk_mul_f32 v[108:109], v[108:109], v[164:165]
v_pk_mul_f32 v[110:111], v[110:111], v[166:167]
v_exp_f32 v104, v104
v_exp_f32 v105, v105
v_exp_f32 v106, v106
v_exp_f32 v107, v107
v_exp_f32 v108, v108
v_exp_f32 v109, v109
v_exp_f32 v110, v110
v_exp_f32 v111, v111
v_pk_add_f32 v[104:105], v[104:105], s[44:45]
v_pk_add_f32 v[106:107], v[106:107], s[44:45]
v_pk_add_f32 v[108:109], v[108:109], s[44:45]
v_pk_add_f32 v[110:111], v[110:111], s[44:45]
v_rcp_f32 v104, v104
v_rcp_f32 v105, v105
v_rcp_f32 v106, v106
v_rcp_f32 v107, v107
v_rcp_f32 v108, v108
v_rcp_f32 v109, v109
v_rcp_f32 v110, v110
v_rcp_f32 v111, v111
v_pk_mul_f32 v[160:161], v[160:161], v[104:105]
v_pk_mul_f32 v[162:163], v[162:163], v[106:107]
v_pk_mul_f32 v[164:165], v[164:165], v[108:109]
v_pk_mul_f32 v[166:167], v[166:167], v[110:111]
v_pk_mul_f32 v[32:33], v[160:161], v[160:161]
v_pk_mul_f32 v[34:35], v[162:163], v[162:163]
v_pk_mul_f32 v[36:37], v[164:165], v[164:165]
v_pk_mul_f32 v[38:39], v[166:167], v[166:167]
v_pk_mul_f32 v[104:105], v[168:169], v[168:169]
v_pk_mul_f32 v[106:107], v[170:171], v[170:171]
v_pk_mul_f32 v[108:109], v[172:173], v[172:173]
v_pk_mul_f32 v[110:111], v[174:175], v[174:175]
v_pk_fma_f32 v[104:105], v[104:105], s[42:43], v[12:13]
v_pk_fma_f32 v[106:107], v[106:107], s[42:43], v[12:13]
v_pk_fma_f32 v[108:109], v[108:109], s[42:43], v[12:13]
v_pk_fma_f32 v[110:111], v[110:111], s[42:43], v[12:13]
v_pk_mul_f32 v[104:105], v[104:105], v[168:169]
v_pk_mul_f32 v[106:107], v[106:107], v[170:171]
v_pk_mul_f32 v[108:109], v[108:109], v[172:173]
v_pk_mul_f32 v[110:111], v[110:111], v[174:175]
v_exp_f32 v104, v104
v_exp_f32 v105, v105
v_exp_f32 v106, v106
v_exp_f32 v107, v107
v_exp_f32 v108, v108
v_exp_f32 v109, v109
v_exp_f32 v110, v110
v_exp_f32 v111, v111
v_pk_add_f32 v[104:105], v[104:105], s[44:45]
v_pk_add_f32 v[106:107], v[106:107], s[44:45]
v_pk_add_f32 v[108:109], v[108:109], s[44:45]
v_pk_add_f32 v[110:111], v[110:111], s[44:45]
v_rcp_f32 v104, v104
v_rcp_f32 v105, v105
v_rcp_f32 v106, v106
v_rcp_f32 v107, v107
v_rcp_f32 v108, v108
v_rcp_f32 v109, v109
v_rcp_f32 v110, v110
v_rcp_f32 v111, v111
v_pk_mul_f32 v[168:169], v[168:169], v[104:105]
v_pk_mul_f32 v[170:171], v[170:171], v[106:107]
v_pk_mul_f32 v[172:173], v[172:173], v[108:109]
v_pk_mul_f32 v[174:175], v[174:175], v[110:111]
v_pk_mul_f32 v[40:41], v[168:169], v[168:169]
v_pk_mul_f32 v[42:43], v[170:171], v[170:171]
v_pk_mul_f32 v[44:45], v[172:173], v[172:173]
v_pk_mul_f32 v[46:47], v[174:175], v[174:175]
v_pk_mul_f32 v[104:105], v[176:177], v[176:177]
v_pk_mul_f32 v[106:107], v[178:179], v[178:179]
v_pk_mul_f32 v[108:109], v[180:181], v[180:181]
v_pk_mul_f32 v[110:111], v[182:183], v[182:183]
v_pk_fma_f32 v[104:105], v[104:105], s[42:43], v[12:13]
v_pk_fma_f32 v[106:107], v[106:107], s[42:43], v[12:13]
v_pk_fma_f32 v[108:109], v[108:109], s[42:43], v[12:13]
v_pk_fma_f32 v[110:111], v[110:111], s[42:43], v[12:13]
v_pk_mul_f32 v[104:105], v[104:105], v[176:177]
v_pk_mul_f32 v[106:107], v[106:107], v[178:179]
v_pk_mul_f32 v[108:109], v[108:109], v[180:181]
v_pk_mul_f32 v[110:111], v[110:111], v[182:183]
v_exp_f32 v104, v104
v_exp_f32 v105, v105
v_exp_f32 v106, v106
v_exp_f32 v107, v107
v_exp_f32 v108, v108
v_exp_f32 v109, v109
v_exp_f32 v110, v110
v_exp_f32 v111, v111
v_pk_add_f32 v[104:105], v[104:105], s[44:45]
v_pk_add_f32 v[106:107], v[106:107], s[44:45]
v_pk_add_f32 v[108:109], v[108:109], s[44:45]
v_pk_add_f32 v[110:111], v[110:111], s[44:45]
v_rcp_f32 v104, v104
v_rcp_f32 v105, v105
v_rcp_f32 v106, v106
v_rcp_f32 v107, v107
v_rcp_f32 v108, v108
v_rcp_f32 v109, v109
v_rcp_f32 v110, v110
v_rcp_f32 v111, v111
v_pk_mul_f32 v[176:177], v[176:177], v[104:105]
v_pk_mul_f32 v[178:179], v[178:179], v[106:107]
v_pk_mul_f32 v[180:181], v[180:181], v[108:109]
v_pk_mul_f32 v[182:183], v[182:183], v[110:111]
v_pk_add_f32 v[16:17], v[160:161], v[176:177]
v_pk_fma_f32 v[32:33], v[176:177], v[176:177], v[32:33]
v_pk_add_f32 v[18:19], v[162:163], v[178:179]
v_pk_fma_f32 v[34:35], v[178:179], v[178:179], v[34:35]
v_pk_add_f32 v[20:21], v[164:165], v[180:181]
v_pk_fma_f32 v[36:37], v[180:181], v[180:181], v[36:37]
v_pk_add_f32 v[22:23], v[166:167], v[182:183]
v_pk_fma_f32 v[38:39], v[182:183], v[182:183], v[38:39]
v_pk_mul_f32 v[104:105], v[184:185], v[184:185]
v_pk_mul_f32 v[106:107], v[186:187], v[186:187]
v_pk_mul_f32 v[108:109], v[188:189], v[188:189]
v_pk_mul_f32 v[110:111], v[190:191], v[190:191]
v_pk_fma_f32 v[104:105], v[104:105], s[42:43], v[12:13]
v_pk_fma_f32 v[106:107], v[106:107], s[42:43], v[12:13]
v_pk_fma_f32 v[108:109], v[108:109], s[42:43], v[12:13]
v_pk_fma_f32 v[110:111], v[110:111], s[42:43], v[12:13]
v_pk_mul_f32 v[104:105], v[104:105], v[184:185]
v_pk_mul_f32 v[106:107], v[106:107], v[186:187]
v_pk_mul_f32 v[108:109], v[108:109], v[188:189]
v_pk_mul_f32 v[110:111], v[110:111], v[190:191]
v_exp_f32 v104, v104
v_exp_f32 v105, v105
v_exp_f32 v106, v106
v_exp_f32 v107, v107
v_exp_f32 v108, v108
v_exp_f32 v109, v109
v_exp_f32 v110, v110
v_exp_f32 v111, v111
v_pk_add_f32 v[104:105], v[104:105], s[44:45]
v_pk_add_f32 v[106:107], v[106:107], s[44:45]
v_pk_add_f32 v[108:109], v[108:109], s[44:45]
v_pk_add_f32 v[110:111], v[110:111], s[44:45]
v_rcp_f32 v104, v104
v_rcp_f32 v105, v105
v_rcp_f32 v106, v106
v_rcp_f32 v107, v107
v_rcp_f32 v108, v108
v_rcp_f32 v109, v109
v_rcp_f32 v110, v110
v_rcp_f32 v111, v111
v_pk_mul_f32 v[184:185], v[184:185], v[104:105]
v_pk_mul_f32 v[186:187], v[186:187], v[106:107]
v_pk_mul_f32 v[188:189], v[188:189], v[108:109]
v_pk_mul_f32 v[190:191], v[190:191], v[110:111]
v_pk_add_f32 v[24:25], v[168:169], v[184:185]
v_pk_fma_f32 v[40:41], v[184:185], v[184:185], v[40:41]
v_pk_add_f32 v[26:27], v[170:171], v[186:187]
v_pk_fma_f32 v[42:43], v[186:187], v[186:187], v[42:43]
v_pk_add_f32 v[28:29], v[172:173], v[188:189]
v_pk_fma_f32 v[44:45], v[188:189], v[188:189], v[44:45]
v_pk_add_f32 v[30:31], v[174:175], v[190:191]
v_pk_fma_f32 v[46:47], v[190:191], v[190:191], v[46:47]
s_nop 0
s_nop 1
v_add_f32_dpp v16, v16, v16 row_ror:8 row_mask:0xf bank_mask:0x3
v_add_f32_dpp v17, v17, v17 row_ror:8 row_mask:0xf bank_mask:0x3
v_add_f32_dpp v18, v18, v18 row_ror:8 row_mask:0xf bank_mask:0x3
v_add_f32_dpp v19, v19, v19 row_ror:8 row_mask:0xf bank_mask:0x3
v_add_f32_dpp v20, v20, v20 row_ror:8 row_mask:0xf bank_mask:0x3
v_add_f32_dpp v21, v21, v21 row_ror:8 row_mask:0xf bank_mask:0x3
v_add_f32_dpp v22, v22, v22 row_ror:8 row_mask:0xf bank_mask:0x3
v_add_f32_dpp v23, v23, v23 row_ror:8 row_mask:0xf bank_mask:0x3
v_add_f32_dpp v24, v24, v24 row_ror:8 row_mask:0xf bank_mask:0x3
v_add_f32_dpp v25, v25, v25 row_ror:8 row_mask:0xf bank_mask:0x3
v_add_f32_dpp v26, v26, v26 row_ror:8 row_mask:0xf bank_mask:0x3
v_add_f32_dpp v27, v27, v27 row_ror:8 row_mask:0xf bank_mask:0x3
v_add_f32_dpp v28, v28, v28 row_ror:8 row_mask:0xf bank_mask:0x3
v_add_f32_dpp v29, v29, v29 row_ror:8 row_mask:0xf bank_mask:0x3
v_add_f32_dpp v30, v30, v30 row_ror:8 row_mask:0xf bank_mask:0x3
v_add_f32_dpp v31, v31, v31 row_ror:8 row_mask:0xf bank_mask:0x3
v_add_f32_dpp v16, v32, v32 row_ror:8 row_mask:0xf bank_mask:0xc
v_add_f32_dpp v17, v33, v33 row_ror:8 row_mask:0xf bank_mask:0xc
v_add_f32_dpp v18, v34, v34 row_ror:8 row_mask:0xf bank_mask:0xc
v_add_f32_dpp v19, v35, v35 row_ror:8 row_mask:0xf bank_mask:0xc
v_add_f32_dpp v20, v36, v36 row_ror:8 row_mask:0xf bank_mask:0xc
v_add_f32_dpp v21, v37, v37 row_ror:8 row_mask:0xf bank_mask:0xc
v_add_f32_dpp v22, v38, v38 row_ror:8 row_mask:0xf bank_mask:0xc
v_add_f32_dpp v23, v39, v39 row_ror:8 row_mask:0xf bank_mask:0xc
v_add_f32_dpp v24, v40, v40 row_ror:8 row_mask:0xf bank_mask:0xc
v_add_f32_dpp v25, v41, v41 row_ror:8 row_mask:0xf bank_mask:0xc
v_add_f32_dpp v26, v42, v42 row_ror:8 row_mask:0xf bank_mask:0xc
v_add_f32_dpp v27, v43, v43 row_ror:8 row_mask:0xf bank_mask:0xc
v_add_f32_dpp v28, v44, v44 row_ror:8 row_mask:0xf bank_mask:0xc
v_add_f32_dpp v29, v45, v45 row_ror:8 row_mask:0xf bank_mask:0xc
v_add_f32_dpp v30, v46, v46 row_ror:8 row_mask:0xf bank_mask:0xc
v_add_f32_dpp v31, v47, v47 row_ror:8 row_mask:0xf bank_mask:0xc
v_add_f32_dpp v16, v16, v16 row_shl:4 row_mask:0xf bank_mask:0x5
v_add_f32_dpp v17, v17, v17 row_shl:4 row_mask:0xf bank_mask:0x5
v_add_f32_dpp v18, v18, v18 row_shl:4 row_mask:0xf bank_mask:0x5
v_add_f32_dpp v19, v19, v19 row_shl:4 row_mask:0xf bank_mask:0x5
v_add_f32_dpp v20, v20, v20 row_shl:4 row_mask:0xf bank_mask:0x5
v_add_f32_dpp v21, v21, v21 row_shl:4 row_mask:0xf bank_mask:0x5
v_add_f32_dpp v22, v22, v22 row_shl:4 row_mask:0xf bank_mask:0x5
v_add_f32_dpp v23, v23, v23 row_shl:4 row_mask:0xf bank_mask:0x5
v_add_f32_dpp v16, v24, v24 row_shr:4 row_mask:0xf bank_mask:0xa
v_add_f32_dpp v17, v25, v25 row_shr:4 row_mask:0xf bank_mask:0xa
v_add_f32_dpp v18, v26, v26 row_shr:4 row_mask:0xf bank_mask:0xa
v_add_f32_dpp v19, v27, v27 row_shr:4 row_mask:0xf bank_mask:0xa
v_add_f32_dpp v20, v28, v28 row_shr:4 row_mask:0xf bank_mask:0xa
v_add_f32_dpp v21, v29, v29 row_shr:4 row_mask:0xf bank_mask:0xa
v_add_f32_dpp v22, v30, v30 row_shr:4 row_mask:0xf bank_mask:0xa
v_add_f32_dpp v23, v31, v31 row_shr:4 row_mask:0xf bank_mask:0xa
v_add_f32_dpp v16, v16, v16 quad_perm:[1,0,3,2] row_mask:0xf bank_mask:0xf
v_add_f32_dpp v17, v17, v17 quad_perm:[1,0,3,2] row_mask:0xf bank_mask:0xf
v_add_f32_dpp v18, v18, v18 quad_perm:[1,0,3,2] row_mask:0xf bank_mask:0xf
v_add_f32_dpp v19, v19, v19 quad_perm:[1,0,3,2] row_mask:0xf bank_mask:0xf
v_add_f32_dpp v20, v20, v20 quad_perm:[1,0,3,2] row_mask:0xf bank_mask:0xf
v_add_f32_dpp v21, v21, v21 quad_perm:[1,0,3,2] row_mask:0xf bank_mask:0xf
v_add_f32_dpp v22, v22, v22 quad_perm:[1,0,3,2] row_mask:0xf bank_mask:0xf
v_add_f32_dpp v23, v23, v23 quad_perm:[1,0,3,2] row_mask:0xf bank_mask:0xf
v_add_f32_dpp v16, v16, v16 quad_perm:[2,3,0,1] row_mask:0xf bank_mask:0xf
v_add_f32_dpp v17, v17, v17 quad_perm:[2,3,0,1] row_mask:0xf bank_mask:0xf
v_add_f32_dpp v18, v18, v18 quad_perm:[2,3,0,1] row_mask:0xf bank_mask:0xf
v_add_f32_dpp v19, v19, v19 quad_perm:[2,3,0,1] row_mask:0xf bank_mask:0xf
v_add_f32_dpp v20, v20, v20 quad_perm:[2,3,0,1] row_mask:0xf bank_mask:0xf
v_add_f32_dpp v21, v21, v21 quad_perm:[2,3,0,1] row_mask:0xf bank_mask:0xf
v_add_f32_dpp v22, v22, v22 quad_perm:[2,3,0,1] row_mask:0xf bank_mask:0xf
v_add_f32_dpp v23, v23, v23 quad_perm:[2,3,0,1] row_mask:0xf bank_mask:0xf
s_mov_b32 s30, 0x11111111
s_mov_b32 s31, 0x11111111
s_mov_b64 exec, s[30:31]
ds_write_b128 v2, v[16:19] offset:2048
ds_write_b128 v2, v[20:23] offset:2064
s_mov_b64 exec, -1
s_waitcnt lgkmcnt(0)
s_barrier
ds_read2st64_b32 v[16:17], v3 offset0:0 offset1:2
ds_read2st64_b32 v[18:19], v3 offset0:4 offset1:6
ds_read2st64_b32 v[20:21], v3 offset0:8 offset1:10
ds_read2st64_b32 v[22:23], v3 offset0:12 offset1:14
s_lshl_b32 s34, s21, 14
s_add_u32 s34, s34, 46235648
s_lshl_b32 s35, s22, 10
s_add_u32 s35, s35, s34
s_waitcnt lgkmcnt(0)
v_pk_add_f32 v[16:17], v[16:17], v[18:19]
v_pk_add_f32 v[20:21], v[20:21], v[22:23]
v_pk_add_f32 v[16:17], v[16:17], v[20:21]
buffer_store_dwordx2 v[16:17], v4, s[16:19], s35 offen sc1
v_pk_mul_f32 v[104:105], v[128:129], s[46:47]
v_pk_mul_f32 v[106:107], v[130:131], s[46:47]
v_pk_mul_f32 v[108:109], v[144:145], s[46:47]
v_pk_mul_f32 v[110:111], v[146:147], s[46:47]
v_max_f32 v128, 0, v128
v_max_f32 v129, 0, v129
v_max_f32 v130, 0, v130
v_max_f32 v131, 0, v131
v_max_f32 v144, 0, v144
v_max_f32 v145, 0, v145
v_max_f32 v146, 0, v146
v_max_f32 v147, 0, v147
v_exp_f32_e64 v104, v104 clamp
v_exp_f32_e64 v105, v105 clamp
v_exp_f32_e64 v106, v106 clamp
v_exp_f32_e64 v107, v107 clamp
v_exp_f32_e64 v108, v108 clamp
v_exp_f32_e64 v109, v109 clamp
v_exp_f32_e64 v110, v110 clamp
v_exp_f32_e64 v111, v111 clamp
v_pk_add_f32 v[128:129], v[128:129], s[48:49]
v_pk_add_f32 v[130:131], v[130:131], s[48:49]
v_pk_add_f32 v[144:145], v[144:145], s[48:49]
v_pk_add_f32 v[146:147], v[146:147], s[48:49]
v_pk_add_f32 v[128:129], v[128:129], v[104:105]
v_pk_add_f32 v[130:131], v[130:131], v[106:107]
v_pk_add_f32 v[144:145], v[144:145], v[108:109]
v_pk_add_f32 v[146:147], v[146:147], v[110:111]
v_cvt_pk_bf16_f32 v240, v128, v129
v_cvt_pk_bf16_f32 v241, v130, v131
v_cvt_pk_bf16_f32 v242, v144, v145
v_cvt_pk_bf16_f32 v243, v146, v147
v_pk_mul_f32 v[104:105], v[132:133], s[46:47]
v_pk_mul_f32 v[106:107], v[134:135], s[46:47]
v_pk_mul_f32 v[108:109], v[148:149], s[46:47]
v_pk_mul_f32 v[110:111], v[150:151], s[46:47]
v_max_f32 v132, 0, v132
v_max_f32 v133, 0, v133
v_max_f32 v134, 0, v134
v_max_f32 v135, 0, v135
v_max_f32 v148, 0, v148
v_max_f32 v149, 0, v149
v_max_f32 v150, 0, v150
v_max_f32 v151, 0, v151
v_exp_f32_e64 v104, v104 clamp
v_exp_f32_e64 v105, v105 clamp
v_exp_f32_e64 v106, v106 clamp
v_exp_f32_e64 v107, v107 clamp
v_exp_f32_e64 v108, v108 clamp
v_exp_f32_e64 v109, v109 clamp
v_exp_f32_e64 v110, v110 clamp
v_exp_f32_e64 v111, v111 clamp
v_pk_add_f32 v[132:133], v[132:133], s[48:49]
v_pk_add_f32 v[134:135], v[134:135], s[48:49]
v_pk_add_f32 v[148:149], v[148:149], s[48:49]
v_pk_add_f32 v[150:151], v[150:151], s[48:49]
v_pk_add_f32 v[132:133], v[132:133], v[104:105]
v_pk_add_f32 v[134:135], v[134:135], v[106:107]
v_pk_add_f32 v[148:149], v[148:149], v[108:109]
v_pk_add_f32 v[150:151], v[150:151], v[110:111]
v_cvt_pk_bf16_f32 v244, v132, v133
v_cvt_pk_bf16_f32 v245, v134, v135
v_cvt_pk_bf16_f32 v246, v148, v149
v_cvt_pk_bf16_f32 v247, v150, v151
v_pk_mul_f32 v[104:105], v[136:137], s[46:47]
v_pk_mul_f32 v[106:107], v[138:139], s[46:47]
v_pk_mul_f32 v[108:109], v[152:153], s[46:47]
v_pk_mul_f32 v[110:111], v[154:155], s[46:47]
v_max_f32 v136, 0, v136
v_max_f32 v137, 0, v137
v_max_f32 v138, 0, v138
v_max_f32 v139, 0, v139
v_max_f32 v152, 0, v152
v_max_f32 v153, 0, v153
v_max_f32 v154, 0, v154
v_max_f32 v155, 0, v155
v_exp_f32_e64 v104, v104 clamp
v_exp_f32_e64 v105, v105 clamp
v_exp_f32_e64 v106, v106 clamp
v_exp_f32_e64 v107, v107 clamp
v_exp_f32_e64 v108, v108 clamp
v_exp_f32_e64 v109, v109 clamp
v_exp_f32_e64 v110, v110 clamp
v_exp_f32_e64 v111, v111 clamp
v_pk_add_f32 v[136:137], v[136:137], s[48:49]
v_pk_add_f32 v[138:139], v[138:139], s[48:49]
v_pk_add_f32 v[152:153], v[152:153], s[48:49]
v_pk_add_f32 v[154:155], v[154:155], s[48:49]
v_pk_add_f32 v[136:137], v[136:137], v[104:105]
v_pk_add_f32 v[138:139], v[138:139], v[106:107]
v_pk_add_f32 v[152:153], v[152:153], v[108:109]
v_pk_add_f32 v[154:155], v[154:155], v[110:111]
v_cvt_pk_bf16_f32 v248, v136, v137
v_cvt_pk_bf16_f32 v249, v138, v139
v_cvt_pk_bf16_f32 v250, v152, v153
v_cvt_pk_bf16_f32 v251, v154, v155
v_pk_mul_f32 v[104:105], v[140:141], s[46:47]
v_pk_mul_f32 v[106:107], v[142:143], s[46:47]
v_pk_mul_f32 v[108:109], v[156:157], s[46:47]
v_pk_mul_f32 v[110:111], v[158:159], s[46:47]
v_max_f32 v140, 0, v140
v_max_f32 v141, 0, v141
v_max_f32 v142, 0, v142
v_max_f32 v143, 0, v143
v_max_f32 v156, 0, v156
v_max_f32 v157, 0, v157
v_max_f32 v158, 0, v158
v_max_f32 v159, 0, v159
v_exp_f32_e64 v104, v104 clamp
v_exp_f32_e64 v105, v105 clamp
v_exp_f32_e64 v106, v106 clamp
v_exp_f32_e64 v107, v107 clamp
v_exp_f32_e64 v108, v108 clamp
v_exp_f32_e64 v109, v109 clamp
v_exp_f32_e64 v110, v110 clamp
v_exp_f32_e64 v111, v111 clamp
v_pk_add_f32 v[140:141], v[140:141], s[48:49]
v_pk_add_f32 v[142:143], v[142:143], s[48:49]
v_pk_add_f32 v[156:157], v[156:157], s[48:49]
v_pk_add_f32 v[158:159], v[158:159], s[48:49]
v_pk_add_f32 v[140:141], v[140:141], v[104:105]
v_pk_add_f32 v[142:143], v[142:143], v[106:107]
v_pk_add_f32 v[156:157], v[156:157], v[108:109]
v_pk_add_f32 v[158:159], v[158:159], v[110:111]
v_cvt_pk_bf16_f32 v252, v140, v141
v_cvt_pk_bf16_f32 v253, v142, v143
v_cvt_pk_bf16_f32 v254, v156, v157
v_cvt_pk_bf16_f32 v255, v158, v159
s_add_u32 s38, s34, 4096
s_add_u32 s39, s34, 8192
s_add_u32 s40, s34, 12288
s_nop 0
s_mov_b32 s36, 0
L_sp_15:
buffer_load_dwordx2 v[32:33], v4, s[16:19], s34 offen offset:0 sc1
buffer_load_dwordx2 v[34:35], v4, s[16:19], s34 offen offset:1024 sc1
buffer_load_dwordx2 v[36:37], v4, s[16:19], s34 offen offset:2048 sc1
buffer_load_dwordx2 v[38:39], v4, s[16:19], s34 offen offset:3072 sc1
buffer_load_dwordx2 v[40:41], v4, s[16:19], s38 offen offset:0 sc1
buffer_load_dwordx2 v[42:43], v4, s[16:19], s38 offen offset:1024 sc1
buffer_load_dwordx2 v[44:45], v4, s[16:19], s38 offen offset:2048 sc1
buffer_load_dwordx2 v[46:47], v4, s[16:19], s38 offen offset:3072 sc1
buffer_load_dwordx2 v[48:49], v4, s[16:19], s39 offen offset:0 sc1
buffer_load_dwordx2 v[50:51], v4, s[16:19], s39 offen offset:1024 sc1
buffer_load_dwordx2 v[52:53], v4, s[16:19], s39 offen offset:2048 sc1
buffer_load_dwordx2 v[54:55], v4, s[16:19], s39 offen offset:3072 sc1
buffer_load_dwordx2 v[56:57], v4, s[16:19], s40 offen offset:0 sc1
buffer_load_dwordx2 v[58:59], v4, s[16:19], s40 offen offset:1024 sc1
buffer_load_dwordx2 v[60:61], v4, s[16:19], s40 offen offset:2048 sc1
buffer_load_dwordx2 v[62:63], v4, s[16:19], s40 offen offset:3072 sc1
s_add_u32 s36, s36, 1
s_waitcnt vmcnt(0)
v_pk_add_f32 v[32:33], v[32:33], v[48:49]
v_pk_add_f32 v[34:35], v[34:35], v[50:51]
v_pk_add_f32 v[36:37], v[36:37], v[52:53]
v_pk_add_f32 v[38:39], v[38:39], v[54:55]
v_pk_add_f32 v[40:41], v[40:41], v[56:57]
v_pk_add_f32 v[42:43], v[42:43], v[58:59]
v_pk_add_f32 v[44:45], v[44:45], v[60:61]
v_pk_add_f32 v[46:47], v[46:47], v[62:63]
v_pk_add_f32 v[32:33], v[32:33], v[40:41]
v_pk_add_f32 v[34:35], v[34:35], v[42:43]
v_pk_add_f32 v[36:37], v[36:37], v[44:45]
v_pk_add_f32 v[38:39], v[38:39], v[46:47]
v_pk_add_f32 v[32:33], v[32:33], v[36:37]
v_pk_add_f32 v[34:35], v[34:35], v[38:39]
v_pk_add_f32 v[32:33], v[32:33], v[34:35]
v_cmp_u_f32 vcc, v32, v33
s_cmp_ge_u32 s36, 6000
s_cbranch_scc1 L_spx_16
s_cmp_lg_u64 vcc, 0
s_cbranch_scc1 L_sp_15
L_spx_16:
v_mul_f32 v32, 0x3a124925, v32
v_mul_f32 v33, 0x3a124925, v33
v_fma_f32 v33, -v32, v32, v33
v_max_f32_e64 v33, 0, v33
v_add_f32 v33, 0x3727c5ac, v33
v_rsq_f32 v33, v33
s_nop 0
v_mul_f32_e64 v32, -v32, v33
ds_write2st64_b32 v3, v33, v32 offset0:16 offset1:18
s_waitcnt lgkmcnt(0)
s_barrier
ds_read_b128 v[16:19], v5 offset:4096
ds_read_b128 v[32:35], v5 offset:4608
ds_read_b128 v[20:23], v5 offset:4112
ds_read_b128 v[36:39], v5 offset:4624
ds_read_b128 v[24:27], v5 offset:4224
ds_read_b128 v[40:43], v5 offset:4736
ds_read_b128 v[28:31], v5 offset:4240
ds_read_b128 v[44:47], v5 offset:4752
s_lshl_b32 s32, s22, 6
s_lshl_b32 s33, s21, 2
s_add_u32 s32, s32, s33
s_lshl_b32 s33, s23, 1
s_add_u32 s32, s32, s33
s_mul_i32 s32, s32, 7168
s_add_u32 s32, s32, 16777216
s_waitcnt lgkmcnt(0)
v_pk_fma_f32 v[160:161], v[160:161], v[16:17], v[32:33]
v_pk_fma_f32 v[162:163], v[162:163], v[18:19], v[34:35]
v_pk_fma_f32 v[164:165], v[164:165], v[20:21], v[36:37]
v_pk_fma_f32 v[166:167], v[166:167], v[22:23], v[38:39]
s_add_u32 s33, s32, 3072
v_cvt_pk_bf16_f32 v80, v160, v161
v_cvt_pk_bf16_f32 v81, v162, v163
v_cvt_pk_bf16_f32 v82, v164, v165
v_cvt_pk_bf16_f32 v83, v166, v167
buffer_store_dwordx4 v[80:83], v11, s[16:19], s33 offen sc1
v_pk_fma_f32 v[168:169], v[168:169], v[24:25], v[40:41]
v_pk_fma_f32 v[170:171], v[170:171], v[26:27], v[42:43]
v_pk_fma_f32 v[172:173], v[172:173], v[28:29], v[44:45]
v_pk_fma_f32 v[174:175], v[174:175], v[30:31], v[46:47]
s_add_u32 s33, s32, 10240
v_cvt_pk_bf16_f32 v84, v168, v169
v_cvt_pk_bf16_f32 v85, v170, v171
v_cvt_pk_bf16_f32 v86, v172, v173
v_cvt_pk_bf16_f32 v87, v174, v175
buffer_store_dwordx4 v[84:87], v11, s[16:19], s33 offen sc1
v_pk_fma_f32 v[176:177], v[176:177], v[16:17], v[32:33]
v_pk_fma_f32 v[178:179], v[178:179], v[18:19], v[34:35]
v_pk_fma_f32 v[180:181], v[180:181], v[20:21], v[36:37]
v_pk_fma_f32 v[182:183], v[182:183], v[22:23], v[38:39]
s_add_u32 s33, s32, 4096
v_cvt_pk_bf16_f32 v88, v176, v177
v_cvt_pk_bf16_f32 v89, v178, v179
v_cvt_pk_bf16_f32 v90, v180, v181
v_cvt_pk_bf16_f32 v91, v182, v183
buffer_store_dwordx4 v[88:91], v11, s[16:19], s33 offen sc1
v_pk_fma_f32 v[184:185], v[184:185], v[24:25], v[40:41]
v_pk_fma_f32 v[186:187], v[186:187], v[26:27], v[42:43]
v_pk_fma_f32 v[188:189], v[188:189], v[28:29], v[44:45]
v_pk_fma_f32 v[190:191], v[190:191], v[30:31], v[46:47]
s_add_u32 s33, s32, 11264
v_cvt_pk_bf16_f32 v92, v184, v185
v_cvt_pk_bf16_f32 v93, v186, v187
v_cvt_pk_bf16_f32 v94, v188, v189
v_cvt_pk_bf16_f32 v95, v190, v191
buffer_store_dwordx4 v[92:95], v11, s[16:19], s33 offen sc1
v_pk_mul_f32 v[104:105], v[192:193], v[192:193]
v_pk_mul_f32 v[106:107], v[194:195], v[194:195]
v_pk_mul_f32 v[108:109], v[196:197], v[196:197]
v_pk_mul_f32 v[110:111], v[198:199], v[198:199]
v_pk_fma_f32 v[104:105], v[104:105], s[42:43], v[12:13]
v_pk_fma_f32 v[106:107], v[106:107], s[42:43], v[12:13]
v_pk_fma_f32 v[108:109], v[108:109], s[42:43], v[12:13]
v_pk_fma_f32 v[110:111], v[110:111], s[42:43], v[12:13]
v_pk_mul_f32 v[104:105], v[104:105], v[192:193]
v_pk_mul_f32 v[106:107], v[106:107], v[194:195]
v_pk_mul_f32 v[108:109], v[108:109], v[196:197]
v_pk_mul_f32 v[110:111], v[110:111], v[198:199]
v_exp_f32 v104, v104
v_exp_f32 v105, v105
v_exp_f32 v106, v106
v_exp_f32 v107, v107
v_exp_f32 v108, v108
v_exp_f32 v109, v109
v_exp_f32 v110, v110
v_exp_f32 v111, v111
v_pk_add_f32 v[104:105], v[104:105], s[44:45]
v_pk_add_f32 v[106:107], v[106:107], s[44:45]
v_pk_add_f32 v[108:109], v[108:109], s[44:45]
v_pk_add_f32 v[110:111], v[110:111], s[44:45]
v_rcp_f32 v104, v104
v_rcp_f32 v105, v105
v_rcp_f32 v106, v106
v_rcp_f32 v107, v107
v_rcp_f32 v108, v108
v_rcp_f32 v109, v109
v_rcp_f32 v110, v110
v_rcp_f32 v111, v111
v_pk_mul_f32 v[192:193], v[192:193], v[104:105]
v_pk_mul_f32 v[194:195], v[194:195], v[106:107]
v_pk_mul_f32 v[196:197], v[196:197], v[108:109]
v_pk_mul_f32 v[198:199], v[198:199], v[110:111]
v_cvt_pk_bf16_f32 v96, v192, v193
v_cvt_pk_bf16_f32 v97, v194, v195
v_cvt_pk_bf16_f32 v98, v196, v197
v_cvt_pk_bf16_f32 v99, v198, v199
ds_write_b128 v6, v[96:99] offset:12288
v_pk_mul_f32 v[104:105], v[200:201], v[200:201]
v_pk_mul_f32 v[106:107], v[202:203], v[202:203]
v_pk_mul_f32 v[108:109], v[204:205], v[204:205]
v_pk_mul_f32 v[110:111], v[206:207], v[206:207]
v_pk_fma_f32 v[104:105], v[104:105], s[42:43], v[12:13]
v_pk_fma_f32 v[106:107], v[106:107], s[42:43], v[12:13]
v_pk_fma_f32 v[108:109], v[108:109], s[42:43], v[12:13]
v_pk_fma_f32 v[110:111], v[110:111], s[42:43], v[12:13]
v_pk_mul_f32 v[104:105], v[104:105], v[200:201]
v_pk_mul_f32 v[106:107], v[106:107], v[202:203]
v_pk_mul_f32 v[108:109], v[108:109], v[204:205]
v_pk_mul_f32 v[110:111], v[110:111], v[206:207]
v_exp_f32 v104, v104
v_exp_f32 v105, v105
v_exp_f32 v106, v106
v_exp_f32 v107, v107
v_exp_f32 v108, v108
v_exp_f32 v109, v109
v_exp_f32 v110, v110
v_exp_f32 v111, v111
v_pk_add_f32 v[104:105], v[104:105], s[44:45]
v_pk_add_f32 v[106:107], v[106:107], s[44:45]
v_pk_add_f32 v[108:109], v[108:109], s[44:45]
v_pk_add_f32 v[110:111], v[110:111], s[44:45]
v_rcp_f32 v104, v104
v_rcp_f32 v105, v105
v_rcp_f32 v106, v106
v_rcp_f32 v107, v107
v_rcp_f32 v108, v108
v_rcp_f32 v109, v109
v_rcp_f32 v110, v110
v_rcp_f32 v111, v111
v_pk_mul_f32 v[200:201], v[200:201], v[104:105]
v_pk_mul_f32 v[202:203], v[202:203], v[106:107]
v_pk_mul_f32 v[204:205], v[204:205], v[108:109]
v_pk_mul_f32 v[206:207], v[206:207], v[110:111]
v_cvt_pk_bf16_f32 v100, v200, v201
v_cvt_pk_bf16_f32 v101, v202, v203
v_cvt_pk_bf16_f32 v102, v204, v205
v_cvt_pk_bf16_f32 v103, v206, v207
ds_write_b128 v6, v[100:103] offset:13312
s_waitcnt vmcnt(0)
s_barrier
v_pk_mul_f32 v[104:105], v[208:209], v[208:209]
v_pk_mul_f32 v[106:107], v[210:211], v[210:211]
v_pk_mul_f32 v[108:109], v[212:213], v[212:213]
v_pk_mul_f32 v[110:111], v[214:215], v[214:215]
v_pk_fma_f32 v[104:105], v[104:105], s[42:43], v[12:13]
v_pk_fma_f32 v[106:107], v[106:107], s[42:43], v[12:13]
v_pk_fma_f32 v[108:109], v[108:109], s[42:43], v[12:13]
v_pk_fma_f32 v[110:111], v[110:111], s[42:43], v[12:13]
v_pk_mul_f32 v[104:105], v[104:105], v[208:209]
v_pk_mul_f32 v[106:107], v[106:107], v[210:211]
v_pk_mul_f32 v[108:109], v[108:109], v[212:213]
v_pk_mul_f32 v[110:111], v[110:111], v[214:215]
v_exp_f32 v104, v104
v_exp_f32 v105, v105
v_exp_f32 v106, v106
v_exp_f32 v107, v107
v_exp_f32 v108, v108
v_exp_f32 v109, v109
v_exp_f32 v110, v110
v_exp_f32 v111, v111
v_pk_add_f32 v[104:105], v[104:105], s[44:45]
v_pk_add_f32 v[106:107], v[106:107], s[44:45]
v_pk_add_f32 v[108:109], v[108:109], s[44:45]
v_pk_add_f32 v[110:111], v[110:111], s[44:45]
v_rcp_f32 v104, v104
v_rcp_f32 v105, v105
v_rcp_f32 v106, v106
v_rcp_f32 v107, v107
v_rcp_f32 v108, v108
v_rcp_f32 v109, v109
v_rcp_f32 v110, v110
v_rcp_f32 v111, v111
v_pk_mul_f32 v[208:209], v[208:209], v[104:105]
v_pk_mul_f32 v[210:211], v[210:211], v[106:107]
v_pk_mul_f32 v[212:213], v[212:213], v[108:109]
v_pk_mul_f32 v[214:215], v[214:215], v[110:111]
v_cvt_pk_bf16_f32 v96, v208, v209
v_cvt_pk_bf16_f32 v97, v210, v211
v_cvt_pk_bf16_f32 v98, v212, v213
v_cvt_pk_bf16_f32 v99, v214, v215
ds_write_b128 v6, v[96:99] offset:16384
v_pk_mul_f32 v[104:105], v[216:217], v[216:217]
v_pk_mul_f32 v[106:107], v[218:219], v[218:219]
v_pk_mul_f32 v[108:109], v[220:221], v[220:221]
v_pk_mul_f32 v[110:111], v[222:223], v[222:223]
v_pk_fma_f32 v[104:105], v[104:105], s[42:43], v[12:13]
v_pk_fma_f32 v[106:107], v[106:107], s[42:43], v[12:13]
v_pk_fma_f32 v[108:109], v[108:109], s[42:43], v[12:13]
v_pk_fma_f32 v[110:111], v[110:111], s[42:43], v[12:13]
v_pk_mul_f32 v[104:105], v[104:105], v[216:217]
v_pk_mul_f32 v[106:107], v[106:107], v[218:219]
v_pk_mul_f32 v[108:109], v[108:109], v[220:221]
v_pk_mul_f32 v[110:111], v[110:111], v[222:223]
v_exp_f32 v104, v104
v_exp_f32 v105, v105
v_exp_f32 v106, v106
v_exp_f32 v107, v107
v_exp_f32 v108, v108
v_exp_f32 v109, v109
v_exp_f32 v110, v110
v_exp_f32 v111, v111
v_pk_add_f32 v[104:105], v[104:105], s[44:45]
v_pk_add_f32 v[106:107], v[106:107], s[44:45]
v_pk_add_f32 v[108:109], v[108:109], s[44:45]
v_pk_add_f32 v[110:111], v[110:111], s[44:45]
v_rcp_f32 v104, v104
v_rcp_f32 v105, v105
v_rcp_f32 v106, v106
v_rcp_f32 v107, v107
v_rcp_f32 v108, v108
v_rcp_f32 v109, v109
v_rcp_f32 v110, v110
v_rcp_f32 v111, v111
v_pk_mul_f32 v[216:217], v[216:217], v[104:105]
v_pk_mul_f32 v[218:219], v[218:219], v[106:107]
v_pk_mul_f32 v[220:221], v[220:221], v[108:109]
v_pk_mul_f32 v[222:223], v[222:223], v[110:111]
v_cvt_pk_bf16_f32 v100, v216, v217
v_cvt_pk_bf16_f32 v101, v218, v219
v_cvt_pk_bf16_f32 v102, v220, v221
v_cvt_pk_bf16_f32 v103, v222, v223
ds_write_b128 v6, v[100:103] offset:17408
L_r1:
s_and_b32 s23, s20, 3
s_cmp_ge_u32 s20, 3
s_cselect_b32 s36, 1, 0
s_mul_i32 s37, s36, 3
s_sub_u32 s37, s20, s37
s_lshl_b32 s38, s100, 1
s_add_u32 s38, s38, s36
s_mul_i32 s39, s21, 24
s_lshl_b32 s37, s37, 3
s_add_u32 s39, s39, s37
v_lshrrev_b32 v17, 3, v1
v_add_u32 v17, s39, v17
v_and_b32_e64 v18, 7, v1
v_mul_u32_u24 v18, 24576, v18
v_lshl_add_u32 v18, v17, 4, v18
s_mul_i32 s39, s38, 196608
s_add_u32 s39, s39, 37748736
s_mul_i32 s24, s22, 458752
s_add_u32 s24, s24, 16777216
s_and_b32 s27, s20, 1
s_mul_i32 s27, s27, 4096
s_add_u32 s24, s24, s27
s_add_u32 s27, s27, 16384
s_waitcnt lgkmcnt(0)
s_barrier
s_add_u32 m0, s27, 0
s_nop 0
buffer_load_dwordx4 v11, s[16:19], s24 offen offset:0 sc1 lds
buffer_load_dwordx4 v11, s[16:19], s24 offen offset:1024 sc1 lds
buffer_load_dwordx4 v11, s[16:19], s24 offen offset:2048 sc1 lds
buffer_load_dwordx4 v11, s[16:19], s24 offen offset:3072 sc1 lds
s_add_u32 s24, s24, 14336
s_add_u32 m0, s27, 30720
s_nop 0
s_nop 0
buffer_load_dwordx4 v11, s[16:19], s24 offen offset:0 sc1 lds
buffer_load_dwordx4 v11, s[16:19], s24 offen offset:1024 sc1 lds
buffer_load_dwordx4 v11, s[16:19], s24 offen offset:2048 sc1 lds
buffer_load_dwordx4 v11, s[16:19], s24 offen offset:3072 sc1 lds
s_add_u32 s24, s24, 14336
s_add_u32 m0, s27, 61440
s_nop 0
s_nop 0
buffer_load_dwordx4 v11, s[16:19], s24 offen offset:0 sc1 lds
buffer_load_dwordx4 v11, s[16:19], s24 offen offset:1024 sc1 lds
buffer_load_dwordx4 v11, s[16:19], s24 offen offset:2048 sc1 lds
buffer_load_dwordx4 v11, s[16:19], s24 offen offset:3072 sc1 lds
s_add_u32 s24, s24, 14336
s_add_u32 m0, s27, 92160
s_nop 0
s_nop 0
buffer_load_dwordx4 v11, s[16:19], s24 offen offset:0 sc1 lds
buffer_load_dwordx4 v11, s[16:19], s24 offen offset:1024 sc1 lds
buffer_load_dwordx4 v11, s[16:19], s24 offen offset:2048 sc1 lds
buffer_load_dwordx4 v11, s[16:19], s24 offen offset:3072 sc1 lds
s_add_u32 s24, s24, 14336
buffer_load_dwordx4 v[72:75], v18, s[16:19], s39 offen sc1
s_add_u32 s39, s39, 6144
buffer_load_dwordx4 v[76:79], v18, s[16:19], s39 offen sc1
s_add_u32 s39, s39, 6144
buffer_load_dwordx4 v[80:83], v18, s[16:19], s39 offen sc1
s_add_u32 s39, s39, 6144
buffer_load_dwordx4 v[84:87], v18, s[16:19], s39 offen sc1
s_waitcnt vmcnt(16)
s_barrier
ds_read_b128 v[24:27], v116 offset:0
ds_read_b128 v[28:31], v116 offset:2048
ds_read_b128 v[40:43], v121 offset:0
ds_read_b128 v[44:47], v121 offset:1024
ds_read_b128 v[48:51], v121 offset:2048
s_nop 0
s_waitcnt lgkmcnt(0)
ds_read_b128 v[32:35], v117 offset:0
v_mfma_f32_16x16x32_bf16 v[128:131], v[40:43], v[24:27], 0
ds_read_b128 v[36:39], v117 offset:2048
v_mfma_f32_16x16x32_bf16 v[132:135], v[40:43], v[28:31], 0
ds_read_b128 v[56:59], v121 offset:7168
v_mfma_f32_16x16x32_bf16 v[136:139], v[44:47], v[24:27], 0
ds_read_b128 v[60:63], v121 offset:8192
v_mfma_f32_16x16x32_bf16 v[140:143], v[44:47], v[28:31], 0
ds_read_b128 v[64:67], v121 offset:9216
v_mfma_f32_16x16x32_bf16 v[144:147], v[48:51], v[24:27], 0
v_mfma_f32_16x16x32_bf16 v[148:151], v[48:51], v[28:31], 0
s_nop 0
s_mov_b32 s29, 7
L_loop2_1:
s_waitcnt vmcnt(8) lgkmcnt(0)
s_barrier
ds_read_b128 v[24:27], v116 offset:30720
v_mfma_f32_16x16x32_bf16 v[128:131], v[56:59], v[32:35], v[128:131]
ds_read_b128 v[28:31], v116 offset:32768
s_nop 0
s_add_u32 m0, s27, 0
v_mfma_f32_16x16x32_bf16 v[132:135], v[56:59], v[36:39], v[132:135]
ds_read_b128 v[40:43], v121 offset:30720
buffer_load_dwordx4 v11, s[16:19], s24 offen offset:0 sc1 lds
v_mfma_f32_16x16x32_bf16 v[136:139], v[60:63], v[32:35], v[136:139]
ds_read_b128 v[44:47], v121 offset:31744
buffer_load_dwordx4 v11, s[16:19], s24 offen offset:1024 sc1 lds
v_mfma_f32_16x16x32_bf16 v[140:143], v[60:63], v[36:39], v[140:143]
ds_read_b128 v[48:51], v121 offset:32768
v_mfma_f32_16x16x32_bf16 v[144:147], v[64:67], v[32:35], v[144:147]
v_mfma_f32_16x16x32_bf16 v[148:151], v[64:67], v[36:39], v[148:151]
s_nop 0
s_waitcnt lgkmcnt(0)
ds_read_b128 v[32:35], v117 offset:30720
v_mfma_f32_16x16x32_bf16 v[128:131], v[40:43], v[24:27], v[128:131]
ds_read_b128 v[36:39], v117 offset:32768
v_mfma_f32_16x16x32_bf16 v[132:135], v[40:43], v[28:31], v[132:135]
ds_read_b128 v[56:59], v121 offset:37888
buffer_load_dwordx4 v11, s[16:19], s24 offen offset:2048 sc1 lds
v_mfma_f32_16x16x32_bf16 v[136:139], v[44:47], v[24:27], v[136:139]
ds_read_b128 v[60:63], v121 offset:38912
buffer_load_dwordx4 v11, s[16:19], s24 offen offset:3072 sc1 lds
s_add_u32 s24, s24, 14336
v_mfma_f32_16x16x32_bf16 v[140:143], v[44:47], v[28:31], v[140:143]
ds_read_b128 v[64:67], v121 offset:39936
v_mfma_f32_16x16x32_bf16 v[144:147], v[48:51], v[24:27], v[144:147]
v_mfma_f32_16x16x32_bf16 v[148:151], v[48:51], v[28:31], v[148:151]
s_waitcnt vmcnt(8) lgkmcnt(0)
s_barrier
ds_read_b128 v[24:27], v118 offset:0
v_mfma_f32_16x16x32_bf16 v[128:131], v[56:59], v[32:35], v[128:131]
ds_read_b128 v[28:31], v118 offset:2048
s_add_u32 m0, s27, 30720
v_mfma_f32_16x16x32_bf16 v[132:135], v[56:59], v[36:39], v[132:135]
ds_read_b128 v[40:43], v122 offset:0
buffer_load_dwordx4 v11, s[16:19], s24 offen offset:0 sc1 lds
v_mfma_f32_16x16x32_bf16 v[136:139], v[60:63], v[32:35], v[136:139]
ds_read_b128 v[44:47], v122 offset:1024
buffer_load_dwordx4 v11, s[16:19], s24 offen offset:1024 sc1 lds
v_mfma_f32_16x16x32_bf16 v[140:143], v[60:63], v[36:39], v[140:143]
ds_read_b128 v[48:51], v122 offset:2048
v_mfma_f32_16x16x32_bf16 v[144:147], v[64:67], v[32:35], v[144:147]
v_mfma_f32_16x16x32_bf16 v[148:151], v[64:67], v[36:39], v[148:151]
s_nop 0
s_waitcnt lgkmcnt(0)
ds_read_b128 v[32:35], v119 offset:0
v_mfma_f32_16x16x32_bf16 v[128:131], v[40:43], v[24:27], v[128:131]
ds_read_b128 v[36:39], v119 offset:2048
v_mfma_f32_16x16x32_bf16 v[132:135], v[40:43], v[28:31], v[132:135]
ds_read_b128 v[56:59], v122 offset:7168
buffer_load_dwordx4 v11, s[16:19], s24 offen offset:2048 sc1 lds
v_mfma_f32_16x16x32_bf16 v[136:139], v[44:47], v[24:27], v[136:139]
ds_read_b128 v[60:63], v122 offset:8192
buffer_load_dwordx4 v11, s[16:19], s24 offen offset:3072 sc1 lds
s_add_u32 s24, s24, 14336
v_mfma_f32_16x16x32_bf16 v[140:143], v[44:47], v[28:31], v[140:143]
ds_read_b128 v[64:67], v122 offset:9216
v_mfma_f32_16x16x32_bf16 v[144:147], v[48:51], v[24:27], v[144:147]
v_mfma_f32_16x16x32_bf16 v[148:151], v[48:51], v[28:31], v[148:151]
s_waitcnt vmcnt(8) lgkmcnt(0)
s_barrier
ds_read_b128 v[24:27], v118 offset:30720
v_mfma_f32_16x16x32_bf16 v[128:131], v[56:59], v[32:35], v[128:131]
ds_read_b128 v[28:31], v118 offset:32768
s_add_u32 m0, s27, 61440
v_mfma_f32_16x16x32_bf16 v[132:135], v[56:59], v[36:39], v[132:135]
ds_read_b128 v[40:43], v122 offset:30720
buffer_load_dwordx4 v11, s[16:19], s24 offen offset:0 sc1 lds
v_mfma_f32_16x16x32_bf16 v[136:139], v[60:63], v[32:35], v[136:139]
ds_read_b128 v[44:47], v122 offset:31744
buffer_load_dwordx4 v11, s[16:19], s24 offen offset:1024 sc1 lds
v_mfma_f32_16x16x32_bf16 v[140:143], v[60:63], v[36:39], v[140:143]
ds_read_b128 v[48:51], v122 offset:32768
v_mfma_f32_16x16x32_bf16 v[144:147], v[64:67], v[32:35], v[144:147]
v_mfma_f32_16x16x32_bf16 v[148:151], v[64:67], v[36:39], v[148:151]
s_nop 0
s_waitcnt lgkmcnt(0)
ds_read_b128 v[32:35], v119 offset:30720
v_mfma_f32_16x16x32_bf16 v[128:131], v[40:43], v[24:27], v[128:131]
ds_read_b128 v[36:39], v119 offset:32768
v_mfma_f32_16x16x32_bf16 v[132:135], v[40:43], v[28:31], v[132:135]
ds_read_b128 v[56:59], v122 offset:37888
buffer_load_dwordx4 v11, s[16:19], s24 offen offset:2048 sc1 lds
v_mfma_f32_16x16x32_bf16 v[136:139], v[44:47], v[24:27], v[136:139]
ds_read_b128 v[60:63], v122 offset:38912
buffer_load_dwordx4 v11, s[16:19], s24 offen offset:3072 sc1 lds
s_add_u32 s24, s24, 14336
v_mfma_f32_16x16x32_bf16 v[140:143], v[44:47], v[28:31], v[140:143]
ds_read_b128 v[64:67], v122 offset:39936
v_mfma_f32_16x16x32_bf16 v[144:147], v[48:51], v[24:27], v[144:147]
v_mfma_f32_16x16x32_bf16 v[148:151], v[48:51], v[28:31], v[148:151]
s_waitcnt vmcnt(8) lgkmcnt(0)
s_barrier
ds_read_b128 v[24:27], v116 offset:0
v_mfma_f32_16x16x32_bf16 v[128:131], v[56:59], v[32:35], v[128:131]
ds_read_b128 v[28:31], v116 offset:2048
s_add_u32 m0, s27, 92160
v_mfma_f32_16x16x32_bf16 v[132:135], v[56:59], v[36:39], v[132:135]
ds_read_b128 v[40:43], v121 offset:0
buffer_load_dwordx4 v11, s[16:19], s24 offen offset:0 sc1 lds
v_mfma_f32_16x16x32_bf16 v[136:139], v[60:63], v[32:35], v[136:139]
ds_read_b128 v[44:47], v121 offset:1024
buffer_load_dwordx4 v11, s[16:19], s24 offen offset:1024 sc1 lds
v_mfma_f32_16x16x32_bf16 v[140:143], v[60:63], v[36:39], v[140:143]
ds_read_b128 v[48:51], v121 offset:2048
v_mfma_f32_16x16x32_bf16 v[144:147], v[64:67], v[32:35], v[144:147]
v_mfma_f32_16x16x32_bf16 v[148:151], v[64:67], v[36:39], v[148:151]
s_nop 0
s_waitcnt lgkmcnt(0)
ds_read_b128 v[32:35], v117 offset:0
v_mfma_f32_16x16x32_bf16 v[128:131], v[40:43], v[24:27], v[128:131]
ds_read_b128 v[36:39], v117 offset:2048
v_mfma_f32_16x16x32_bf16 v[132:135], v[40:43], v[28:31], v[132:135]
ds_read_b128 v[56:59], v121 offset:7168
buffer_load_dwordx4 v11, s[16:19], s24 offen offset:2048 sc1 lds
v_mfma_f32_16x16x32_bf16 v[136:139], v[44:47], v[24:27], v[136:139]
ds_read_b128 v[60:63], v121 offset:8192
buffer_load_dwordx4 v11, s[16:19], s24 offen offset:3072 sc1 lds
s_add_u32 s24, s24, 14336
v_mfma_f32_16x16x32_bf16 v[140:143], v[44:47], v[28:31], v[140:143]
ds_read_b128 v[64:67], v121 offset:9216
v_mfma_f32_16x16x32_bf16 v[144:147], v[48:51], v[24:27], v[144:147]
v_mfma_f32_16x16x32_bf16 v[148:151], v[48:51], v[28:31], v[148:151]
s_sub_u32 s29, s29, 1
s_cmp_eq_u32 s29, 6
s_cbranch_scc1 L_side1_6
s_cmp_eq_u32 s29, 4
s_cbranch_scc1 L_side1_4
s_cmp_eq_u32 s29, 3
s_cbranch_scc1 L_side1_3
s_cmp_eq_u32 s29, 2
s_cbranch_scc1 L_side1_2
s_cmp_lg_u32 s29, 0
s_cbranch_scc1 L_loop2_1
v_and_b32 v12, 63, v0
s_lshl_b32 s27, s20, 10
v_add_u32 v224, s27, v11
s_lshr_b32 s38, s20, 1
s_lshl_b32 s39, s38, 11
s_and_b32 s30, s20, 1
s_lshl_b32 s31, s30, 3
s_add_u32 s39, s39, s31
v_add_u32 v225, s39, v11
v_lshrrev_b32_e64 v13, 3, v12
v_bfe_u32 v14, v12, 4, 2
v_lshlrev_b32 v14, 1, v14
v_and_b32 v15, 7, v12
v_xor_b32 v14, v14, v15
v_lshlrev_b32 v14, 4, v14
v_lshl_add_u32 v226, v13, 11, v14
s_lshl_b32 s39, s20, 14
v_add_u32 v226, s39, v226
v_bfe_u32 v13, v12, 2, 3
v_lshrrev_b32 v14, 5, v12
v_lshlrev_b32 v14, 10, v14
v_lshl_add_u32 v14, v13, 7, v14
v_lshrrev_b32_e64 v13, 1, v13
v_lshl_add_u32 v14, v13, 5, v14
v_and_b32_e64 v15, 3, v12
v_lshl_add_u32 v227, v15, 3, v14
v_xor_b32 v228, 32, v227
v_xor_b32 v229, 64, v227
v_xor_b32 v230, 96, v227
v_bfe_u32 v13, v12, 2, 2
v_lshl_add_u32 v13, v13, 3, v15
v_lshlrev_b32_e64 v231, 11, v13
v_bfe_u32 v13, v12, 4, 1
v_lshl_add_u32 v231, v13, 5, v231
v_lshrrev_b32_e64 v13, 5, v12
v_lshl_add_u32 v231, v13, 4, v231
s_lshl_b32 s26, s50, 7
s_lshl_b32 s38, s38, 5
s_add_u32 s26, s26, s38
s_lshl_b32 s30, s30, 2
s_add_u32 s26, s26, s30
s_lshl_b32 s26, s26, 11
s_lshl_b32 s40, s51, 7
s_add_u32 s26, s26, s40
s_mul_i32 s24, s50, 720896
s_add_u32 s24, s24, 25165824
s_mov_b32 s25, s40
s_lshl_b32 s41, s50, 11
s_add_u32 s41, s41, 47218688
s_lshr_b32 s30, s2, 3
s_lshl_b32 s30, s30, 3
s_add_u32 s30, s30, s20
s_lshl_b32 s30, s30, 13
s_and_b32 s31, s51, 8
s_add_u32 s31, s31, 3
s_lshl_b32 s31, s31, 7
s_add_u32 s30, s30, s31
v_lshlrev_b32 v232, 11, v12
v_add_u32 v232, s30, v232
v_cmp_gt_u32 vcc, 4, v12
v_bfrev_b32 v233, 1
v_cndmask_b32 v232, v233, v232, vcc
s_lshl_b32 s30, s21, 8
s_lshl_b32 s31, s23, 6
s_add_u32 s30, s30, s31
buffer_load_ushort v88, v120, s[60:63], s30 offen
buffer_load_ushort v90, v120, s[60:63], s30 offen offset:8
s_lshl_b32 s30, s23, 10
s_add_u32 s30, s30, 139264
v_add_u32 v16, s30, v11
buffer_load_dword v233, v232, s[64:67], 0 offen
s_waitcnt vmcnt(11) lgkmcnt(0)
s_barrier
ds_read_b128 v[24:27], v116 offset:30720
v_mfma_f32_16x16x32_bf16 v[128:131], v[56:59], v[32:35], v[128:131]
ds_read_b128 v[28:31], v116 offset:32768
v_mfma_f32_16x16x32_bf16 v[132:135], v[56:59], v[36:39], v[132:135]
ds_read_b128 v[40:43], v121 offset:30720
v_mfma_f32_16x16x32_bf16 v[136:139], v[60:63], v[32:35], v[136:139]
ds_read_b128 v[44:47], v121 offset:31744
v_mfma_f32_16x16x32_bf16 v[140:143], v[60:63], v[36:39], v[140:143]
ds_read_b128 v[48:51], v121 offset:32768
v_mfma_f32_16x16x32_bf16 v[144:147], v[64:67], v[32:35], v[144:147]
v_mfma_f32_16x16x32_bf16 v[148:151], v[64:67], v[36:39], v[148:151]
s_nop 0
s_waitcnt lgkmcnt(0)
ds_read_b128 v[32:35], v117 offset:30720
v_mfma_f32_16x16x32_bf16 v[128:131], v[40:43], v[24:27], v[128:131]
ds_read_b128 v[36:39], v117 offset:32768
v_mfma_f32_16x16x32_bf16 v[132:135], v[40:43], v[28:31], v[132:135]
ds_read_b128 v[56:59], v121 offset:37888
v_mfma_f32_16x16x32_bf16 v[136:139], v[44:47], v[24:27], v[136:139]
ds_read_b128 v[60:63], v121 offset:38912
v_mfma_f32_16x16x32_bf16 v[140:143], v[44:47], v[28:31], v[140:143]
ds_read_b128 v[64:67], v121 offset:39936
v_mfma_f32_16x16x32_bf16 v[144:147], v[48:51], v[24:27], v[144:147]
v_mfma_f32_16x16x32_bf16 v[148:151], v[48:51], v[28:31], v[148:151]
s_waitcnt vmcnt(7) lgkmcnt(0)
s_barrier
ds_read_b128 v[24:27], v118 offset:0
v_mfma_f32_16x16x32_bf16 v[128:131], v[56:59], v[32:35], v[128:131]
ds_read_b128 v[28:31], v118 offset:2048
v_mfma_f32_16x16x32_bf16 v[132:135], v[56:59], v[36:39], v[132:135]
ds_read_b128 v[40:43], v122 offset:0
v_mfma_f32_16x16x32_bf16 v[136:139], v[60:63], v[32:35], v[136:139]
ds_read_b128 v[44:47], v122 offset:1024
v_mfma_f32_16x16x32_bf16 v[140:143], v[60:63], v[36:39], v[140:143]
ds_read_b128 v[48:51], v122 offset:2048
v_mfma_f32_16x16x32_bf16 v[144:147], v[64:67], v[32:35], v[144:147]
v_mfma_f32_16x16x32_bf16 v[148:151], v[64:67], v[36:39], v[148:151]
s_nop 0
s_waitcnt lgkmcnt(0)
ds_read_b128 v[32:35], v119 offset:0
v_mfma_f32_16x16x32_bf16 v[128:131], v[40:43], v[24:27], v[128:131]
ds_read_b128 v[36:39], v119 offset:2048
v_mfma_f32_16x16x32_bf16 v[132:135], v[40:43], v[28:31], v[132:135]
ds_read_b128 v[56:59], v122 offset:7168
v_mfma_f32_16x16x32_bf16 v[136:139], v[44:47], v[24:27], v[136:139]
ds_read_b128 v[60:63], v122 offset:8192
v_mfma_f32_16x16x32_bf16 v[140:143], v[44:47], v[28:31], v[140:143]
ds_read_b128 v[64:67], v122 offset:9216
v_mfma_f32_16x16x32_bf16 v[144:147], v[48:51], v[24:27], v[144:147]
v_mfma_f32_16x16x32_bf16 v[148:151], v[48:51], v[28:31], v[148:151]
s_waitcnt vmcnt(3) lgkmcnt(0)
s_barrier
ds_read_b128 v[24:27], v118 offset:30720
v_mfma_f32_16x16x32_bf16 v[128:131], v[56:59], v[32:35], v[128:131]
ds_read_b128 v[28:31], v118 offset:32768
s_nop 0
s_add_u32 m0, s27, 0
v_mfma_f32_16x16x32_bf16 v[132:135], v[56:59], v[36:39], v[132:135]
ds_read_b128 v[40:43], v122 offset:30720
buffer_load_dwordx4 v226, s[64:67], s25 offen lds
s_add_u32 s25, s25, 131072
v_mfma_f32_16x16x32_bf16 v[136:139], v[60:63], v[32:35], v[136:139]
ds_read_b128 v[44:47], v122 offset:31744
v_mfma_f32_16x16x32_bf16 v[140:143], v[60:63], v[36:39], v[140:143]
ds_read_b128 v[48:51], v122 offset:32768
buffer_load_dwordx4 v[160:163], v224, s[16:19], s24 offen sc1
s_add_u32 s24, s24, 8192
v_mfma_f32_16x16x32_bf16 v[144:147], v[64:67], v[32:35], v[144:147]
v_mfma_f32_16x16x32_bf16 v[148:151], v[64:67], v[36:39], v[148:151]
buffer_load_dwordx4 v[164:167], v224, s[16:19], s24 offen sc1
s_add_u32 s24, s24, 8192
s_nop 0
s_waitcnt lgkmcnt(0)
ds_read_b128 v[32:35], v119 offset:30720
v_mfma_f32_16x16x32_bf16 v[128:131], v[40:43], v[24:27], v[128:131]
ds_read_b128 v[36:39], v119 offset:32768
s_add_u32 m0, s27, 8192
v_mfma_f32_16x16x32_bf16 v[132:135], v[40:43], v[28:31], v[132:135]
ds_read_b128 v[56:59], v122 offset:37888
buffer_load_dwordx4 v226, s[64:67], s25 offen lds
s_add_u32 s25, s25, 131072
v_mfma_f32_16x16x32_bf16 v[136:139], v[44:47], v[24:27], v[136:139]
ds_read_b128 v[60:63], v122 offset:38912
v_mfma_f32_16x16x32_bf16 v[140:143], v[44:47], v[28:31], v[140:143]
ds_read_b128 v[64:67], v122 offset:39936
buffer_load_dwordx4 v[168:171], v224, s[16:19], s24 offen sc1
s_add_u32 s24, s24, 8192
v_mfma_f32_16x16x32_bf16 v[144:147], v[48:51], v[24:27], v[144:147]
v_mfma_f32_16x16x32_bf16 v[148:151], v[48:51], v[28:31], v[148:151]
buffer_load_dwordx4 v[172:175], v224, s[16:19], s24 offen sc1
s_add_u32 s24, s24, 8192
s_nop 0
s_waitcnt lgkmcnt(0)
v_mfma_f32_16x16x32_bf16 v[128:131], v[56:59], v[32:35], v[128:131]
s_add_u32 m0, s27, 16384
v_mfma_f32_16x16x32_bf16 v[132:135], v[56:59], v[36:39], v[132:135]
buffer_load_dwordx4 v226, s[64:67], s25 offen lds
s_add_u32 s25, s25, 131072
v_mfma_f32_16x16x32_bf16 v[136:139], v[60:63], v[32:35], v[136:139]
v_mfma_f32_16x16x32_bf16 v[140:143], v[60:63], v[36:39], v[140:143]
buffer_load_dwordx4 v[176:179], v224, s[16:19], s24 offen sc1
s_add_u32 s24, s24, 8192
v_mfma_f32_16x16x32_bf16 v[144:147], v[64:67], v[32:35], v[144:147]
v_mfma_f32_16x16x32_bf16 v[148:151], v[64:67], v[36:39], v[148:151]
buffer_load_dwordx4 v[180:183], v224, s[16:19], s24 offen sc1
s_add_u32 s24, s24, 8192
ds_read_b128 v[72:75], v16 offset:0
ds_read_b128 v[76:79], v16 offset:4096
ds_read_b128 v[80:83], v16 offset:8192
s_mov_b32 s33, 0xffff0000
s_mul_i32 s30, s21, 720896
s_lshl_b32 s31, s23, 11
s_add_u32 s30, s30, s31
s_add_u32 s30, s30, 25427968
s_lshr_b32 s32, s22, 1
s_mul_i32 s32, s32, 57344
s_add_u32 s30, s30, s32
s_and_b32 s34, s22, 1
s_lshl_b32 s35, s34, 15
s_add_u32 s35, s35, s30
s_add_u32 s35, s35, 16384
s_lshl_b32 s39, s34, 10
s_add_u32 s39, s39, s30
s_add_u32 s39, s39, 24576
s_waitcnt vmcnt(10)
v_lshlrev_b32 v88, 16, v88
v_lshlrev_b32 v90, 16, v90
v_mov_b32 v89, v88
v_mov_b32 v91, v90
s_waitcnt lgkmcnt(0)
v_lshlrev_b32 v92, 16, v72
v_and_b32 v93, s33, v72
v_lshlrev_b32 v94, 16, v73
v_and_b32_e64 v95, s33, v73
v_pk_add_f32 v[128:129], v[128:129], v[88:89]
v_pk_add_f32 v[130:131], v[130:131], v[88:89]
v_pk_mul_f32 v[128:129], v[128:129], v[92:93]
v_pk_mul_f32 v[130:131], v[130:131], v[94:95]
v_lshlrev_b32 v96, 16, v74
v_and_b32 v97, s33, v74
v_lshlrev_b32 v98, 16, v75
v_and_b32 v99, s33, v75
v_pk_add_f32 v[132:133], v[132:133], v[90:91]
v_pk_add_f32 v[134:135], v[134:135], v[90:91]
v_pk_mul_f32 v[132:133], v[132:133], v[96:97]
v_pk_mul_f32 v[134:135], v[134:135], v[98:99]
v_lshlrev_b32 v92, 16, v76
v_and_b32 v93, s33, v76
v_lshlrev_b32 v94, 16, v77
v_and_b32 v95, s33, v77
v_pk_add_f32 v[136:137], v[136:137], v[88:89]
v_pk_add_f32 v[138:139], v[138:139], v[88:89]
v_pk_mul_f32 v[136:137], v[136:137], v[92:93]
v_pk_mul_f32 v[138:139], v[138:139], v[94:95]
v_lshlrev_b32 v96, 16, v78
v_and_b32 v97, s33, v78
v_lshlrev_b32 v98, 16, v79
v_and_b32 v99, s33, v79
v_pk_add_f32 v[140:141], v[140:141], v[90:91]
v_pk_add_f32 v[142:143], v[142:143], v[90:91]
v_pk_mul_f32 v[140:141], v[140:141], v[96:97]
v_pk_mul_f32 v[142:143], v[142:143], v[98:99]
v_cvt_pk_bf16_f32 v48, v128, v129
v_cvt_pk_bf16_f32 v49, v130, v131
v_cvt_pk_bf16_f32 v50, v136, v137
v_cvt_pk_bf16_f32 v51, v138, v139
buffer_store_dwordx4 v[48:51], v11, s[16:19], s35 offen offset:0 sc1
v_cvt_pk_bf16_f32 v52, v132, v133
v_cvt_pk_bf16_f32 v53, v134, v135
v_cvt_pk_bf16_f32 v54, v140, v141
v_cvt_pk_bf16_f32 v55, v142, v143
buffer_store_dwordx4 v[52:55], v11, s[16:19], s35 offen offset:1024 sc1
v_lshlrev_b32 v92, 16, v80
v_and_b32 v93, s33, v80
v_lshlrev_b32 v94, 16, v81
v_and_b32 v95, s33, v81
v_pk_add_f32 v[144:145], v[144:145], v[88:89]
v_pk_add_f32 v[146:147], v[146:147], v[88:89]
v_pk_mul_f32 v[144:145], v[144:145], v[92:93]
v_pk_mul_f32 v[146:147], v[146:147], v[94:95]
v_lshlrev_b32 v96, 16, v82
v_and_b32 v97, s33, v82
v_lshlrev_b32 v98, 16, v83
v_and_b32 v99, s33, v83
v_pk_add_f32 v[148:149], v[148:149], v[90:91]
v_pk_add_f32 v[150:151], v[150:151], v[90:91]
v_pk_mul_f32 v[148:149], v[148:149], v[96:97]
v_pk_mul_f32 v[150:151], v[150:151], v[98:99]
v_cvt_pk_bf16_f32 v56, v144, v145
v_cvt_pk_bf16_f32 v57, v146, v147
v_cvt_pk_bf16_f32 v58, v148, v149
v_cvt_pk_bf16_f32 v59, v150, v151
buffer_store_dwordx4 v[56:59], v11, s[16:19], s39 offen sc1
s_branch L_stage3
L_side1_6:
v_lshrrev_b32 v18, 7, v17
v_lshlrev_b32 v18, 10, v18
v_and_b32 v19, 63, v17
v_lshl_add_u32 v18, v19, 4, v18
v_bfe_u32 v19, v17, 6, 1
v_lshl_add_u32 v18, v19, 3, v18
s_mul_i32 s37, s38, 3072
s_add_u32 s37, s37, 46137344
v_pk_add_f32 v[72:73], v[72:73], v[76:77]
v_pk_add_f32 v[80:81], v[80:81], v[84:85]
v_pk_add_f32 v[74:75], v[74:75], v[78:79]
v_pk_add_f32 v[82:83], v[82:83], v[86:87]
v_pk_add_f32 v[72:73], v[72:73], v[80:81]
v_pk_add_f32 v[74:75], v[74:75], v[82:83]
s_nop 0
s_nop 1
v_add_f32_dpp v72, v72, v72 row_half_mirror row_mask:0xf bank_mask:0xf
v_add_f32_dpp v73, v73, v73 row_half_mirror row_mask:0xf bank_mask:0xf
v_add_f32_dpp v74, v74, v74 row_half_mirror row_mask:0xf bank_mask:0xf
v_add_f32_dpp v75, v75, v75 row_half_mirror row_mask:0xf bank_mask:0xf
s_nop 0
s_nop 1
v_add_f32_dpp v72, v72, v72 quad_perm:[1,0,3,2] row_mask:0xf bank_mask:0xf
v_add_f32_dpp v73, v73, v73 quad_perm:[1,0,3,2] row_mask:0xf bank_mask:0xf
v_add_f32_dpp v74, v74, v74 quad_perm:[1,0,3,2] row_mask:0xf bank_mask:0xf
v_add_f32_dpp v75, v75, v75 quad_perm:[1,0,3,2] row_mask:0xf bank_mask:0xf
s_nop 0
s_nop 1
v_add_f32_dpp v72, v72, v72 quad_perm:[2,3,0,1] row_mask:0xf bank_mask:0xf
v_add_f32_dpp v73, v73, v73 quad_perm:[2,3,0,1] row_mask:0xf bank_mask:0xf
v_add_f32_dpp v74, v74, v74 quad_perm:[2,3,0,1] row_mask:0xf bank_mask:0xf
v_add_f32_dpp v75, v75, v75 quad_perm:[2,3,0,1] row_mask:0xf bank_mask:0xf
v_cvt_pk_bf16_f32 v72, v72, v73
v_cvt_pk_bf16_f32 v73, v74, v75
s_mov_b32 s36, 0x01010101
s_mov_b32 exec_lo, s36
s_mov_b32 exec_hi, s36
buffer_store_dwordx2 v[72:73], v18, s[16:19], s37 offen sc1
s_nop 0
s_mov_b64 exec, -1
s_branch L_loop2_1
L_side1_4:
s_lshl_b32 s38, s101, 1
s_mul_i32 s37, s38, 3072
s_add_u32 s37, s37, 46137344
buffer_load_dwordx4 v[100:103], v11, s[16:19], s37 offen offset:0 sc1
buffer_load_dwordx4 v[104:107], v11, s[16:19], s37 offen offset:1024 sc1
buffer_load_dwordx4 v[108:111], v11, s[16:19], s37 offen offset:2048 sc1
s_branch L_loop2_1
L_side1_3:
s_mov_b32 s36, 0
s_branch L_kvc_19
L_kv_17:
buffer_load_dwordx4 v[100:103], v11, s[16:19], s37 offen offset:0 sc1
buffer_load_dwordx4 v[104:107], v11, s[16:19], s37 offen offset:1024 sc1
buffer_load_dwordx4 v[108:111], v11, s[16:19], s37 offen offset:2048 sc1
s_waitcnt vmcnt(0)
L_kvc_19:
v_max3_u32 v19, v100, v101, v102
v_max3_u32 v19, v19, v103, v104
v_max3_u32 v19, v19, v105, v106
v_max3_u32 v19, v19, v107, v108
v_max3_u32 v19, v19, v109, v110
v_max_u32_e64 v19, v19, v111
v_cmp_eq_u32 vcc, -1, v19
s_add_u32 s36, s36, 1
s_cmp_ge_u32 s36, 6000
s_nop 0
s_cbranch_scc1 L_kvx_18
s_cmp_lg_u64 vcc, 0
s_cbranch_scc1 L_kv_17
L_kvx_18:
v_mfma_f32_16x16x32_bf16 v[160:163], v[100:103], v[240:243], 0
v_mfma_f32_16x16x32_bf16 v[164:167], v[104:107], v[240:243], 0
v_mfma_f32_16x16x32_bf16 v[168:171], v[108:111], v[240:243], 0
v_mfma_f32_16x16x32_bf16 v[172:175], v[100:103], v[244:247], 0
v_mfma_f32_16x16x32_bf16 v[176:179], v[104:107], v[244:247], 0
v_mfma_f32_16x16x32_bf16 v[180:183], v[108:111], v[244:247], 0
v_mfma_f32_16x16x32_bf16 v[184:187], v[100:103], v[248:251], 0
v_mfma_f32_16x16x32_bf16 v[188:191], v[104:107], v[248:251], 0
v_mfma_f32_16x16x32_bf16 v[192:195], v[108:111], v[248:251], 0
v_mfma_f32_16x16x32_bf16 v[196:199], v[100:103], v[252:255], 0
v_mfma_f32_16x16x32_bf16 v[200:203], v[104:107], v[252:255], 0
v_mfma_f32_16x16x32_bf16 v[204:207], v[108:111], v[252:255], 0
s_mul_i32 s30, s21, 720896
s_lshl_b32 s31, s38, 13
s_add_u32 s30, s30, s31
s_and_b32 s31, s20, 1
s_lshl_b32 s31, s31, 12
s_add_u32 s30, s30, s31
s_add_u32 s30, s30, 25165824
s_nop 7
v_add_f32 v168, 0x358637bd, v168
v_add_f32 v180, 0x358637bd, v180
v_add_f32 v192, 0x358637bd, v192
v_add_f32 v204, 0x358637bd, v204
v_rcp_f32 v168, v168
v_rcp_f32 v180, v180
v_rcp_f32 v192, v192
v_rcp_f32 v204, v204
v_mov_b32 v169, v168
v_mov_b32 v181, v180
v_mov_b32 v193, v192
v_mov_b32 v205, v204
v_pk_mul_f32 v[160:161], v[160:161], v[168:169]
v_pk_mul_f32 v[162:163], v[162:163], v[168:169]
v_pk_mul_f32 v[164:165], v[164:165], v[168:169]
v_pk_mul_f32 v[166:167], v[166:167], v[168:169]
v_cvt_pk_bf16_f32 v208, v160, v161
v_cvt_pk_bf16_f32 v209, v162, v163
v_cvt_pk_bf16_f32 v210, v164, v165
v_cvt_pk_bf16_f32 v211, v166, v167
buffer_store_dwordx4 v[208:211], v11, s[16:19], s30 offen offset:0 sc1
v_pk_mul_f32 v[172:173], v[172:173], v[180:181]
v_pk_mul_f32 v[174:175], v[174:175], v[180:181]
v_pk_mul_f32 v[176:177], v[176:177], v[180:181]
v_pk_mul_f32 v[178:179], v[178:179], v[180:181]
v_cvt_pk_bf16_f32 v212, v172, v173
v_cvt_pk_bf16_f32 v213, v174, v175
v_cvt_pk_bf16_f32 v214, v176, v177
v_cvt_pk_bf16_f32 v215, v178, v179
buffer_store_dwordx4 v[212:215], v11, s[16:19], s30 offen offset:1024 sc1
v_pk_mul_f32 v[184:185], v[184:185], v[192:193]
v_pk_mul_f32 v[186:187], v[186:187], v[192:193]
v_pk_mul_f32 v[188:189], v[188:189], v[192:193]
v_pk_mul_f32 v[190:191], v[190:191], v[192:193]
v_cvt_pk_bf16_f32 v216, v184, v185
v_cvt_pk_bf16_f32 v217, v186, v187
v_cvt_pk_bf16_f32 v218, v188, v189
v_cvt_pk_bf16_f32 v219, v190, v191
buffer_store_dwordx4 v[216:219], v11, s[16:19], s30 offen offset:2048 sc1
v_pk_mul_f32 v[196:197], v[196:197], v[204:205]
v_pk_mul_f32 v[198:199], v[198:199], v[204:205]
v_pk_mul_f32 v[200:201], v[200:201], v[204:205]
v_pk_mul_f32 v[202:203], v[202:203], v[204:205]
v_cvt_pk_bf16_f32 v220, v196, v197
v_cvt_pk_bf16_f32 v221, v198, v199
v_cvt_pk_bf16_f32 v222, v200, v201
v_cvt_pk_bf16_f32 v223, v202, v203
buffer_store_dwordx4 v[220:223], v11, s[16:19], s30 offen offset:3072 sc1
s_branch L_loop2_1
L_side1_2:
s_cmp_lg_u32 s20, 4
s_cbranch_scc1 L_loop2_1
s_lshl_b32 s30, s21, 4
s_add_u32 s30, s30, s22
s_lshl_b32 s30, s30, 7
s_add_u32 s30, s30, 47218688
v_mov_b32 v20, 0
v_mov_b32 v21, 0
v_mov_b32 v22, 0
v_mov_b32 v23, 0
s_mov_b64 exec, 0xff
buffer_store_dwordx4 v[20:23], v11, s[16:19], s30 offen sc1
s_mov_b64 exec, -1
s_branch L_loop2_1
L_g3:
s_lshl_b32 s24, s21, 18
s_lshl_b32 s25, s100, 7
s_add_u32 s25, s25, 4096
s_mul_i32 s26, s22, 224
s_lshl_b32 s27, s20, 11
s_mul_i32 s28, s23, 13312
s_lshr_b32 s30, s22, 1
s_and_b32 s31, s22, 1
s_add_u32 m0, s28, 12288
s_nop 0
buffer_load_dwordx4 v3, s[8:11], s25 offen offset:0 lds
s_add_u32 m0, s28, 13248
s_nop 0
buffer_load_dwordx4 v3, s[8:11], s25 offen offset:64 lds
s_add_u32 s25, s25, 196608
s_add_u32 m0, s28, 14848
s_nop 0
buffer_load_dwordx4 v4, s[12:15], s26 offen offset:3584 lds
s_add_u32 m0, s28, 15808
s_nop 0
buffer_load_dwordx4 v4, s[12:15], s26 offen offset:3648 lds
s_add_u32 m0, s28, 16768
s_nop 0
buffer_load_dwordx4 v4, s[12:15], s26 offen offset:3712 lds
s_add_u32 s26, s26, 229376
s_add_u32 m0, s28, 47104
s_nop 0
buffer_load_dwordx4 v3, s[8:11], s25 offen offset:0 lds
s_add_u32 m0, s28, 48064
s_nop 0
buffer_load_dwordx4 v3, s[8:11], s25 offen offset:64 lds
s_add_u32 s25, s25, 196608
s_add_u32 m0, s28, 49664
s_nop 0
buffer_load_dwordx4 v4, s[12:15], s26 offen offset:3584 lds
s_add_u32 m0, s28, 50624
s_nop 0
buffer_load_dwordx4 v4, s[12:15], s26 offen offset:3648 lds
s_add_u32 m0, s28, 51584
s_nop 0
buffer_load_dwordx4 v4, s[12:15], s26 offen offset:3712 lds
s_add_u32 s26, s26, 229376
s_lshl_b32 s32, s21, 18
s_lshl_b32 s33, s30, 10
s_add_u32 s32, s32, s33
s_lshl_b32 s33, s31, 7
s_add_u32 s32, s32, s33
s_lshl_b32 s33, s20, 15
s_add_u32 s32, s32, s33
s_add_u32 s33, s32, 16384
s_mov_b32 s36, 0xffff0000
s_waitcnt vmcnt(10)
v_lshlrev_b32 v32, 16, v16
v_and_b32 v33, s36, v16
v_lshlrev_b32 v34, 16, v17
v_and_b32 v35, s36, v17
v_lshlrev_b32 v36, 16, v18
v_and_b32 v37, s36, v18
v_lshlrev_b32 v38, 16, v19
v_and_b32 v39, s36, v19
v_lshlrev_b32 v40, 16, v20
v_and_b32 v41, s36, v20
v_lshlrev_b32 v42, 16, v21
v_and_b32 v43, s36, v21
v_lshlrev_b32 v44, 16, v22
v_and_b32 v45, s36, v22
v_lshlrev_b32 v46, 16, v23
v_and_b32_e64 v47, s36, v23
v_pk_add_f32 v[66:67], v[32:33], v[34:35]
v_pk_mul_f32 v[68:69], v[32:33], v[32:33]
v_pk_fma_f32 v[68:69], v[34:35], v[34:35], v[68:69]
v_pk_add_f32 v[66:67], v[66:67], v[36:37]
v_pk_fma_f32 v[68:69], v[36:37], v[36:37], v[68:69]
v_pk_add_f32 v[66:67], v[66:67], v[38:39]
v_pk_fma_f32 v[68:69], v[38:39], v[38:39], v[68:69]
v_pk_add_f32 v[66:67], v[66:67], v[40:41]
v_pk_fma_f32 v[68:69], v[40:41], v[40:41], v[68:69]
v_pk_add_f32 v[66:67], v[66:67], v[42:43]
v_pk_fma_f32 v[68:69], v[42:43], v[42:43], v[68:69]
v_pk_add_f32 v[66:67], v[66:67], v[44:45]
v_pk_fma_f32 v[68:69], v[44:45], v[44:45], v[68:69]
v_pk_add_f32 v[66:67], v[66:67], v[46:47]
v_pk_fma_f32 v[68:69], v[46:47], v[46:47], v[68:69]
v_add_f32 v66, v66, v67
v_add_f32_e64 v67, v68, v69
s_nop 1
v_add_f32_dpp v66, v66, v66 row_ror:8 row_mask:0xf bank_mask:0xf
v_add_f32_dpp v67, v67, v67 row_ror:8 row_mask:0xf bank_mask:0xf
v_mov_b32 v68, v66
v_mov_b32 v69, v67
s_nop 1
v_permlane16_swap_b32 v68, v66
v_permlane16_swap_b32 v69, v67
s_nop 1
v_pk_add_f32 v[66:67], v[66:67], v[68:69]
v_mov_b32 v68, v66
v_mov_b32 v69, v67
s_nop 1
v_permlane32_swap_b32 v68, v66
v_permlane32_swap_b32 v69, v67
s_nop 1
v_pk_add_f32 v[66:67], v[66:67], v[68:69]
s_mov_b64 exec, 0xff
ds_write_b64 v62, v[66:67]
s_nop 0
s_mov_b64 exec, -1
s_waitcnt lgkmcnt(0)
s_barrier
ds_read_b128 v[16:19], v63 offset:0
ds_read_b128 v[20:23], v63 offset:16
ds_read_b128 v[24:27], v63 offset:32
ds_read_b128 v[28:31], v63 offset:48
s_nop 0
s_waitcnt lgkmcnt(0)
v_pk_add_f32 v[16:17], v[16:17], v[24:25]
v_pk_add_f32 v[18:19], v[18:19], v[26:27]
v_pk_add_f32 v[20:21], v[20:21], v[28:29]
v_pk_add_f32 v[22:23], v[22:23], v[30:31]
v_pk_add_f32 v[16:17], v[16:17], v[20:21]
v_pk_add_f32 v[18:19], v[18:19], v[22:23]
v_pk_add_f32 v[16:17], v[16:17], v[18:19]
v_mul_f32 v16, 0x3a800000, v16
v_mul_f32 v17, 0x3a800000, v17
v_fma_f32 v17, -v16, v16, v17
v_max_f32_e64 v17, 0, v17
v_add_f32 v17, 0x3727c5ac, v17
v_rsq_f32 v18, v17
v_mul_f32 v16, -1.0, v16
v_mov_b32 v17, v16
v_mov_b32 v19, v18
v_pk_add_f32 v[32:33], v[32:33], v[16:17]
v_pk_add_f32 v[34:35], v[34:35], v[16:17]
v_pk_add_f32 v[36:37], v[36:37], v[16:17]
v_pk_add_f32 v[38:39], v[38:39], v[16:17]
v_pk_add_f32 v[40:41], v[40:41], v[16:17]
v_pk_add_f32 v[42:43], v[42:43], v[16:17]
v_pk_add_f32 v[44:45], v[44:45], v[16:17]
v_pk_add_f32 v[46:47], v[46:47], v[16:17]
v_pk_mul_f32 v[32:33], v[32:33], v[18:19]
v_pk_mul_f32 v[34:35], v[34:35], v[18:19]
v_pk_mul_f32 v[36:37], v[36:37], v[18:19]
v_pk_mul_f32 v[38:39], v[38:39], v[18:19]
v_pk_mul_f32 v[40:41], v[40:41], v[18:19]
v_pk_mul_f32 v[42:43], v[42:43], v[18:19]
v_pk_mul_f32 v[44:45], v[44:45], v[18:19]
v_pk_mul_f32 v[46:47], v[46:47], v[18:19]
v_cvt_pk_bf16_f32 v20, v32, v33
v_cvt_pk_bf16_f32 v21, v34, v35
v_cvt_pk_bf16_f32 v22, v36, v37
v_cvt_pk_bf16_f32 v23, v38, v39
v_cvt_pk_bf16_f32 v24, v40, v41
v_cvt_pk_bf16_f32 v25, v42, v43
v_cvt_pk_bf16_f32 v26, v44, v45
v_cvt_pk_bf16_f32 v27, v46, v47
buffer_store_dwordx4 v[20:23], v65, s[16:19], s32 offen sc1
buffer_store_dwordx4 v[24:27], v65, s[16:19], s33 offen sc1
s_lshl_b32 s30, s21, 4
s_waitcnt vmcnt(0)
s_barrier
s_add_u32 m0, s28, 81920
s_nop 0
buffer_load_dwordx4 v3, s[8:11], s25 offen offset:0 lds
s_add_u32 m0, s28, 82880
s_nop 0
buffer_load_dwordx4 v3, s[8:11], s25 offen offset:64 lds
s_add_u32 s25, s25, 196608
s_add_u32 m0, s28, 84480
s_nop 0
buffer_load_dwordx4 v4, s[12:15], s26 offen offset:3584 lds
s_add_u32 m0, s28, 85440
s_nop 0
buffer_load_dwordx4 v4, s[12:15], s26 offen offset:3648 lds
s_add_u32 m0, s28, 86400
s_nop 0
buffer_load_dwordx4 v4, s[12:15], s26 offen offset:3712 lds
s_add_u32 s26, s26, 229376
s_add_u32 m0, s28, 116736
s_nop 0
buffer_load_dwordx4 v3, s[8:11], s25 offen offset:0 lds
s_add_u32 m0, s28, 117696
s_nop 0
buffer_load_dwordx4 v3, s[8:11], s25 offen offset:64 lds
s_add_u32 s25, s25, 196608
s_add_u32 m0, s28, 119296
s_nop 0
buffer_load_dwordx4 v4, s[12:15], s26 offen offset:3584 lds
s_add_u32 m0, s28, 120256
s_nop 0
buffer_load_dwordx4 v4, s[12:15], s26 offen offset:3648 lds
s_add_u32 m0, s28, 121216
s_nop 0
buffer_load_dwordx4 v4, s[12:15], s26 offen offset:3712 lds
s_add_u32 s26, s26, 229376
s_cmp_lg_u32 s23, 0
s_cbranch_scc1 L_t_20
s_mul_i32 s46, s2, 32768
s_nop 0
s_add_u32 s76, s56, s46
s_addc_u32 s77, s57, 0
s_and_b32 s77, s77, 0xffff
s_mov_b32 s78, 32768
s_mov_b32 s79, 0x00020000
s_mov_b32 s3, 8192
v_min_u32 v124, 63, v12
v_lshlrev_b32 v124, 7, v124
v_subrev_u32 v124, 24576, v124
s_branch L_t_21
L_t_20:
s_mul_i32 s46, s2, 14336
s_nop 0
s_add_u32 s76, s68, s46
s_addc_u32 s77, s69, 0
s_and_b32 s77, s77, 0xffff
s_mov_b32 s78, 14336
s_mov_b32 s79, 0x00020000
s_mov_b32 s3, 8192
v_min_u32 v124, 63, v12
v_lshlrev_b32 v124, 7, v124
v_subrev_u32 v124, 8192, v124
L_t_21:
v_lshrrev_b32 v13, 3, v12
v_lshrrev_b32 v14, 5, v12
v_and_b32_e64 v123, 3, v13
v_lshl_add_u32 v14, v14, 3, v123
v_lshlrev_b32 v14, 12, v14
v_lshrrev_b32 v13, 4, v12
v_and_b32 v123, 7, v12
v_xor_b32 v13, v13, v123
v_lshl_add_u32 v112, v13, 4, v14
v_xor_b32_e64 v113, 64, v112
v_add_u32 v114, 14336, v112
v_add_u32 v115, 78848, v113
v_add_u32 v113, 64512, v113
v_and_b32 v13, 15, v12
v_lshrrev_b32 v14, 1, v13
v_lshrrev_b32 v123, 4, v12
v_xor_b32 v14, v14, v123
v_lshlrev_b32_e64 v14, 4, v14
v_lshl_add_u32 v116, v13, 7, v14
s_and_b32 s36, s20, 3
s_lshl_b32 s36, s36, 12
v_add_u32 v116, s36, v116
v_xor_b32 v117, 64, v116
v_add_u32 v118, 61440, v116
v_add_u32 v119, 61440, v117
s_lshr_b32 s36, s20, 2
s_lshl_b32 s36, s36, 12
s_add_u32 s36, s36, 16384
v_add_u32_e64 v121, s36, v11
v_add_u32 v122, 61440, v121
v_bfe_u32 v13, v12, 2, 2
v_and_b32_e64 v14, 3, v12
v_lshl_add_u32 v13, v13, 3, v14
v_lshlrev_b32 v120, 1, v13
s_barrier
s_waitcnt vmcnt(15)
s_barrier
ds_read_b128 v[16:19], v5 offset:0
ds_read_b128 v[20:23], v5 offset:1024
ds_read_b128 v[24:27], v5 offset:2048
ds_read_b128 v[28:31], v5 offset:3072
ds_read_b64_tr_b16 v[48:49], v7 offset:1024
ds_read_b64_tr_b16 v[50:51], v7 offset:1280
ds_read_b64_tr_b16 v[52:53], v8 offset:1024
ds_read_b64_tr_b16 v[54:55], v8 offset:1280
ds_read_b64_tr_b16 v[56:57], v8 offset:12288
ds_read_b64_tr_b16 v[58:59], v8 offset:12544
ds_read_b64_tr_b16 v[60:61], v8 offset:9216
ds_read_b64_tr_b16 v[62:63], v8 offset:9472
ds_read_b64_tr_b16 v[64:65], v8 offset:8192
ds_read_b64_tr_b16 v[66:67], v8 offset:8448
ds_read_b64_tr_b16 v[68:69], v7 offset:9216
ds_read_b64_tr_b16 v[70:71], v7 offset:9472
s_bfe_u32 s41, s2, 0x20003
s_waitcnt vmcnt(10) lgkmcnt(0)
s_barrier
v_mfma_f32_16x16x32_bf16 v[128:131], v[48:51], v[16:19], 0
ds_read_b128 v[32:35], v5 offset:34816
v_mfma_f32_16x16x32_bf16 v[132:135], v[48:51], v[20:23], 0
ds_read_b128 v[36:39], v5 offset:35840
v_mfma_f32_16x16x32_bf16 v[136:139], v[48:51], v[24:27], 0
ds_read_b128 v[40:43], v5 offset:36864
s_add_u32 m0, s28, 12288
v_mfma_f32_16x16x32_bf16 v[140:143], v[48:51], v[28:31], 0
ds_read_b128 v[44:47], v5 offset:37888
buffer_load_dwordx4 v3, s[8:11], s25 offen offset:0 lds
v_mfma_f32_16x16x32_bf16 v[144:147], v[52:55], v[16:19], 0
ds_read_b64_tr_b16 v[76:77], v7 offset:35840
v_mfma_f32_16x16x32_bf16 v[148:151], v[52:55], v[20:23], 0
ds_read_b64_tr_b16 v[78:79], v7 offset:36096
v_mfma_f32_16x16x32_bf16 v[152:155], v[52:55], v[24:27], 0
ds_read_b64_tr_b16 v[80:81], v8 offset:35840
v_mfma_f32_16x16x32_bf16 v[156:159], v[52:55], v[28:31], 0
ds_read_b64_tr_b16 v[82:83], v8 offset:36096
s_add_u32 m0, s28, 13248
v_mfma_f32_16x16x32_bf16 v[160:163], v[16:19], v[56:59], 0
ds_read_b64_tr_b16 v[84:85], v8 offset:47104
buffer_load_dwordx4 v3, s[8:11], s25 offen offset:64 lds
s_add_u32 s25, s25, 196608
v_mfma_f32_16x16x32_bf16 v[164:167], v[20:23], v[56:59], 0
ds_read_b64_tr_b16 v[86:87], v8 offset:47360
v_mfma_f32_16x16x32_bf16 v[168:171], v[24:27], v[56:59], 0
ds_read_b64_tr_b16 v[88:89], v8 offset:44032
v_mfma_f32_16x16x32_bf16 v[172:175], v[28:31], v[56:59], 0
ds_read_b64_tr_b16 v[90:91], v8 offset:44288
v_mfma_f32_16x16x32_bf16 v[176:179], v[16:19], v[60:63], 0
ds_read_b64_tr_b16 v[92:93], v8 offset:43008
s_add_u32 m0, s28, 14848
v_mfma_f32_16x16x32_bf16 v[180:183], v[20:23], v[60:63], 0
ds_read_b64_tr_b16 v[94:95], v8 offset:43264
buffer_load_dwordx4 v4, s[12:15], s26 offen offset:3584 lds
v_mfma_f32_16x16x32_bf16 v[184:187], v[24:27], v[60:63], 0
ds_read_b64_tr_b16 v[96:97], v7 offset:44032
v_mfma_f32_16x16x32_bf16 v[188:191], v[28:31], v[60:63], 0
ds_read_b64_tr_b16 v[98:99], v7 offset:44288
v_mfma_f32_16x16x32_bf16 v[192:195], v[64:67], v[16:19], 0
v_mfma_f32_16x16x32_bf16 v[196:199], v[64:67], v[20:23], 0
s_add_u32 m0, s28, 15808
v_mfma_f32_16x16x32_bf16 v[200:203], v[64:67], v[24:27], 0
buffer_load_dwordx4 v4, s[12:15], s26 offen offset:3648 lds
v_mfma_f32_16x16x32_bf16 v[204:207], v[64:67], v[28:31], 0
v_mfma_f32_16x16x32_bf16 v[208:211], v[68:71], v[16:19], 0
v_mfma_f32_16x16x32_bf16 v[212:215], v[68:71], v[20:23], 0
v_mfma_f32_16x16x32_bf16 v[216:219], v[68:71], v[24:27], 0
s_add_u32 m0, s28, 16768
v_mfma_f32_16x16x32_bf16 v[220:223], v[68:71], v[28:31], 0
buffer_load_dwordx4 v4, s[12:15], s26 offen offset:3712 lds
s_add_u32 s26, s26, 229376
s_nop 0
s_cmp_eq_u32 s41, 0
s_cselect_b32 s40, 0, 0x40000000
v_or_b32 v240, s40, v124
buffer_load_dword v125, v240, s[76:79], 0 offen
s_waitcnt vmcnt(11) lgkmcnt(0)
s_barrier
v_mfma_f32_16x16x32_bf16 v[128:131], v[76:79], v[32:35], v[128:131]
ds_read_b128 v[16:19], v6 offset:0
v_mfma_f32_16x16x32_bf16 v[132:135], v[76:79], v[36:39], v[132:135]
ds_read_b128 v[20:23], v6 offset:1024
v_mfma_f32_16x16x32_bf16 v[136:139], v[76:79], v[40:43], v[136:139]
ds_read_b128 v[24:27], v6 offset:2048
s_add_u32 m0, s28, 47104
v_mfma_f32_16x16x32_bf16 v[140:143], v[76:79], v[44:47], v[140:143]
ds_read_b128 v[28:31], v6 offset:3072
buffer_load_dwordx4 v3, s[8:11], s25 offen offset:0 lds
v_mfma_f32_16x16x32_bf16 v[144:147], v[80:83], v[32:35], v[144:147]
ds_read_b64_tr_b16 v[48:49], v9 offset:1024
v_mfma_f32_16x16x32_bf16 v[148:151], v[80:83], v[36:39], v[148:151]
ds_read_b64_tr_b16 v[50:51], v9 offset:1280
v_mfma_f32_16x16x32_bf16 v[152:155], v[80:83], v[40:43], v[152:155]
ds_read_b64_tr_b16 v[52:53], v10 offset:1024
v_mfma_f32_16x16x32_bf16 v[156:159], v[80:83], v[44:47], v[156:159]
ds_read_b64_tr_b16 v[54:55], v10 offset:1280
s_add_u32 m0, s28, 48064
v_mfma_f32_16x16x32_bf16 v[160:163], v[32:35], v[84:87], v[160:163]
ds_read_b64_tr_b16 v[56:57], v10 offset:12288
buffer_load_dwordx4 v3, s[8:11], s25 offen offset:64 lds
s_add_u32 s25, s25, 196608
v_mfma_f32_16x16x32_bf16 v[164:167], v[36:39], v[84:87], v[164:167]
ds_read_b64_tr_b16 v[58:59], v10 offset:12544
v_mfma_f32_16x16x32_bf16 v[168:171], v[40:43], v[84:87], v[168:171]
ds_read_b64_tr_b16 v[60:61], v10 offset:9216
v_mfma_f32_16x16x32_bf16 v[172:175], v[44:47], v[84:87], v[172:175]
ds_read_b64_tr_b16 v[62:63], v10 offset:9472
v_mfma_f32_16x16x32_bf16 v[176:179], v[32:35], v[88:91], v[176:179]
ds_read_b64_tr_b16 v[64:65], v10 offset:8192
s_add_u32 m0, s28, 49664
v_mfma_f32_16x16x32_bf16 v[180:183], v[36:39], v[88:91], v[180:183]
ds_read_b64_tr_b16 v[66:67], v10 offset:8448
buffer_load_dwordx4 v4, s[12:15], s26 offen offset:3584 lds
v_mfma_f32_16x16x32_bf16 v[184:187], v[40:43], v[88:91], v[184:187]
ds_read_b64_tr_b16 v[68:69], v9 offset:9216
v_mfma_f32_16x16x32_bf16 v[188:191], v[44:47], v[88:91], v[188:191]
ds_read_b64_tr_b16 v[70:71], v9 offset:9472
v_mfma_f32_16x16x32_bf16 v[192:195], v[92:95], v[32:35], v[192:195]
v_mfma_f32_16x16x32_bf16 v[196:199], v[92:95], v[36:39], v[196:199]
s_add_u32 m0, s28, 50624
v_mfma_f32_16x16x32_bf16 v[200:203], v[92:95], v[40:43], v[200:203]
buffer_load_dwordx4 v4, s[12:15], s26 offen offset:3648 lds
v_mfma_f32_16x16x32_bf16 v[204:207], v[92:95], v[44:47], v[204:207]
v_mfma_f32_16x16x32_bf16 v[208:211], v[96:99], v[32:35], v[208:211]
v_mfma_f32_16x16x32_bf16 v[212:215], v[96:99], v[36:39], v[212:215]
v_mfma_f32_16x16x32_bf16 v[216:219], v[96:99], v[40:43], v[216:219]
s_add_u32 m0, s28, 51584
v_mfma_f32_16x16x32_bf16 v[220:223], v[96:99], v[44:47], v[220:223]
buffer_load_dwordx4 v4, s[12:15], s26 offen offset:3712 lds
s_add_u32 s26, s26, 229376
s_nop 0
s_cmp_eq_u32 s41, 1
s_cselect_b32 s40, 0, 0x40000000
v_or_b32 v240, s40, v124
buffer_load_dword v125, v240, s[76:79], 0 offen
s_waitcnt vmcnt(12) lgkmcnt(0)
s_barrier
v_mfma_f32_16x16x32_bf16 v[128:131], v[48:51], v[16:19], v[128:131]
ds_read_b128 v[32:35], v6 offset:34816
v_mfma_f32_16x16x32_bf16 v[132:135], v[48:51], v[20:23], v[132:135]
ds_read_b128 v[36:39], v6 offset:35840
v_mfma_f32_16x16x32_bf16 v[136:139], v[48:51], v[24:27], v[136:139]
ds_read_b128 v[40:43], v6 offset:36864
s_add_u32 m0, s28, 81920
v_mfma_f32_16x16x32_bf16 v[140:143], v[48:51], v[28:31], v[140:143]
ds_read_b128 v[44:47], v6 offset:37888
buffer_load_dwordx4 v3, s[8:11], s25 offen offset:0 lds
v_mfma_f32_16x16x32_bf16 v[144:147], v[52:55], v[16:19], v[144:147]
ds_read_b64_tr_b16 v[76:77], v9 offset:35840
v_mfma_f32_16x16x32_bf16 v[148:151], v[52:55], v[20:23], v[148:151]
ds_read_b64_tr_b16 v[78:79], v9 offset:36096
v_mfma_f32_16x16x32_bf16 v[152:155], v[52:55], v[24:27], v[152:155]
ds_read_b64_tr_b16 v[80:81], v10 offset:35840
v_mfma_f32_16x16x32_bf16 v[156:159], v[52:55], v[28:31], v[156:159]
ds_read_b64_tr_b16 v[82:83], v10 offset:36096
s_add_u32 m0, s28, 82880
v_mfma_f32_16x16x32_bf16 v[160:163], v[16:19], v[56:59], v[160:163]
ds_read_b64_tr_b16 v[84:85], v10 offset:47104
buffer_load_dwordx4 v3, s[8:11], s25 offen offset:64 lds
s_add_u32 s25, s25, 196608
v_mfma_f32_16x16x32_bf16 v[164:167], v[20:23], v[56:59], v[164:167]
ds_read_b64_tr_b16 v[86:87], v10 offset:47360
v_mfma_f32_16x16x32_bf16 v[168:171], v[24:27], v[56:59], v[168:171]
ds_read_b64_tr_b16 v[88:89], v10 offset:44032
v_mfma_f32_16x16x32_bf16 v[172:175], v[28:31], v[56:59], v[172:175]
ds_read_b64_tr_b16 v[90:91], v10 offset:44288
v_mfma_f32_16x16x32_bf16 v[176:179], v[16:19], v[60:63], v[176:179]
ds_read_b64_tr_b16 v[92:93], v10 offset:43008
s_add_u32 m0, s28, 84480
v_mfma_f32_16x16x32_bf16 v[180:183], v[20:23], v[60:63], v[180:183]
ds_read_b64_tr_b16 v[94:95], v10 offset:43264
buffer_load_dwordx4 v4, s[12:15], s26 offen offset:3584 lds
v_mfma_f32_16x16x32_bf16 v[184:187], v[24:27], v[60:63], v[184:187]
ds_read_b64_tr_b16 v[96:97], v9 offset:44032
v_mfma_f32_16x16x32_bf16 v[188:191], v[28:31], v[60:63], v[188:191]
ds_read_b64_tr_b16 v[98:99], v9 offset:44288
v_mfma_f32_16x16x32_bf16 v[192:195], v[64:67], v[16:19], v[192:195]
v_mfma_f32_16x16x32_bf16 v[196:199], v[64:67], v[20:23], v[196:199]
s_add_u32 m0, s28, 85440
v_mfma_f32_16x16x32_bf16 v[200:203], v[64:67], v[24:27], v[200:203]
buffer_load_dwordx4 v4, s[12:15], s26 offen offset:3648 lds
v_mfma_f32_16x16x32_bf16 v[204:207], v[64:67], v[28:31], v[204:207]
v_mfma_f32_16x16x32_bf16 v[208:211], v[68:71], v[16:19], v[208:211]
v_mfma_f32_16x16x32_bf16 v[212:215], v[68:71], v[20:23], v[212:215]
v_mfma_f32_16x16x32_bf16 v[216:219], v[68:71], v[24:27], v[216:219]
s_add_u32 m0, s28, 86400
v_mfma_f32_16x16x32_bf16 v[220:223], v[68:71], v[28:31], v[220:223]
buffer_load_dwordx4 v4, s[12:15], s26 offen offset:3712 lds
s_add_u32 s26, s26, 229376
s_nop 0
s_cmp_eq_u32 s41, 2
s_cselect_b32 s40, 0, 0x40000000
v_or_b32 v240, s40, v124
buffer_load_dword v125, v240, s[76:79], 0 offen
s_waitcnt vmcnt(13) lgkmcnt(0)
s_barrier
v_mfma_f32_16x16x32_bf16 v[128:131], v[76:79], v[32:35], v[128:131]
ds_read_b128 v[16:19], v5 offset:0
v_mfma_f32_16x16x32_bf16 v[132:135], v[76:79], v[36:39], v[132:135]
ds_read_b128 v[20:23], v5 offset:1024
v_mfma_f32_16x16x32_bf16 v[136:139], v[76:79], v[40:43], v[136:139]
ds_read_b128 v[24:27], v5 offset:2048
s_add_u32 m0, s28, 116736
v_mfma_f32_16x16x32_bf16 v[140:143], v[76:79], v[44:47], v[140:143]
ds_read_b128 v[28:31], v5 offset:3072
buffer_load_dwordx4 v3, s[8:11], s25 offen offset:0 lds
v_mfma_f32_16x16x32_bf16 v[144:147], v[80:83], v[32:35], v[144:147]
ds_read_b64_tr_b16 v[48:49], v7 offset:1024
v_mfma_f32_16x16x32_bf16 v[148:151], v[80:83], v[36:39], v[148:151]
ds_read_b64_tr_b16 v[50:51], v7 offset:1280
v_mfma_f32_16x16x32_bf16 v[152:155], v[80:83], v[40:43], v[152:155]
ds_read_b64_tr_b16 v[52:53], v8 offset:1024
v_mfma_f32_16x16x32_bf16 v[156:159], v[80:83], v[44:47], v[156:159]
ds_read_b64_tr_b16 v[54:55], v8 offset:1280
s_add_u32 m0, s28, 117696
v_mfma_f32_16x16x32_bf16 v[160:163], v[32:35], v[84:87], v[160:163]
ds_read_b64_tr_b16 v[56:57], v8 offset:12288
buffer_load_dwordx4 v3, s[8:11], s25 offen offset:64 lds
s_add_u32 s25, s25, 196608
v_mfma_f32_16x16x32_bf16 v[164:167], v[36:39], v[84:87], v[164:167]
ds_read_b64_tr_b16 v[58:59], v8 offset:12544
v_mfma_f32_16x16x32_bf16 v[168:171], v[40:43], v[84:87], v[168:171]
ds_read_b64_tr_b16 v[60:61], v8 offset:9216
v_mfma_f32_16x16x32_bf16 v[172:175], v[44:47], v[84:87], v[172:175]
ds_read_b64_tr_b16 v[62:63], v8 offset:9472
v_mfma_f32_16x16x32_bf16 v[176:179], v[32:35], v[88:91], v[176:179]
ds_read_b64_tr_b16 v[64:65], v8 offset:8192
s_add_u32 m0, s28, 119296
v_mfma_f32_16x16x32_bf16 v[180:183], v[36:39], v[88:91], v[180:183]
ds_read_b64_tr_b16 v[66:67], v8 offset:8448
buffer_load_dwordx4 v4, s[12:15], s26 offen offset:3584 lds
v_mfma_f32_16x16x32_bf16 v[184:187], v[40:43], v[88:91], v[184:187]
ds_read_b64_tr_b16 v[68:69], v7 offset:9216
v_mfma_f32_16x16x32_bf16 v[188:191], v[44:47], v[88:91], v[188:191]
ds_read_b64_tr_b16 v[70:71], v7 offset:9472
v_mfma_f32_16x16x32_bf16 v[192:195], v[92:95], v[32:35], v[192:195]
v_mfma_f32_16x16x32_bf16 v[196:199], v[92:95], v[36:39], v[196:199]
s_add_u32 m0, s28, 120256
v_mfma_f32_16x16x32_bf16 v[200:203], v[92:95], v[40:43], v[200:203]
buffer_load_dwordx4 v4, s[12:15], s26 offen offset:3648 lds
v_mfma_f32_16x16x32_bf16 v[204:207], v[92:95], v[44:47], v[204:207]
v_mfma_f32_16x16x32_bf16 v[208:211], v[96:99], v[32:35], v[208:211]
v_mfma_f32_16x16x32_bf16 v[212:215], v[96:99], v[36:39], v[212:215]
v_mfma_f32_16x16x32_bf16 v[216:219], v[96:99], v[40:43], v[216:219]
s_add_u32 m0, s28, 121216
v_mfma_f32_16x16x32_bf16 v[220:223], v[96:99], v[44:47], v[220:223]
buffer_load_dwordx4 v4, s[12:15], s26 offen offset:3712 lds
s_add_u32 s26, s26, 229376
s_nop 0
s_cmp_eq_u32 s41, 3
s_cselect_b32 s40, 0, 0x40000000
v_or_b32 v240, s40, v124
buffer_load_dword v125, v240, s[76:79], 0 offen
v_add_u32 v124, s3, v124
s_mov_b32 s29, 6
L_loop1_3:
s_waitcnt vmcnt(13) lgkmcnt(0)
s_barrier
v_mfma_f32_16x16x32_bf16 v[128:131], v[48:51], v[16:19], v[128:131]
ds_read_b128 v[32:35], v5 offset:34816
v_mfma_f32_16x16x32_bf16 v[132:135], v[48:51], v[20:23], v[132:135]
ds_read_b128 v[36:39], v5 offset:35840
v_mfma_f32_16x16x32_bf16 v[136:139], v[48:51], v[24:27], v[136:139]
ds_read_b128 v[40:43], v5 offset:36864
s_add_u32 m0, s28, 12288
v_mfma_f32_16x16x32_bf16 v[140:143], v[48:51], v[28:31], v[140:143]
ds_read_b128 v[44:47], v5 offset:37888
buffer_load_dwordx4 v3, s[8:11], s25 offen offset:0 lds
v_mfma_f32_16x16x32_bf16 v[144:147], v[52:55], v[16:19], v[144:147]
ds_read_b64_tr_b16 v[76:77], v7 offset:35840
v_mfma_f32_16x16x32_bf16 v[148:151], v[52:55], v[20:23], v[148:151]
ds_read_b64_tr_b16 v[78:79], v7 offset:36096
v_mfma_f32_16x16x32_bf16 v[152:155], v[52:55], v[24:27], v[152:155]
ds_read_b64_tr_b16 v[80:81], v8 offset:35840
v_mfma_f32_16x16x32_bf16 v[156:159], v[52:55], v[28:31], v[156:159]
ds_read_b64_tr_b16 v[82:83], v8 offset:36096
s_add_u32 m0, s28, 13248
v_mfma_f32_16x16x32_bf16 v[160:163], v[16:19], v[56:59], v[160:163]
ds_read_b64_tr_b16 v[84:85], v8 offset:47104
buffer_load_dwordx4 v3, s[8:11], s25 offen offset:64 lds
s_add_u32 s25, s25, 196608
v_mfma_f32_16x16x32_bf16 v[164:167], v[20:23], v[56:59], v[164:167]
ds_read_b64_tr_b16 v[86:87], v8 offset:47360
v_mfma_f32_16x16x32_bf16 v[168:171], v[24:27], v[56:59], v[168:171]
ds_read_b64_tr_b16 v[88:89], v8 offset:44032
v_mfma_f32_16x16x32_bf16 v[172:175], v[28:31], v[56:59], v[172:175]
ds_read_b64_tr_b16 v[90:91], v8 offset:44288
v_mfma_f32_16x16x32_bf16 v[176:179], v[16:19], v[60:63], v[176:179]
ds_read_b64_tr_b16 v[92:93], v8 offset:43008
s_add_u32 m0, s28, 14848
v_mfma_f32_16x16x32_bf16 v[180:183], v[20:23], v[60:63], v[180:183]
ds_read_b64_tr_b16 v[94:95], v8 offset:43264
buffer_load_dwordx4 v4, s[12:15], s26 offen offset:3584 lds
v_mfma_f32_16x16x32_bf16 v[184:187], v[24:27], v[60:63], v[184:187]
ds_read_b64_tr_b16 v[96:97], v7 offset:44032
v_mfma_f32_16x16x32_bf16 v[188:191], v[28:31], v[60:63], v[188:191]
ds_read_b64_tr_b16 v[98:99], v7 offset:44288
v_mfma_f32_16x16x32_bf16 v[192:195], v[64:67], v[16:19], v[192:195]
v_mfma_f32_16x16x32_bf16 v[196:199], v[64:67], v[20:23], v[196:199]
s_add_u32 m0, s28, 15808
v_mfma_f32_16x16x32_bf16 v[200:203], v[64:67], v[24:27], v[200:203]
buffer_load_dwordx4 v4, s[12:15], s26 offen offset:3648 lds
v_mfma_f32_16x16x32_bf16 v[204:207], v[64:67], v[28:31], v[204:207]
v_mfma_f32_16x16x32_bf16 v[208:211], v[68:71], v[16:19], v[208:211]
v_mfma_f32_16x16x32_bf16 v[212:215], v[68:71], v[20:23], v[212:215]
v_mfma_f32_16x16x32_bf16 v[216:219], v[68:71], v[24:27], v[216:219]
s_add_u32 m0, s28, 16768
v_mfma_f32_16x16x32_bf16 v[220:223], v[68:71], v[28:31], v[220:223]
buffer_load_dwordx4 v4, s[12:15], s26 offen offset:3712 lds
s_add_u32 s26, s26, 229376
s_nop 0
s_cmp_eq_u32 s41, 0
s_cselect_b32 s40, 0, 0x40000000
v_or_b32 v240, s40, v124
buffer_load_dword v125, v240, s[76:79], 0 offen
s_waitcnt vmcnt(13) lgkmcnt(0)
s_barrier
v_mfma_f32_16x16x32_bf16 v[128:131], v[76:79], v[32:35], v[128:131]
ds_read_b128 v[16:19], v6 offset:0
v_mfma_f32_16x16x32_bf16 v[132:135], v[76:79], v[36:39], v[132:135]
ds_read_b128 v[20:23], v6 offset:1024
v_mfma_f32_16x16x32_bf16 v[136:139], v[76:79], v[40:43], v[136:139]
ds_read_b128 v[24:27], v6 offset:2048
s_add_u32 m0, s28, 47104
v_mfma_f32_16x16x32_bf16 v[140:143], v[76:79], v[44:47], v[140:143]
ds_read_b128 v[28:31], v6 offset:3072
buffer_load_dwordx4 v3, s[8:11], s25 offen offset:0 lds
v_mfma_f32_16x16x32_bf16 v[144:147], v[80:83], v[32:35], v[144:147]
ds_read_b64_tr_b16 v[48:49], v9 offset:1024
v_mfma_f32_16x16x32_bf16 v[148:151], v[80:83], v[36:39], v[148:151]
ds_read_b64_tr_b16 v[50:51], v9 offset:1280
v_mfma_f32_16x16x32_bf16 v[152:155], v[80:83], v[40:43], v[152:155]
ds_read_b64_tr_b16 v[52:53], v10 offset:1024
v_mfma_f32_16x16x32_bf16 v[156:159], v[80:83], v[44:47], v[156:159]
ds_read_b64_tr_b16 v[54:55], v10 offset:1280
s_add_u32 m0, s28, 48064
v_mfma_f32_16x16x32_bf16 v[160:163], v[32:35], v[84:87], v[160:163]
ds_read_b64_tr_b16 v[56:57], v10 offset:12288
buffer_load_dwordx4 v3, s[8:11], s25 offen offset:64 lds
s_add_u32 s25, s25, 196608
v_mfma_f32_16x16x32_bf16 v[164:167], v[36:39], v[84:87], v[164:167]
ds_read_b64_tr_b16 v[58:59], v10 offset:12544
v_mfma_f32_16x16x32_bf16 v[168:171], v[40:43], v[84:87], v[168:171]
ds_read_b64_tr_b16 v[60:61], v10 offset:9216
v_mfma_f32_16x16x32_bf16 v[172:175], v[44:47], v[84:87], v[172:175]
ds_read_b64_tr_b16 v[62:63], v10 offset:9472
v_mfma_f32_16x16x32_bf16 v[176:179], v[32:35], v[88:91], v[176:179]
ds_read_b64_tr_b16 v[64:65], v10 offset:8192
s_add_u32 m0, s28, 49664
v_mfma_f32_16x16x32_bf16 v[180:183], v[36:39], v[88:91], v[180:183]
ds_read_b64_tr_b16 v[66:67], v10 offset:8448
buffer_load_dwordx4 v4, s[12:15], s26 offen offset:3584 lds
v_mfma_f32_16x16x32_bf16 v[184:187], v[40:43], v[88:91], v[184:187]
ds_read_b64_tr_b16 v[68:69], v9 offset:9216
v_mfma_f32_16x16x32_bf16 v[188:191], v[44:47], v[88:91], v[188:191]
ds_read_b64_tr_b16 v[70:71], v9 offset:9472
v_mfma_f32_16x16x32_bf16 v[192:195], v[92:95], v[32:35], v[192:195]
v_mfma_f32_16x16x32_bf16 v[196:199], v[92:95], v[36:39], v[196:199]
s_add_u32 m0, s28, 50624
v_mfma_f32_16x16x32_bf16 v[200:203], v[92:95], v[40:43], v[200:203]
buffer_load_dwordx4 v4, s[12:15], s26 offen offset:3648 lds
v_mfma_f32_16x16x32_bf16 v[204:207], v[92:95], v[44:47], v[204:207]
v_mfma_f32_16x16x32_bf16 v[208:211], v[96:99], v[32:35], v[208:211]
v_mfma_f32_16x16x32_bf16 v[212:215], v[96:99], v[36:39], v[212:215]
v_mfma_f32_16x16x32_bf16 v[216:219], v[96:99], v[40:43], v[216:219]
s_add_u32 m0, s28, 51584
v_mfma_f32_16x16x32_bf16 v[220:223], v[96:99], v[44:47], v[220:223]
buffer_load_dwordx4 v4, s[12:15], s26 offen offset:3712 lds
s_add_u32 s26, s26, 229376
s_nop 0
s_cmp_eq_u32 s41, 1
s_cselect_b32 s40, 0, 0x40000000
v_or_b32 v240, s40, v124
buffer_load_dword v125, v240, s[76:79], 0 offen
s_waitcnt vmcnt(13) lgkmcnt(0)
s_barrier
v_mfma_f32_16x16x32_bf16 v[128:131], v[48:51], v[16:19], v[128:131]
ds_read_b128 v[32:35], v6 offset:34816
v_mfma_f32_16x16x32_bf16 v[132:135], v[48:51], v[20:23], v[132:135]
ds_read_b128 v[36:39], v6 offset:35840
v_mfma_f32_16x16x32_bf16 v[136:139], v[48:51], v[24:27], v[136:139]
ds_read_b128 v[40:43], v6 offset:36864
s_add_u32 m0, s28, 81920
v_mfma_f32_16x16x32_bf16 v[140:143], v[48:51], v[28:31], v[140:143]
ds_read_b128 v[44:47], v6 offset:37888
buffer_load_dwordx4 v3, s[8:11], s25 offen offset:0 lds
v_mfma_f32_16x16x32_bf16 v[144:147], v[52:55], v[16:19], v[144:147]
ds_read_b64_tr_b16 v[76:77], v9 offset:35840
v_mfma_f32_16x16x32_bf16 v[148:151], v[52:55], v[20:23], v[148:151]
ds_read_b64_tr_b16 v[78:79], v9 offset:36096
v_mfma_f32_16x16x32_bf16 v[152:155], v[52:55], v[24:27], v[152:155]
ds_read_b64_tr_b16 v[80:81], v10 offset:35840
v_mfma_f32_16x16x32_bf16 v[156:159], v[52:55], v[28:31], v[156:159]
ds_read_b64_tr_b16 v[82:83], v10 offset:36096
s_add_u32 m0, s28, 82880
v_mfma_f32_16x16x32_bf16 v[160:163], v[16:19], v[56:59], v[160:163]
ds_read_b64_tr_b16 v[84:85], v10 offset:47104
buffer_load_dwordx4 v3, s[8:11], s25 offen offset:64 lds
s_add_u32 s25, s25, 196608
v_mfma_f32_16x16x32_bf16 v[164:167], v[20:23], v[56:59], v[164:167]
ds_read_b64_tr_b16 v[86:87], v10 offset:47360
v_mfma_f32_16x16x32_bf16 v[168:171], v[24:27], v[56:59], v[168:171]
ds_read_b64_tr_b16 v[88:89], v10 offset:44032
v_mfma_f32_16x16x32_bf16 v[172:175], v[28:31], v[56:59], v[172:175]
ds_read_b64_tr_b16 v[90:91], v10 offset:44288
v_mfma_f32_16x16x32_bf16 v[176:179], v[16:19], v[60:63], v[176:179]
ds_read_b64_tr_b16 v[92:93], v10 offset:43008
s_add_u32 m0, s28, 84480
v_mfma_f32_16x16x32_bf16 v[180:183], v[20:23], v[60:63], v[180:183]
ds_read_b64_tr_b16 v[94:95], v10 offset:43264
buffer_load_dwordx4 v4, s[12:15], s26 offen offset:3584 lds
v_mfma_f32_16x16x32_bf16 v[184:187], v[24:27], v[60:63], v[184:187]
ds_read_b64_tr_b16 v[96:97], v9 offset:44032
v_mfma_f32_16x16x32_bf16 v[188:191], v[28:31], v[60:63], v[188:191]
ds_read_b64_tr_b16 v[98:99], v9 offset:44288
v_mfma_f32_16x16x32_bf16 v[192:195], v[64:67], v[16:19], v[192:195]
v_mfma_f32_16x16x32_bf16 v[196:199], v[64:67], v[20:23], v[196:199]
s_add_u32 m0, s28, 85440
v_mfma_f32_16x16x32_bf16 v[200:203], v[64:67], v[24:27], v[200:203]
buffer_load_dwordx4 v4, s[12:15], s26 offen offset:3648 lds
v_mfma_f32_16x16x32_bf16 v[204:207], v[64:67], v[28:31], v[204:207]
v_mfma_f32_16x16x32_bf16 v[208:211], v[68:71], v[16:19], v[208:211]
v_mfma_f32_16x16x32_bf16 v[212:215], v[68:71], v[20:23], v[212:215]
v_mfma_f32_16x16x32_bf16 v[216:219], v[68:71], v[24:27], v[216:219]
s_add_u32 m0, s28, 86400
v_mfma_f32_16x16x32_bf16 v[220:223], v[68:71], v[28:31], v[220:223]
buffer_load_dwordx4 v4, s[12:15], s26 offen offset:3712 lds
s_add_u32 s26, s26, 229376
s_nop 0
s_cmp_eq_u32 s41, 2
s_cselect_b32 s40, 0, 0x40000000
v_or_b32 v240, s40, v124
buffer_load_dword v125, v240, s[76:79], 0 offen
s_waitcnt vmcnt(13) lgkmcnt(0)
s_barrier
v_mfma_f32_16x16x32_bf16 v[128:131], v[76:79], v[32:35], v[128:131]
ds_read_b128 v[16:19], v5 offset:0
v_mfma_f32_16x16x32_bf16 v[132:135], v[76:79], v[36:39], v[132:135]
ds_read_b128 v[20:23], v5 offset:1024
v_mfma_f32_16x16x32_bf16 v[136:139], v[76:79], v[40:43], v[136:139]
ds_read_b128 v[24:27], v5 offset:2048
s_add_u32 m0, s28, 116736
v_mfma_f32_16x16x32_bf16 v[140:143], v[76:79], v[44:47], v[140:143]
ds_read_b128 v[28:31], v5 offset:3072
buffer_load_dwordx4 v3, s[8:11], s25 offen offset:0 lds
v_mfma_f32_16x16x32_bf16 v[144:147], v[80:83], v[32:35], v[144:147]
ds_read_b64_tr_b16 v[48:49], v7 offset:1024
v_mfma_f32_16x16x32_bf16 v[148:151], v[80:83], v[36:39], v[148:151]
ds_read_b64_tr_b16 v[50:51], v7 offset:1280
v_mfma_f32_16x16x32_bf16 v[152:155], v[80:83], v[40:43], v[152:155]
ds_read_b64_tr_b16 v[52:53], v8 offset:1024
v_mfma_f32_16x16x32_bf16 v[156:159], v[80:83], v[44:47], v[156:159]
ds_read_b64_tr_b16 v[54:55], v8 offset:1280
s_add_u32 m0, s28, 117696
v_mfma_f32_16x16x32_bf16 v[160:163], v[32:35], v[84:87], v[160:163]
ds_read_b64_tr_b16 v[56:57], v8 offset:12288
buffer_load_dwordx4 v3, s[8:11], s25 offen offset:64 lds
s_add_u32 s25, s25, 196608
v_mfma_f32_16x16x32_bf16 v[164:167], v[36:39], v[84:87], v[164:167]
ds_read_b64_tr_b16 v[58:59], v8 offset:12544
v_mfma_f32_16x16x32_bf16 v[168:171], v[40:43], v[84:87], v[168:171]
ds_read_b64_tr_b16 v[60:61], v8 offset:9216
v_mfma_f32_16x16x32_bf16 v[172:175], v[44:47], v[84:87], v[172:175]
ds_read_b64_tr_b16 v[62:63], v8 offset:9472
v_mfma_f32_16x16x32_bf16 v[176:179], v[32:35], v[88:91], v[176:179]
ds_read_b64_tr_b16 v[64:65], v8 offset:8192
s_add_u32 m0, s28, 119296
v_mfma_f32_16x16x32_bf16 v[180:183], v[36:39], v[88:91], v[180:183]
ds_read_b64_tr_b16 v[66:67], v8 offset:8448
buffer_load_dwordx4 v4, s[12:15], s26 offen offset:3584 lds
v_mfma_f32_16x16x32_bf16 v[184:187], v[40:43], v[88:91], v[184:187]
ds_read_b64_tr_b16 v[68:69], v7 offset:9216
v_mfma_f32_16x16x32_bf16 v[188:191], v[44:47], v[88:91], v[188:191]
ds_read_b64_tr_b16 v[70:71], v7 offset:9472
v_mfma_f32_16x16x32_bf16 v[192:195], v[92:95], v[32:35], v[192:195]
v_mfma_f32_16x16x32_bf16 v[196:199], v[92:95], v[36:39], v[196:199]
s_add_u32 m0, s28, 120256
v_mfma_f32_16x16x32_bf16 v[200:203], v[92:95], v[40:43], v[200:203]
buffer_load_dwordx4 v4, s[12:15], s26 offen offset:3648 lds
v_mfma_f32_16x16x32_bf16 v[204:207], v[92:95], v[44:47], v[204:207]
v_mfma_f32_16x16x32_bf16 v[208:211], v[96:99], v[32:35], v[208:211]
v_mfma_f32_16x16x32_bf16 v[212:215], v[96:99], v[36:39], v[212:215]
v_mfma_f32_16x16x32_bf16 v[216:219], v[96:99], v[40:43], v[216:219]
s_add_u32 m0, s28, 121216
v_mfma_f32_16x16x32_bf16 v[220:223], v[96:99], v[44:47], v[220:223]
buffer_load_dwordx4 v4, s[12:15], s26 offen offset:3712 lds
s_add_u32 s26, s26, 229376
s_nop 0
s_cmp_eq_u32 s41, 3
s_cselect_b32 s40, 0, 0x40000000
v_or_b32 v240, s40, v124
buffer_load_dword v125, v240, s[76:79], 0 offen
v_add_u32 v124, s3, v124
s_sub_u32 s29, s29, 1
s_cmp_lg_u32 s29, 0
s_cbranch_scc1 L_loop1_3
s_waitcnt vmcnt(10) lgkmcnt(0)
s_barrier
v_mfma_f32_16x16x32_bf16 v[128:131], v[48:51], v[16:19], v[128:131]
ds_read_b128 v[32:35], v5 offset:34816
v_mfma_f32_16x16x32_bf16 v[132:135], v[48:51], v[20:23], v[132:135]
ds_read_b128 v[36:39], v5 offset:35840
v_mfma_f32_16x16x32_bf16 v[136:139], v[48:51], v[24:27], v[136:139]
ds_read_b128 v[40:43], v5 offset:36864
v_mfma_f32_16x16x32_bf16 v[140:143], v[48:51], v[28:31], v[140:143]
ds_read_b128 v[44:47], v5 offset:37888
v_mfma_f32_16x16x32_bf16 v[144:147], v[52:55], v[16:19], v[144:147]
ds_read_b64_tr_b16 v[76:77], v7 offset:35840
v_mfma_f32_16x16x32_bf16 v[148:151], v[52:55], v[20:23], v[148:151]
ds_read_b64_tr_b16 v[78:79], v7 offset:36096
v_mfma_f32_16x16x32_bf16 v[152:155], v[52:55], v[24:27], v[152:155]
ds_read_b64_tr_b16 v[80:81], v8 offset:35840
v_mfma_f32_16x16x32_bf16 v[156:159], v[52:55], v[28:31], v[156:159]
ds_read_b64_tr_b16 v[82:83], v8 offset:36096
v_mfma_f32_16x16x32_bf16 v[160:163], v[16:19], v[56:59], v[160:163]
ds_read_b64_tr_b16 v[84:85], v8 offset:47104
v_mfma_f32_16x16x32_bf16 v[164:167], v[20:23], v[56:59], v[164:167]
ds_read_b64_tr_b16 v[86:87], v8 offset:47360
v_mfma_f32_16x16x32_bf16 v[168:171], v[24:27], v[56:59], v[168:171]
ds_read_b64_tr_b16 v[88:89], v8 offset:44032
v_mfma_f32_16x16x32_bf16 v[172:175], v[28:31], v[56:59], v[172:175]
ds_read_b64_tr_b16 v[90:91], v8 offset:44288
v_mfma_f32_16x16x32_bf16 v[176:179], v[16:19], v[60:63], v[176:179]
ds_read_b64_tr_b16 v[92:93], v8 offset:43008
v_mfma_f32_16x16x32_bf16 v[180:183], v[20:23], v[60:63], v[180:183]
ds_read_b64_tr_b16 v[94:95], v8 offset:43264
v_mfma_f32_16x16x32_bf16 v[184:187], v[24:27], v[60:63], v[184:187]
ds_read_b64_tr_b16 v[96:97], v7 offset:44032
v_mfma_f32_16x16x32_bf16 v[188:191], v[28:31], v[60:63], v[188:191]
ds_read_b64_tr_b16 v[98:99], v7 offset:44288
v_mfma_f32_16x16x32_bf16 v[192:195], v[64:67], v[16:19], v[192:195]
v_mfma_f32_16x16x32_bf16 v[196:199], v[64:67], v[20:23], v[196:199]
v_mfma_f32_16x16x32_bf16 v[200:203], v[64:67], v[24:27], v[200:203]
v_mfma_f32_16x16x32_bf16 v[204:207], v[64:67], v[28:31], v[204:207]
v_mfma_f32_16x16x32_bf16 v[208:211], v[68:71], v[16:19], v[208:211]
v_mfma_f32_16x16x32_bf16 v[212:215], v[68:71], v[20:23], v[212:215]
v_mfma_f32_16x16x32_bf16 v[216:219], v[68:71], v[24:27], v[216:219]
v_mfma_f32_16x16x32_bf16 v[220:223], v[68:71], v[28:31], v[220:223]
s_waitcnt vmcnt(5) lgkmcnt(0)
s_barrier
v_mfma_f32_16x16x32_bf16 v[128:131], v[76:79], v[32:35], v[128:131]
ds_read_b128 v[16:19], v6 offset:0
v_mfma_f32_16x16x32_bf16 v[132:135], v[76:79], v[36:39], v[132:135]
ds_read_b128 v[20:23], v6 offset:1024
v_mfma_f32_16x16x32_bf16 v[136:139], v[76:79], v[40:43], v[136:139]
ds_read_b128 v[24:27], v6 offset:2048
v_mfma_f32_16x16x32_bf16 v[140:143], v[76:79], v[44:47], v[140:143]
ds_read_b128 v[28:31], v6 offset:3072
v_mfma_f32_16x16x32_bf16 v[144:147], v[80:83], v[32:35], v[144:147]
ds_read_b64_tr_b16 v[48:49], v9 offset:1024
v_mfma_f32_16x16x32_bf16 v[148:151], v[80:83], v[36:39], v[148:151]
ds_read_b64_tr_b16 v[50:51], v9 offset:1280
v_mfma_f32_16x16x32_bf16 v[152:155], v[80:83], v[40:43], v[152:155]
ds_read_b64_tr_b16 v[52:53], v10 offset:1024
v_mfma_f32_16x16x32_bf16 v[156:159], v[80:83], v[44:47], v[156:159]
ds_read_b64_tr_b16 v[54:55], v10 offset:1280
v_mfma_f32_16x16x32_bf16 v[160:163], v[32:35], v[84:87], v[160:163]
ds_read_b64_tr_b16 v[56:57], v10 offset:12288
v_mfma_f32_16x16x32_bf16 v[164:167], v[36:39], v[84:87], v[164:167]
ds_read_b64_tr_b16 v[58:59], v10 offset:12544
v_mfma_f32_16x16x32_bf16 v[168:171], v[40:43], v[84:87], v[168:171]
ds_read_b64_tr_b16 v[60:61], v10 offset:9216
v_mfma_f32_16x16x32_bf16 v[172:175], v[44:47], v[84:87], v[172:175]
ds_read_b64_tr_b16 v[62:63], v10 offset:9472
v_mfma_f32_16x16x32_bf16 v[176:179], v[32:35], v[88:91], v[176:179]
ds_read_b64_tr_b16 v[64:65], v10 offset:8192
v_mfma_f32_16x16x32_bf16 v[180:183], v[36:39], v[88:91], v[180:183]
ds_read_b64_tr_b16 v[66:67], v10 offset:8448
v_mfma_f32_16x16x32_bf16 v[184:187], v[40:43], v[88:91], v[184:187]
ds_read_b64_tr_b16 v[68:69], v9 offset:9216
v_mfma_f32_16x16x32_bf16 v[188:191], v[44:47], v[88:91], v[188:191]
ds_read_b64_tr_b16 v[70:71], v9 offset:9472
v_mfma_f32_16x16x32_bf16 v[192:195], v[92:95], v[32:35], v[192:195]
v_mfma_f32_16x16x32_bf16 v[196:199], v[92:95], v[36:39], v[196:199]
v_mfma_f32_16x16x32_bf16 v[200:203], v[92:95], v[40:43], v[200:203]
v_mfma_f32_16x16x32_bf16 v[204:207], v[92:95], v[44:47], v[204:207]
v_mfma_f32_16x16x32_bf16 v[208:211], v[96:99], v[32:35], v[208:211]
v_mfma_f32_16x16x32_bf16 v[212:215], v[96:99], v[36:39], v[212:215]
v_mfma_f32_16x16x32_bf16 v[216:219], v[96:99], v[40:43], v[216:219]
v_mfma_f32_16x16x32_bf16 v[220:223], v[96:99], v[44:47], v[220:223]
s_waitcnt vmcnt(0) lgkmcnt(0)
s_barrier
v_mfma_f32_16x16x32_bf16 v[128:131], v[48:51], v[16:19], v[128:131]
ds_read_b128 v[32:35], v6 offset:34816
v_mfma_f32_16x16x32_bf16 v[132:135], v[48:51], v[20:23], v[132:135]
ds_read_b128 v[36:39], v6 offset:35840
v_mfma_f32_16x16x32_bf16 v[136:139], v[48:51], v[24:27], v[136:139]
ds_read_b128 v[40:43], v6 offset:36864
v_mfma_f32_16x16x32_bf16 v[140:143], v[48:51], v[28:31], v[140:143]
ds_read_b128 v[44:47], v6 offset:37888
v_mfma_f32_16x16x32_bf16 v[144:147], v[52:55], v[16:19], v[144:147]
ds_read_b64_tr_b16 v[76:77], v9 offset:35840
v_mfma_f32_16x16x32_bf16 v[148:151], v[52:55], v[20:23], v[148:151]
ds_read_b64_tr_b16 v[78:79], v9 offset:36096
v_mfma_f32_16x16x32_bf16 v[152:155], v[52:55], v[24:27], v[152:155]
ds_read_b64_tr_b16 v[80:81], v10 offset:35840
v_mfma_f32_16x16x32_bf16 v[156:159], v[52:55], v[28:31], v[156:159]
ds_read_b64_tr_b16 v[82:83], v10 offset:36096
v_mfma_f32_16x16x32_bf16 v[160:163], v[16:19], v[56:59], v[160:163]
ds_read_b64_tr_b16 v[84:85], v10 offset:47104
v_mfma_f32_16x16x32_bf16 v[164:167], v[20:23], v[56:59], v[164:167]
ds_read_b64_tr_b16 v[86:87], v10 offset:47360
v_mfma_f32_16x16x32_bf16 v[168:171], v[24:27], v[56:59], v[168:171]
ds_read_b64_tr_b16 v[88:89], v10 offset:44032
v_mfma_f32_16x16x32_bf16 v[172:175], v[28:31], v[56:59], v[172:175]
ds_read_b64_tr_b16 v[90:91], v10 offset:44288
v_mfma_f32_16x16x32_bf16 v[176:179], v[16:19], v[60:63], v[176:179]
ds_read_b64_tr_b16 v[92:93], v10 offset:43008
v_mfma_f32_16x16x32_bf16 v[180:183], v[20:23], v[60:63], v[180:183]
ds_read_b64_tr_b16 v[94:95], v10 offset:43264
v_mfma_f32_16x16x32_bf16 v[184:187], v[24:27], v[60:63], v[184:187]
ds_read_b64_tr_b16 v[96:97], v9 offset:44032
v_mfma_f32_16x16x32_bf16 v[188:191], v[28:31], v[60:63], v[188:191]
ds_read_b64_tr_b16 v[98:99], v9 offset:44288
v_mfma_f32_16x16x32_bf16 v[192:195], v[64:67], v[16:19], v[192:195]
v_mfma_f32_16x16x32_bf16 v[196:199], v[64:67], v[20:23], v[196:199]
v_mfma_f32_16x16x32_bf16 v[200:203], v[64:67], v[24:27], v[200:203]
v_mfma_f32_16x16x32_bf16 v[204:207], v[64:67], v[28:31], v[204:207]
v_mfma_f32_16x16x32_bf16 v[208:211], v[68:71], v[16:19], v[208:211]
v_mfma_f32_16x16x32_bf16 v[212:215], v[68:71], v[20:23], v[212:215]
v_mfma_f32_16x16x32_bf16 v[216:219], v[68:71], v[24:27], v[216:219]
v_mfma_f32_16x16x32_bf16 v[220:223], v[68:71], v[28:31], v[220:223]
s_waitcnt lgkmcnt(0)
s_barrier
v_mfma_f32_16x16x32_bf16 v[128:131], v[76:79], v[32:35], v[128:131]
v_mfma_f32_16x16x32_bf16 v[132:135], v[76:79], v[36:39], v[132:135]
v_mfma_f32_16x16x32_bf16 v[136:139], v[76:79], v[40:43], v[136:139]
v_mfma_f32_16x16x32_bf16 v[140:143], v[76:79], v[44:47], v[140:143]
v_mfma_f32_16x16x32_bf16 v[144:147], v[80:83], v[32:35], v[144:147]
v_mfma_f32_16x16x32_bf16 v[148:151], v[80:83], v[36:39], v[148:151]
v_mfma_f32_16x16x32_bf16 v[152:155], v[80:83], v[40:43], v[152:155]
v_mfma_f32_16x16x32_bf16 v[156:159], v[80:83], v[44:47], v[156:159]
v_mfma_f32_16x16x32_bf16 v[160:163], v[32:35], v[84:87], v[160:163]
v_mfma_f32_16x16x32_bf16 v[164:167], v[36:39], v[84:87], v[164:167]
v_mfma_f32_16x16x32_bf16 v[168:171], v[40:43], v[84:87], v[168:171]
v_mfma_f32_16x16x32_bf16 v[172:175], v[44:47], v[84:87], v[172:175]
v_mfma_f32_16x16x32_bf16 v[176:179], v[32:35], v[88:91], v[176:179]
v_mfma_f32_16x16x32_bf16 v[180:183], v[36:39], v[88:91], v[180:183]
v_mfma_f32_16x16x32_bf16 v[184:187], v[40:43], v[88:91], v[184:187]
v_mfma_f32_16x16x32_bf16 v[188:191], v[44:47], v[88:91], v[188:191]
v_mfma_f32_16x16x32_bf16 v[192:195], v[92:95], v[32:35], v[192:195]
v_mfma_f32_16x16x32_bf16 v[196:199], v[92:95], v[36:39], v[196:199]
v_mfma_f32_16x16x32_bf16 v[200:203], v[92:95], v[40:43], v[200:203]
v_mfma_f32_16x16x32_bf16 v[204:207], v[92:95], v[44:47], v[204:207]
v_mfma_f32_16x16x32_bf16 v[208:211], v[96:99], v[32:35], v[208:211]
v_mfma_f32_16x16x32_bf16 v[212:215], v[96:99], v[36:39], v[212:215]
v_mfma_f32_16x16x32_bf16 v[216:219], v[96:99], v[40:43], v[216:219]
v_mfma_f32_16x16x32_bf16 v[220:223], v[96:99], v[44:47], v[220:223]
s_mov_b32 s42, 0xbdd2d3e8
s_mov_b32 s43, 0xbdd2d3e8
s_mov_b32 s44, 0x3f800000
s_mov_b32 s45, 0x3f800000
s_mov_b32 s46, 0x3fb8aa3b
s_mov_b32 s47, 0x3fb8aa3b
s_mov_b32 s48, 0x358637bd
s_mov_b32 s49, 0x358637bd
v_mov_b32 v12, 0xc0135761
v_mov_b32 v13, 0xc0135761
v_and_b32_e64 v1, 63, v0
v_bfe_u32 v2, v1, 3, 1
v_lshlrev_b32_e64 v2, 9, v2
v_bfe_u32 v3, v1, 2, 1
v_lshl_add_u32 v2, v3, 7, v2
v_lshrrev_b32 v3, 4, v1
v_lshlrev_b32_e64 v5, 5, v3
s_lshl_b32 s30, s23, 8
s_add_u32 s30, s30, 151552
v_add_u32 v5, s30, v5
v_add_u32_e64 v2, v2, v5
s_lshl_b32 s30, s23, 11
s_add_u32 s30, s30, 122880
v_add_u32 v6, s30, v11
s_lshl_b32 s30, s21, 2
s_and_b32 s31, s22, 3
s_add_u32 s30, s30, s31
s_lshl_b32 s30, s30, 1
s_add_u32 s30, s30, s23
s_lshl_b32 s30, s30, 16
v_and_b32 v124, 15, v1
v_lshlrev_b32 v124, 12, v124
v_lshrrev_b32 v125, 4, v1
v_lshl_add_u32 v124, v125, 10, v124
buffer_load_dword v125, v124, s[56:59], s30 offen offset:384
s_lshl_b32 s30, s2, 1
s_add_u32 s30, s30, s23
s_lshl_b32 s30, s30, 12
v_and_b32 v127, 31, v1
v_lshlrev_b32_e64 v127, 7, v127
buffer_load_dword v125, v127, s[64:67], s30 offen
s_lshl_b32 s30, s21, 1
s_add_u32 s30, s30, s23
s_lshl_b32 s30, s30, 7
v_mov_b32 v126, 0
buffer_load_dword v125, v126, s[60:63], s30 offen
v_and_b32 v127, 15, v1
v_lshlrev_b32 v127, 4, v127
buffer_load_dword v126, v127, s[4:7], 0 offen sc1
v_pk_mul_f32 v[104:105], v[160:161], v[160:161]
v_pk_mul_f32 v[106:107], v[162:163], v[162:163]
v_pk_mul_f32 v[108:109], v[164:165], v[164:165]
v_pk_mul_f32 v[110:111], v[166:167], v[166:167]
v_pk_fma_f32 v[104:105], v[104:105], s[42:43], v[12:13]
v_pk_fma_f32 v[106:107], v[106:107], s[42:43], v[12:13]
v_pk_fma_f32 v[108:109], v[108:109], s[42:43], v[12:13]
v_pk_fma_f32 v[110:111], v[110:111], s[42:43], v[12:13]
v_pk_mul_f32 v[104:105], v[104:105], v[160:161]
v_pk_mul_f32 v[106:107], v[106:107], v[162:163]
v_pk_mul_f32 v[108:109], v[108:109], v[164:165]
v_pk_mul_f32 v[110:111], v[110:111], v[166:167]
v_exp_f32 v104, v104
v_exp_f32 v105, v105
v_exp_f32 v106, v106
v_exp_f32 v107, v107
v_exp_f32 v108, v108
v_exp_f32 v109, v109
v_exp_f32 v110, v110
v_exp_f32 v111, v111
v_pk_add_f32 v[104:105], v[104:105], s[44:45]
v_pk_add_f32 v[106:107], v[106:107], s[44:45]
v_pk_add_f32 v[108:109], v[108:109], s[44:45]
v_pk_add_f32 v[110:111], v[110:111], s[44:45]
v_rcp_f32 v104, v104
v_rcp_f32 v105, v105
v_rcp_f32 v106, v106
v_rcp_f32 v107, v107
v_rcp_f32 v108, v108
v_rcp_f32 v109, v109
v_rcp_f32 v110, v110
v_rcp_f32 v111, v111
v_pk_mul_f32 v[160:161], v[160:161], v[104:105]
v_pk_mul_f32 v[162:163], v[162:163], v[106:107]
v_pk_mul_f32 v[164:165], v[164:165], v[108:109]
v_pk_mul_f32 v[166:167], v[166:167], v[110:111]
v_pk_mul_f32 v[32:33], v[160:161], v[160:161]
v_pk_mul_f32 v[34:35], v[162:163], v[162:163]
v_pk_mul_f32 v[36:37], v[164:165], v[164:165]
v_pk_mul_f32 v[38:39], v[166:167], v[166:167]
v_pk_mul_f32 v[104:105], v[168:169], v[168:169]
v_pk_mul_f32 v[106:107], v[170:171], v[170:171]
v_pk_mul_f32 v[108:109], v[172:173], v[172:173]
v_pk_mul_f32 v[110:111], v[174:175], v[174:175]
v_pk_fma_f32 v[104:105], v[104:105], s[42:43], v[12:13]
v_pk_fma_f32 v[106:107], v[106:107], s[42:43], v[12:13]
v_pk_fma_f32 v[108:109], v[108:109], s[42:43], v[12:13]
v_pk_fma_f32 v[110:111], v[110:111], s[42:43], v[12:13]
v_pk_mul_f32 v[104:105], v[104:105], v[168:169]
v_pk_mul_f32 v[106:107], v[106:107], v[170:171]
v_pk_mul_f32 v[108:109], v[108:109], v[172:173]
v_pk_mul_f32 v[110:111], v[110:111], v[174:175]
v_exp_f32 v104, v104
v_exp_f32 v105, v105
v_exp_f32 v106, v106
v_exp_f32 v107, v107
v_exp_f32 v108, v108
v_exp_f32 v109, v109
v_exp_f32 v110, v110
v_exp_f32 v111, v111
v_pk_add_f32 v[104:105], v[104:105], s[44:45]
v_pk_add_f32 v[106:107], v[106:107], s[44:45]
v_pk_add_f32 v[108:109], v[108:109], s[44:45]
v_pk_add_f32 v[110:111], v[110:111], s[44:45]
v_rcp_f32 v104, v104
v_rcp_f32 v105, v105
v_rcp_f32 v106, v106
v_rcp_f32 v107, v107
v_rcp_f32 v108, v108
v_rcp_f32 v109, v109
v_rcp_f32 v110, v110
v_rcp_f32 v111, v111
v_pk_mul_f32 v[168:169], v[168:169], v[104:105]
v_pk_mul_f32 v[170:171], v[170:171], v[106:107]
v_pk_mul_f32 v[172:173], v[172:173], v[108:109]
v_pk_mul_f32 v[174:175], v[174:175], v[110:111]
v_pk_mul_f32 v[40:41], v[168:169], v[168:169]
v_pk_mul_f32 v[42:43], v[170:171], v[170:171]
v_pk_mul_f32 v[44:45], v[172:173], v[172:173]
v_pk_mul_f32 v[46:47], v[174:175], v[174:175]
v_pk_mul_f32 v[104:105], v[176:177], v[176:177]
v_pk_mul_f32 v[106:107], v[178:179], v[178:179]
v_pk_mul_f32 v[108:109], v[180:181], v[180:181]
v_pk_mul_f32 v[110:111], v[182:183], v[182:183]
v_pk_fma_f32 v[104:105], v[104:105], s[42:43], v[12:13]
v_pk_fma_f32 v[106:107], v[106:107], s[42:43], v[12:13]
v_pk_fma_f32 v[108:109], v[108:109], s[42:43], v[12:13]
v_pk_fma_f32 v[110:111], v[110:111], s[42:43], v[12:13]
v_pk_mul_f32 v[104:105], v[104:105], v[176:177]
v_pk_mul_f32 v[106:107], v[106:107], v[178:179]
v_pk_mul_f32 v[108:109], v[108:109], v[180:181]
v_pk_mul_f32 v[110:111], v[110:111], v[182:183]
v_exp_f32 v104, v104
v_exp_f32 v105, v105
v_exp_f32 v106, v106
v_exp_f32 v107, v107
v_exp_f32 v108, v108
v_exp_f32 v109, v109
v_exp_f32 v110, v110
v_exp_f32 v111, v111
v_pk_add_f32 v[104:105], v[104:105], s[44:45]
v_pk_add_f32 v[106:107], v[106:107], s[44:45]
v_pk_add_f32 v[108:109], v[108:109], s[44:45]
v_pk_add_f32 v[110:111], v[110:111], s[44:45]
v_rcp_f32 v104, v104
v_rcp_f32 v105, v105
v_rcp_f32 v106, v106
v_rcp_f32 v107, v107
v_rcp_f32 v108, v108
v_rcp_f32 v109, v109
v_rcp_f32 v110, v110
v_rcp_f32 v111, v111
v_pk_mul_f32 v[176:177], v[176:177], v[104:105]
v_pk_mul_f32 v[178:179], v[178:179], v[106:107]
v_pk_mul_f32 v[180:181], v[180:181], v[108:109]
v_pk_mul_f32 v[182:183], v[182:183], v[110:111]
v_pk_add_f32 v[16:17], v[160:161], v[176:177]
v_pk_fma_f32 v[32:33], v[176:177], v[176:177], v[32:33]
v_pk_add_f32 v[18:19], v[162:163], v[178:179]
v_pk_fma_f32 v[34:35], v[178:179], v[178:179], v[34:35]
v_pk_add_f32 v[20:21], v[164:165], v[180:181]
v_pk_fma_f32 v[36:37], v[180:181], v[180:181], v[36:37]
v_pk_add_f32 v[22:23], v[166:167], v[182:183]
v_pk_fma_f32 v[38:39], v[182:183], v[182:183], v[38:39]
v_pk_mul_f32 v[104:105], v[184:185], v[184:185]
v_pk_mul_f32 v[106:107], v[186:187], v[186:187]
v_pk_mul_f32 v[108:109], v[188:189], v[188:189]
v_pk_mul_f32 v[110:111], v[190:191], v[190:191]
v_pk_fma_f32 v[104:105], v[104:105], s[42:43], v[12:13]
v_pk_fma_f32 v[106:107], v[106:107], s[42:43], v[12:13]
v_pk_fma_f32 v[108:109], v[108:109], s[42:43], v[12:13]
v_pk_fma_f32 v[110:111], v[110:111], s[42:43], v[12:13]
v_pk_mul_f32 v[104:105], v[104:105], v[184:185]
v_pk_mul_f32 v[106:107], v[106:107], v[186:187]
v_pk_mul_f32 v[108:109], v[108:109], v[188:189]
v_pk_mul_f32 v[110:111], v[110:111], v[190:191]
v_exp_f32 v104, v104
v_exp_f32 v105, v105
v_exp_f32 v106, v106
v_exp_f32 v107, v107
v_exp_f32 v108, v108
v_exp_f32 v109, v109
v_exp_f32 v110, v110
v_exp_f32 v111, v111
v_pk_add_f32 v[104:105], v[104:105], s[44:45]
v_pk_add_f32 v[106:107], v[106:107], s[44:45]
v_pk_add_f32 v[108:109], v[108:109], s[44:45]
v_pk_add_f32 v[110:111], v[110:111], s[44:45]
v_rcp_f32 v104, v104
v_rcp_f32 v105, v105
v_rcp_f32 v106, v106
v_rcp_f32 v107, v107
v_rcp_f32 v108, v108
v_rcp_f32 v109, v109
v_rcp_f32 v110, v110
v_rcp_f32 v111, v111
v_pk_mul_f32 v[184:185], v[184:185], v[104:105]
v_pk_mul_f32 v[186:187], v[186:187], v[106:107]
v_pk_mul_f32 v[188:189], v[188:189], v[108:109]
v_pk_mul_f32 v[190:191], v[190:191], v[110:111]
v_pk_add_f32 v[24:25], v[168:169], v[184:185]
v_pk_fma_f32 v[40:41], v[184:185], v[184:185], v[40:41]
v_pk_add_f32 v[26:27], v[170:171], v[186:187]
v_pk_fma_f32 v[42:43], v[186:187], v[186:187], v[42:43]
v_pk_add_f32 v[28:29], v[172:173], v[188:189]
v_pk_fma_f32 v[44:45], v[188:189], v[188:189], v[44:45]
v_pk_add_f32 v[30:31], v[174:175], v[190:191]
v_pk_fma_f32 v[46:47], v[190:191], v[190:191], v[46:47]
s_nop 0
s_nop 1
v_add_f32_dpp v16, v16, v16 row_ror:8 row_mask:0xf bank_mask:0x3
v_add_f32_dpp v17, v17, v17 row_ror:8 row_mask:0xf bank_mask:0x3
v_add_f32_dpp v18, v18, v18 row_ror:8 row_mask:0xf bank_mask:0x3
v_add_f32_dpp v19, v19, v19 row_ror:8 row_mask:0xf bank_mask:0x3
v_add_f32_dpp v20, v20, v20 row_ror:8 row_mask:0xf bank_mask:0x3
v_add_f32_dpp v21, v21, v21 row_ror:8 row_mask:0xf bank_mask:0x3
v_add_f32_dpp v22, v22, v22 row_ror:8 row_mask:0xf bank_mask:0x3
v_add_f32_dpp v23, v23, v23 row_ror:8 row_mask:0xf bank_mask:0x3
v_add_f32_dpp v24, v24, v24 row_ror:8 row_mask:0xf bank_mask:0x3
v_add_f32_dpp v25, v25, v25 row_ror:8 row_mask:0xf bank_mask:0x3
v_add_f32_dpp v26, v26, v26 row_ror:8 row_mask:0xf bank_mask:0x3
v_add_f32_dpp v27, v27, v27 row_ror:8 row_mask:0xf bank_mask:0x3
v_add_f32_dpp v28, v28, v28 row_ror:8 row_mask:0xf bank_mask:0x3
v_add_f32_dpp v29, v29, v29 row_ror:8 row_mask:0xf bank_mask:0x3
v_add_f32_dpp v30, v30, v30 row_ror:8 row_mask:0xf bank_mask:0x3
v_add_f32_dpp v31, v31, v31 row_ror:8 row_mask:0xf bank_mask:0x3
v_add_f32_dpp v16, v32, v32 row_ror:8 row_mask:0xf bank_mask:0xc
v_add_f32_dpp v17, v33, v33 row_ror:8 row_mask:0xf bank_mask:0xc
v_add_f32_dpp v18, v34, v34 row_ror:8 row_mask:0xf bank_mask:0xc
v_add_f32_dpp v19, v35, v35 row_ror:8 row_mask:0xf bank_mask:0xc
v_add_f32_dpp v20, v36, v36 row_ror:8 row_mask:0xf bank_mask:0xc
v_add_f32_dpp v21, v37, v37 row_ror:8 row_mask:0xf bank_mask:0xc
v_add_f32_dpp v22, v38, v38 row_ror:8 row_mask:0xf bank_mask:0xc
v_add_f32_dpp v23, v39, v39 row_ror:8 row_mask:0xf bank_mask:0xc
v_add_f32_dpp v24, v40, v40 row_ror:8 row_mask:0xf bank_mask:0xc
v_add_f32_dpp v25, v41, v41 row_ror:8 row_mask:0xf bank_mask:0xc
v_add_f32_dpp v26, v42, v42 row_ror:8 row_mask:0xf bank_mask:0xc
v_add_f32_dpp v27, v43, v43 row_ror:8 row_mask:0xf bank_mask:0xc
v_add_f32_dpp v28, v44, v44 row_ror:8 row_mask:0xf bank_mask:0xc
v_add_f32_dpp v29, v45, v45 row_ror:8 row_mask:0xf bank_mask:0xc
v_add_f32_dpp v30, v46, v46 row_ror:8 row_mask:0xf bank_mask:0xc
v_add_f32_dpp v31, v47, v47 row_ror:8 row_mask:0xf bank_mask:0xc
v_add_f32_dpp v16, v16, v16 row_shl:4 row_mask:0xf bank_mask:0x5
v_add_f32_dpp v17, v17, v17 row_shl:4 row_mask:0xf bank_mask:0x5
v_add_f32_dpp v18, v18, v18 row_shl:4 row_mask:0xf bank_mask:0x5
v_add_f32_dpp v19, v19, v19 row_shl:4 row_mask:0xf bank_mask:0x5
v_add_f32_dpp v20, v20, v20 row_shl:4 row_mask:0xf bank_mask:0x5
v_add_f32_dpp v21, v21, v21 row_shl:4 row_mask:0xf bank_mask:0x5
v_add_f32_dpp v22, v22, v22 row_shl:4 row_mask:0xf bank_mask:0x5
v_add_f32_dpp v23, v23, v23 row_shl:4 row_mask:0xf bank_mask:0x5
v_add_f32_dpp v16, v24, v24 row_shr:4 row_mask:0xf bank_mask:0xa
v_add_f32_dpp v17, v25, v25 row_shr:4 row_mask:0xf bank_mask:0xa
v_add_f32_dpp v18, v26, v26 row_shr:4 row_mask:0xf bank_mask:0xa
v_add_f32_dpp v19, v27, v27 row_shr:4 row_mask:0xf bank_mask:0xa
v_add_f32_dpp v20, v28, v28 row_shr:4 row_mask:0xf bank_mask:0xa
v_add_f32_dpp v21, v29, v29 row_shr:4 row_mask:0xf bank_mask:0xa
v_add_f32_dpp v22, v30, v30 row_shr:4 row_mask:0xf bank_mask:0xa
v_add_f32_dpp v23, v31, v31 row_shr:4 row_mask:0xf bank_mask:0xa
v_add_f32_dpp v16, v16, v16 quad_perm:[1,0,3,2] row_mask:0xf bank_mask:0xf
v_add_f32_dpp v17, v17, v17 quad_perm:[1,0,3,2] row_mask:0xf bank_mask:0xf
v_add_f32_dpp v18, v18, v18 quad_perm:[1,0,3,2] row_mask:0xf bank_mask:0xf
v_add_f32_dpp v19, v19, v19 quad_perm:[1,0,3,2] row_mask:0xf bank_mask:0xf
v_add_f32_dpp v20, v20, v20 quad_perm:[1,0,3,2] row_mask:0xf bank_mask:0xf
v_add_f32_dpp v21, v21, v21 quad_perm:[1,0,3,2] row_mask:0xf bank_mask:0xf
v_add_f32_dpp v22, v22, v22 quad_perm:[1,0,3,2] row_mask:0xf bank_mask:0xf
v_add_f32_dpp v23, v23, v23 quad_perm:[1,0,3,2] row_mask:0xf bank_mask:0xf
v_add_f32_dpp v16, v16, v16 quad_perm:[2,3,0,1] row_mask:0xf bank_mask:0xf
v_add_f32_dpp v17, v17, v17 quad_perm:[2,3,0,1] row_mask:0xf bank_mask:0xf
v_add_f32_dpp v18, v18, v18 quad_perm:[2,3,0,1] row_mask:0xf bank_mask:0xf
v_add_f32_dpp v19, v19, v19 quad_perm:[2,3,0,1] row_mask:0xf bank_mask:0xf
v_add_f32_dpp v20, v20, v20 quad_perm:[2,3,0,1] row_mask:0xf bank_mask:0xf
v_add_f32_dpp v21, v21, v21 quad_perm:[2,3,0,1] row_mask:0xf bank_mask:0xf
v_add_f32_dpp v22, v22, v22 quad_perm:[2,3,0,1] row_mask:0xf bank_mask:0xf
v_add_f32_dpp v23, v23, v23 quad_perm:[2,3,0,1] row_mask:0xf bank_mask:0xf
s_mov_b32 s30, 0x11111111
s_mov_b32 s31, 0x11111111
s_mov_b64 exec, s[30:31]
ds_write_b128 v2, v[16:19] offset:3072
ds_write_b128 v2, v[20:23] offset:3088
s_mov_b64 exec, -1
s_waitcnt lgkmcnt(0)
s_barrier
v_pk_mul_f32 v[104:105], v[128:129], s[46:47]
v_pk_mul_f32 v[106:107], v[130:131], s[46:47]
v_pk_mul_f32 v[108:109], v[144:145], s[46:47]
v_pk_mul_f32 v[110:111], v[146:147], s[46:47]
v_max_f32 v128, 0, v128
v_max_f32 v129, 0, v129
v_max_f32 v130, 0, v130
v_max_f32 v131, 0, v131
v_max_f32 v144, 0, v144
v_max_f32 v145, 0, v145
v_max_f32 v146, 0, v146
v_max_f32 v147, 0, v147
v_exp_f32_e64 v104, v104 clamp
v_exp_f32_e64 v105, v105 clamp
v_exp_f32_e64 v106, v106 clamp
v_exp_f32_e64 v107, v107 clamp
v_exp_f32_e64 v108, v108 clamp
v_exp_f32_e64 v109, v109 clamp
v_exp_f32_e64 v110, v110 clamp
v_exp_f32_e64 v111, v111 clamp
v_pk_add_f32 v[128:129], v[128:129], s[48:49]
v_pk_add_f32 v[130:131], v[130:131], s[48:49]
v_pk_add_f32 v[144:145], v[144:145], s[48:49]
v_pk_add_f32 v[146:147], v[146:147], s[48:49]
v_pk_add_f32 v[128:129], v[128:129], v[104:105]
v_pk_add_f32 v[130:131], v[130:131], v[106:107]
v_pk_add_f32 v[144:145], v[144:145], v[108:109]
v_pk_add_f32 v[146:147], v[146:147], v[110:111]
v_cvt_pk_bf16_f32 v240, v128, v129
v_cvt_pk_bf16_f32 v241, v130, v131
v_cvt_pk_bf16_f32 v242, v144, v145
v_cvt_pk_bf16_f32 v243, v146, v147
v_pk_mul_f32 v[104:105], v[132:133], s[46:47]
v_pk_mul_f32 v[106:107], v[134:135], s[46:47]
v_pk_mul_f32 v[108:109], v[148:149], s[46:47]
v_pk_mul_f32 v[110:111], v[150:151], s[46:47]
v_max_f32 v132, 0, v132
v_max_f32 v133, 0, v133
v_max_f32 v134, 0, v134
v_max_f32 v135, 0, v135
v_max_f32 v148, 0, v148
v_max_f32 v149, 0, v149
v_max_f32 v150, 0, v150
v_max_f32 v151, 0, v151
v_exp_f32_e64 v104, v104 clamp
v_exp_f32_e64 v105, v105 clamp
v_exp_f32_e64 v106, v106 clamp
v_exp_f32_e64 v107, v107 clamp
v_exp_f32_e64 v108, v108 clamp
v_exp_f32_e64 v109, v109 clamp
v_exp_f32_e64 v110, v110 clamp
v_exp_f32_e64 v111, v111 clamp
v_pk_add_f32 v[132:133], v[132:133], s[48:49]
v_pk_add_f32 v[134:135], v[134:135], s[48:49]
v_pk_add_f32 v[148:149], v[148:149], s[48:49]
v_pk_add_f32 v[150:151], v[150:151], s[48:49]
v_pk_add_f32 v[132:133], v[132:133], v[104:105]
v_pk_add_f32 v[134:135], v[134:135], v[106:107]
v_pk_add_f32 v[148:149], v[148:149], v[108:109]
v_pk_add_f32 v[150:151], v[150:151], v[110:111]
v_cvt_pk_bf16_f32 v244, v132, v133
v_cvt_pk_bf16_f32 v245, v134, v135
v_cvt_pk_bf16_f32 v246, v148, v149
v_cvt_pk_bf16_f32 v247, v150, v151
v_pk_mul_f32 v[104:105], v[136:137], s[46:47]
v_pk_mul_f32 v[106:107], v[138:139], s[46:47]
v_pk_mul_f32 v[108:109], v[152:153], s[46:47]
v_pk_mul_f32 v[110:111], v[154:155], s[46:47]
v_max_f32 v136, 0, v136
v_max_f32 v137, 0, v137
v_max_f32 v138, 0, v138
v_max_f32 v139, 0, v139
v_max_f32 v152, 0, v152
v_max_f32 v153, 0, v153
v_max_f32 v154, 0, v154
v_max_f32 v155, 0, v155
v_exp_f32_e64 v104, v104 clamp
v_exp_f32_e64 v105, v105 clamp
v_exp_f32_e64 v106, v106 clamp
v_exp_f32_e64 v107, v107 clamp
v_exp_f32_e64 v108, v108 clamp
v_exp_f32_e64 v109, v109 clamp
v_exp_f32_e64 v110, v110 clamp
v_exp_f32_e64 v111, v111 clamp
v_pk_add_f32 v[136:137], v[136:137], s[48:49]
v_pk_add_f32 v[138:139], v[138:139], s[48:49]
v_pk_add_f32 v[152:153], v[152:153], s[48:49]
v_pk_add_f32 v[154:155], v[154:155], s[48:49]
v_pk_add_f32 v[136:137], v[136:137], v[104:105]
v_pk_add_f32 v[138:139], v[138:139], v[106:107]
v_pk_add_f32 v[152:153], v[152:153], v[108:109]
v_pk_add_f32 v[154:155], v[154:155], v[110:111]
v_cvt_pk_bf16_f32 v248, v136, v137
v_cvt_pk_bf16_f32 v249, v138, v139
v_cvt_pk_bf16_f32 v250, v152, v153
v_cvt_pk_bf16_f32 v251, v154, v155
v_pk_mul_f32 v[104:105], v[140:141], s[46:47]
v_pk_mul_f32 v[106:107], v[142:143], s[46:47]
v_pk_mul_f32 v[108:109], v[156:157], s[46:47]
v_pk_mul_f32 v[110:111], v[158:159], s[46:47]
v_max_f32 v140, 0, v140
v_max_f32 v141, 0, v141
v_max_f32 v142, 0, v142
v_max_f32 v143, 0, v143
v_max_f32 v156, 0, v156
v_max_f32 v157, 0, v157
v_max_f32 v158, 0, v158
v_max_f32 v159, 0, v159
v_exp_f32_e64 v104, v104 clamp
v_exp_f32_e64 v105, v105 clamp
v_exp_f32_e64 v106, v106 clamp
v_exp_f32_e64 v107, v107 clamp
v_exp_f32_e64 v108, v108 clamp
v_exp_f32_e64 v109, v109 clamp
v_exp_f32_e64 v110, v110 clamp
v_exp_f32_e64 v111, v111 clamp
v_pk_add_f32 v[140:141], v[140:141], s[48:49]
v_pk_add_f32 v[142:143], v[142:143], s[48:49]
v_pk_add_f32 v[156:157], v[156:157], s[48:49]
v_pk_add_f32 v[158:159], v[158:159], s[48:49]
v_pk_add_f32 v[140:141], v[140:141], v[104:105]
v_pk_add_f32 v[142:143], v[142:143], v[106:107]
v_pk_add_f32 v[156:157], v[156:157], v[108:109]
v_pk_add_f32 v[158:159], v[158:159], v[110:111]
v_cvt_pk_bf16_f32 v252, v140, v141
v_cvt_pk_bf16_f32 v253, v142, v143
v_cvt_pk_bf16_f32 v254, v156, v157
v_cvt_pk_bf16_f32 v255, v158, v159
s_nop 0
s_barrier
ds_read_b128 v[16:19], v5 offset:4096
ds_read_b128 v[32:35], v5 offset:4608
ds_read_b128 v[20:23], v5 offset:4112
ds_read_b128 v[36:39], v5 offset:4624
ds_read_b128 v[24:27], v5 offset:4224
ds_read_b128 v[40:43], v5 offset:4736
ds_read_b128 v[28:31], v5 offset:4240
ds_read_b128 v[44:47], v5 offset:4752
s_lshl_b32 s32, s22, 6
s_lshl_b32 s33, s21, 2
s_add_u32 s32, s32, s33
s_lshl_b32 s33, s23, 1
s_add_u32 s32, s32, s33
s_mul_i32 s32, s32, 7168
s_add_u32 s32, s32, 16777216
s_waitcnt lgkmcnt(0)
v_pk_fma_f32 v[160:161], v[160:161], v[16:17], v[32:33]
v_pk_fma_f32 v[162:163], v[162:163], v[18:19], v[34:35]
v_pk_fma_f32 v[164:165], v[164:165], v[20:21], v[36:37]
v_pk_fma_f32 v[166:167], v[166:167], v[22:23], v[38:39]
s_add_u32 s33, s32, 5120
v_cvt_pk_bf16_f32 v80, v160, v161
v_cvt_pk_bf16_f32 v81, v162, v163
v_cvt_pk_bf16_f32 v82, v164, v165
v_cvt_pk_bf16_f32 v83, v166, v167
buffer_store_dwordx4 v[80:83], v11, s[16:19], s33 offen sc1
v_pk_fma_f32 v[168:169], v[168:169], v[24:25], v[40:41]
v_pk_fma_f32 v[170:171], v[170:171], v[26:27], v[42:43]
v_pk_fma_f32 v[172:173], v[172:173], v[28:29], v[44:45]
v_pk_fma_f32 v[174:175], v[174:175], v[30:31], v[46:47]
s_add_u32 s33, s32, 12288
v_cvt_pk_bf16_f32 v84, v168, v169
v_cvt_pk_bf16_f32 v85, v170, v171
v_cvt_pk_bf16_f32 v86, v172, v173
v_cvt_pk_bf16_f32 v87, v174, v175
buffer_store_dwordx4 v[84:87], v11, s[16:19], s33 offen sc1
v_pk_fma_f32 v[176:177], v[176:177], v[16:17], v[32:33]
v_pk_fma_f32 v[178:179], v[178:179], v[18:19], v[34:35]
v_pk_fma_f32 v[180:181], v[180:181], v[20:21], v[36:37]
v_pk_fma_f32 v[182:183], v[182:183], v[22:23], v[38:39]
s_add_u32 s33, s32, 6144
v_cvt_pk_bf16_f32 v88, v176, v177
v_cvt_pk_bf16_f32 v89, v178, v179
v_cvt_pk_bf16_f32 v90, v180, v181
v_cvt_pk_bf16_f32 v91, v182, v183
buffer_store_dwordx4 v[88:91], v11, s[16:19], s33 offen sc1
v_pk_fma_f32 v[184:185], v[184:185], v[24:25], v[40:41]
v_pk_fma_f32 v[186:187], v[186:187], v[26:27], v[42:43]
v_pk_fma_f32 v[188:189], v[188:189], v[28:29], v[44:45]
v_pk_fma_f32 v[190:191], v[190:191], v[30:31], v[46:47]
s_add_u32 s33, s32, 13312
v_cvt_pk_bf16_f32 v92, v184, v185
v_cvt_pk_bf16_f32 v93, v186, v187
v_cvt_pk_bf16_f32 v94, v188, v189
v_cvt_pk_bf16_f32 v95, v190, v191
buffer_store_dwordx4 v[92:95], v11, s[16:19], s33 offen sc1
v_pk_mul_f32 v[104:105], v[192:193], v[192:193]
v_pk_mul_f32 v[106:107], v[194:195], v[194:195]
v_pk_mul_f32 v[108:109], v[196:197], v[196:197]
v_pk_mul_f32 v[110:111], v[198:199], v[198:199]
v_pk_fma_f32 v[104:105], v[104:105], s[42:43], v[12:13]
v_pk_fma_f32 v[106:107], v[106:107], s[42:43], v[12:13]
v_pk_fma_f32 v[108:109], v[108:109], s[42:43], v[12:13]
v_pk_fma_f32 v[110:111], v[110:111], s[42:43], v[12:13]
v_pk_mul_f32 v[104:105], v[104:105], v[192:193]
v_pk_mul_f32 v[106:107], v[106:107], v[194:195]
v_pk_mul_f32 v[108:109], v[108:109], v[196:197]
v_pk_mul_f32 v[110:111], v[110:111], v[198:199]
v_exp_f32 v104, v104
v_exp_f32 v105, v105
v_exp_f32 v106, v106
v_exp_f32 v107, v107
v_exp_f32 v108, v108
v_exp_f32 v109, v109
v_exp_f32 v110, v110
v_exp_f32 v111, v111
v_pk_add_f32 v[104:105], v[104:105], s[44:45]
v_pk_add_f32 v[106:107], v[106:107], s[44:45]
v_pk_add_f32 v[108:109], v[108:109], s[44:45]
v_pk_add_f32 v[110:111], v[110:111], s[44:45]
v_rcp_f32 v104, v104
v_rcp_f32 v105, v105
v_rcp_f32 v106, v106
v_rcp_f32 v107, v107
v_rcp_f32 v108, v108
v_rcp_f32 v109, v109
v_rcp_f32 v110, v110
v_rcp_f32 v111, v111
v_pk_mul_f32 v[192:193], v[192:193], v[104:105]
v_pk_mul_f32 v[194:195], v[194:195], v[106:107]
v_pk_mul_f32 v[196:197], v[196:197], v[108:109]
v_pk_mul_f32 v[198:199], v[198:199], v[110:111]
v_cvt_pk_bf16_f32 v96, v192, v193
v_cvt_pk_bf16_f32 v97, v194, v195
v_cvt_pk_bf16_f32 v98, v196, v197
v_cvt_pk_bf16_f32 v99, v198, v199
ds_write_b128 v6, v[96:99] offset:20480
v_pk_mul_f32 v[104:105], v[200:201], v[200:201]
v_pk_mul_f32 v[106:107], v[202:203], v[202:203]
v_pk_mul_f32 v[108:109], v[204:205], v[204:205]
v_pk_mul_f32 v[110:111], v[206:207], v[206:207]
v_pk_fma_f32 v[104:105], v[104:105], s[42:43], v[12:13]
v_pk_fma_f32 v[106:107], v[106:107], s[42:43], v[12:13]
v_pk_fma_f32 v[108:109], v[108:109], s[42:43], v[12:13]
v_pk_fma_f32 v[110:111], v[110:111], s[42:43], v[12:13]
v_pk_mul_f32 v[104:105], v[104:105], v[200:201]
v_pk_mul_f32 v[106:107], v[106:107], v[202:203]
v_pk_mul_f32 v[108:109], v[108:109], v[204:205]
v_pk_mul_f32 v[110:111], v[110:111], v[206:207]
v_exp_f32 v104, v104
v_exp_f32 v105, v105
v_exp_f32 v106, v106
v_exp_f32 v107, v107
v_exp_f32 v108, v108
v_exp_f32 v109, v109
v_exp_f32 v110, v110
v_exp_f32 v111, v111
v_pk_add_f32 v[104:105], v[104:105], s[44:45]
v_pk_add_f32 v[106:107], v[106:107], s[44:45]
v_pk_add_f32 v[108:109], v[108:109], s[44:45]
v_pk_add_f32 v[110:111], v[110:111], s[44:45]
v_rcp_f32 v104, v104
v_rcp_f32 v105, v105
v_rcp_f32 v106, v106
v_rcp_f32 v107, v107
v_rcp_f32 v108, v108
v_rcp_f32 v109, v109
v_rcp_f32 v110, v110
v_rcp_f32 v111, v111
v_pk_mul_f32 v[200:201], v[200:201], v[104:105]
v_pk_mul_f32 v[202:203], v[202:203], v[106:107]
v_pk_mul_f32 v[204:205], v[204:205], v[108:109]
v_pk_mul_f32 v[206:207], v[206:207], v[110:111]
v_cvt_pk_bf16_f32 v100, v200, v201
v_cvt_pk_bf16_f32 v101, v202, v203
v_cvt_pk_bf16_f32 v102, v204, v205
v_cvt_pk_bf16_f32 v103, v206, v207
ds_write_b128 v6, v[100:103] offset:21504
s_waitcnt vmcnt(0)
s_mov_b32 s36, 0
s_branch L_inic_24
L_ini_22:
buffer_load_dword v126, v127, s[4:7], 0 offen sc1
s_waitcnt vmcnt(0)
L_inic_24:
v_cmp_gt_u32 vcc, 16, v126
s_add_u32 s36, s36, 1
s_cmp_ge_u32 s36, 6000
s_cbranch_scc1 L_inix_23
s_cmp_lg_u64 vcc, 0
s_cbranch_scc1 L_ini_22
L_inix_23:
s_barrier
v_pk_mul_f32 v[104:105], v[208:209], v[208:209]
v_pk_mul_f32 v[106:107], v[210:211], v[210:211]
v_pk_mul_f32 v[108:109], v[212:213], v[212:213]
v_pk_mul_f32 v[110:111], v[214:215], v[214:215]
v_pk_fma_f32 v[104:105], v[104:105], s[42:43], v[12:13]
v_pk_fma_f32 v[106:107], v[106:107], s[42:43], v[12:13]
v_pk_fma_f32 v[108:109], v[108:109], s[42:43], v[12:13]
v_pk_fma_f32 v[110:111], v[110:111], s[42:43], v[12:13]
v_pk_mul_f32 v[104:105], v[104:105], v[208:209]
v_pk_mul_f32 v[106:107], v[106:107], v[210:211]
v_pk_mul_f32 v[108:109], v[108:109], v[212:213]
v_pk_mul_f32 v[110:111], v[110:111], v[214:215]
v_exp_f32 v104, v104
v_exp_f32 v105, v105
v_exp_f32 v106, v106
v_exp_f32 v107, v107
v_exp_f32 v108, v108
v_exp_f32 v109, v109
v_exp_f32 v110, v110
v_exp_f32 v111, v111
v_pk_add_f32 v[104:105], v[104:105], s[44:45]
v_pk_add_f32 v[106:107], v[106:107], s[44:45]
v_pk_add_f32 v[108:109], v[108:109], s[44:45]
v_pk_add_f32 v[110:111], v[110:111], s[44:45]
v_rcp_f32 v104, v104
v_rcp_f32 v105, v105
v_rcp_f32 v106, v106
v_rcp_f32 v107, v107
v_rcp_f32 v108, v108
v_rcp_f32 v109, v109
v_rcp_f32 v110, v110
v_rcp_f32 v111, v111
v_pk_mul_f32 v[208:209], v[208:209], v[104:105]
v_pk_mul_f32 v[210:211], v[210:211], v[106:107]
v_pk_mul_f32 v[212:213], v[212:213], v[108:109]
v_pk_mul_f32 v[214:215], v[214:215], v[110:111]
v_cvt_pk_bf16_f32 v96, v208, v209
v_cvt_pk_bf16_f32 v97, v210, v211
v_cvt_pk_bf16_f32 v98, v212, v213
v_cvt_pk_bf16_f32 v99, v214, v215
ds_write_b128 v6, v[96:99] offset:24576
v_pk_mul_f32 v[104:105], v[216:217], v[216:217]
v_pk_mul_f32 v[106:107], v[218:219], v[218:219]
v_pk_mul_f32 v[108:109], v[220:221], v[220:221]
v_pk_mul_f32 v[110:111], v[222:223], v[222:223]
v_pk_fma_f32 v[104:105], v[104:105], s[42:43], v[12:13]
v_pk_fma_f32 v[106:107], v[106:107], s[42:43], v[12:13]
v_pk_fma_f32 v[108:109], v[108:109], s[42:43], v[12:13]
v_pk_fma_f32 v[110:111], v[110:111], s[42:43], v[12:13]
v_pk_mul_f32 v[104:105], v[104:105], v[216:217]
v_pk_mul_f32 v[106:107], v[106:107], v[218:219]
v_pk_mul_f32 v[108:109], v[108:109], v[220:221]
v_pk_mul_f32 v[110:111], v[110:111], v[222:223]
v_exp_f32 v104, v104
v_exp_f32 v105, v105
v_exp_f32 v106, v106
v_exp_f32 v107, v107
v_exp_f32 v108, v108
v_exp_f32 v109, v109
v_exp_f32 v110, v110
v_exp_f32 v111, v111
v_pk_add_f32 v[104:105], v[104:105], s[44:45]
v_pk_add_f32 v[106:107], v[106:107], s[44:45]
v_pk_add_f32 v[108:109], v[108:109], s[44:45]
v_pk_add_f32 v[110:111], v[110:111], s[44:45]
v_rcp_f32 v104, v104
v_rcp_f32 v105, v105
v_rcp_f32 v106, v106
v_rcp_f32 v107, v107
v_rcp_f32 v108, v108
v_rcp_f32 v109, v109
v_rcp_f32 v110, v110
v_rcp_f32 v111, v111
v_pk_mul_f32 v[216:217], v[216:217], v[104:105]
v_pk_mul_f32 v[218:219], v[218:219], v[106:107]
v_pk_mul_f32 v[220:221], v[220:221], v[108:109]
v_pk_mul_f32 v[222:223], v[222:223], v[110:111]
v_cvt_pk_bf16_f32 v100, v216, v217
v_cvt_pk_bf16_f32 v101, v218, v219
v_cvt_pk_bf16_f32 v102, v220, v221
v_cvt_pk_bf16_f32 v103, v222, v223
ds_write_b128 v6, v[100:103] offset:25600
L_r2:
s_and_b32 s23, s20, 3
s_mul_i32 s24, s22, 458752
s_add_u32 s24, s24, 16777216
s_and_b32 s27, s20, 1
s_mul_i32 s27, s27, 3072
s_add_u32 s27, s27, 8192
s_add_u32 s24, s24, s27
s_add_u32 s27, s27, 16384
s_nop 0
s_waitcnt lgkmcnt(0)
s_barrier
s_add_u32 m0, s27, 0
s_nop 0
buffer_load_dwordx4 v11, s[16:19], s24 offen offset:0 sc1 lds
buffer_load_dwordx4 v11, s[16:19], s24 offen offset:1024 sc1 lds
buffer_load_dwordx4 v11, s[16:19], s24 offen offset:2048 sc1 lds
s_add_u32 s24, s24, 14336
s_add_u32 m0, s27, 30720
s_nop 0
s_nop 0
buffer_load_dwordx4 v11, s[16:19], s24 offen offset:0 sc1 lds
buffer_load_dwordx4 v11, s[16:19], s24 offen offset:1024 sc1 lds
buffer_load_dwordx4 v11, s[16:19], s24 offen offset:2048 sc1 lds
s_add_u32 s24, s24, 14336
s_add_u32 m0, s27, 61440
s_nop 0
s_nop 0
buffer_load_dwordx4 v11, s[16:19], s24 offen offset:0 sc1 lds
buffer_load_dwordx4 v11, s[16:19], s24 offen offset:1024 sc1 lds
buffer_load_dwordx4 v11, s[16:19], s24 offen offset:2048 sc1 lds
s_add_u32 s24, s24, 14336
s_add_u32 m0, s27, 92160
s_nop 0
s_nop 0
buffer_load_dwordx4 v11, s[16:19], s24 offen offset:0 sc1 lds
buffer_load_dwordx4 v11, s[16:19], s24 offen offset:1024 sc1 lds
buffer_load_dwordx4 v11, s[16:19], s24 offen offset:2048 sc1 lds
s_add_u32 s24, s24, 14336
s_waitcnt vmcnt(9)
s_barrier
ds_read_b128 v[24:27], v116 offset:0
ds_read_b128 v[28:31], v116 offset:2048
ds_read_b128 v[40:43], v121 offset:0
ds_read_b128 v[44:47], v121 offset:1024
ds_read_b128 v[48:51], v121 offset:2048
s_nop 0
s_waitcnt lgkmcnt(0)
ds_read_b128 v[32:35], v117 offset:0
v_mfma_f32_16x16x32_bf16 v[128:131], v[40:43], v[24:27], 0
ds_read_b128 v[36:39], v117 offset:2048
v_mfma_f32_16x16x32_bf16 v[132:135], v[40:43], v[28:31], 0
ds_read_b128 v[56:59], v121 offset:7168
v_mfma_f32_16x16x32_bf16 v[136:139], v[44:47], v[24:27], 0
ds_read_b128 v[60:63], v121 offset:8192
v_mfma_f32_16x16x32_bf16 v[140:143], v[44:47], v[28:31], 0
ds_read_b128 v[64:67], v121 offset:9216
v_mfma_f32_16x16x32_bf16 v[144:147], v[48:51], v[24:27], 0
v_mfma_f32_16x16x32_bf16 v[148:151], v[48:51], v[28:31], 0
s_nop 0
s_mov_b32 s29, 7
L_loop2_2:
s_waitcnt vmcnt(6) lgkmcnt(0)
s_barrier
ds_read_b128 v[24:27], v116 offset:30720
v_mfma_f32_16x16x32_bf16 v[128:131], v[56:59], v[32:35], v[128:131]
ds_read_b128 v[28:31], v116 offset:32768
s_nop 0
s_add_u32 m0, s27, 0
v_mfma_f32_16x16x32_bf16 v[132:135], v[56:59], v[36:39], v[132:135]
ds_read_b128 v[40:43], v121 offset:30720
buffer_load_dwordx4 v11, s[16:19], s24 offen offset:0 sc1 lds
v_mfma_f32_16x16x32_bf16 v[136:139], v[60:63], v[32:35], v[136:139]
ds_read_b128 v[44:47], v121 offset:31744
buffer_load_dwordx4 v11, s[16:19], s24 offen offset:1024 sc1 lds
v_mfma_f32_16x16x32_bf16 v[140:143], v[60:63], v[36:39], v[140:143]
ds_read_b128 v[48:51], v121 offset:32768
v_mfma_f32_16x16x32_bf16 v[144:147], v[64:67], v[32:35], v[144:147]
v_mfma_f32_16x16x32_bf16 v[148:151], v[64:67], v[36:39], v[148:151]
s_nop 0
s_waitcnt lgkmcnt(0)
ds_read_b128 v[32:35], v117 offset:30720
v_mfma_f32_16x16x32_bf16 v[128:131], v[40:43], v[24:27], v[128:131]
ds_read_b128 v[36:39], v117 offset:32768
v_mfma_f32_16x16x32_bf16 v[132:135], v[40:43], v[28:31], v[132:135]
ds_read_b128 v[56:59], v121 offset:37888
buffer_load_dwordx4 v11, s[16:19], s24 offen offset:2048 sc1 lds
s_add_u32 s24, s24, 14336
v_mfma_f32_16x16x32_bf16 v[136:139], v[44:47], v[24:27], v[136:139]
ds_read_b128 v[60:63], v121 offset:38912
v_mfma_f32_16x16x32_bf16 v[140:143], v[44:47], v[28:31], v[140:143]
ds_read_b128 v[64:67], v121 offset:39936
v_mfma_f32_16x16x32_bf16 v[144:147], v[48:51], v[24:27], v[144:147]
v_mfma_f32_16x16x32_bf16 v[148:151], v[48:51], v[28:31], v[148:151]
s_waitcnt vmcnt(6) lgkmcnt(0)
s_barrier
ds_read_b128 v[24:27], v118 offset:0
v_mfma_f32_16x16x32_bf16 v[128:131], v[56:59], v[32:35], v[128:131]
ds_read_b128 v[28:31], v118 offset:2048
s_add_u32 m0, s27, 30720
v_mfma_f32_16x16x32_bf16 v[132:135], v[56:59], v[36:39], v[132:135]
ds_read_b128 v[40:43], v122 offset:0
buffer_load_dwordx4 v11, s[16:19], s24 offen offset:0 sc1 lds
v_mfma_f32_16x16x32_bf16 v[136:139], v[60:63], v[32:35], v[136:139]
ds_read_b128 v[44:47], v122 offset:1024
buffer_load_dwordx4 v11, s[16:19], s24 offen offset:1024 sc1 lds
v_mfma_f32_16x16x32_bf16 v[140:143], v[60:63], v[36:39], v[140:143]
ds_read_b128 v[48:51], v122 offset:2048
v_mfma_f32_16x16x32_bf16 v[144:147], v[64:67], v[32:35], v[144:147]
v_mfma_f32_16x16x32_bf16 v[148:151], v[64:67], v[36:39], v[148:151]
s_nop 0
s_waitcnt lgkmcnt(0)
ds_read_b128 v[32:35], v119 offset:0
v_mfma_f32_16x16x32_bf16 v[128:131], v[40:43], v[24:27], v[128:131]
ds_read_b128 v[36:39], v119 offset:2048
v_mfma_f32_16x16x32_bf16 v[132:135], v[40:43], v[28:31], v[132:135]
ds_read_b128 v[56:59], v122 offset:7168
buffer_load_dwordx4 v11, s[16:19], s24 offen offset:2048 sc1 lds
s_add_u32 s24, s24, 14336
v_mfma_f32_16x16x32_bf16 v[136:139], v[44:47], v[24:27], v[136:139]
ds_read_b128 v[60:63], v122 offset:8192
v_mfma_f32_16x16x32_bf16 v[140:143], v[44:47], v[28:31], v[140:143]
ds_read_b128 v[64:67], v122 offset:9216
v_mfma_f32_16x16x32_bf16 v[144:147], v[48:51], v[24:27], v[144:147]
v_mfma_f32_16x16x32_bf16 v[148:151], v[48:51], v[28:31], v[148:151]
s_waitcnt vmcnt(6) lgkmcnt(0)
s_barrier
ds_read_b128 v[24:27], v118 offset:30720
v_mfma_f32_16x16x32_bf16 v[128:131], v[56:59], v[32:35], v[128:131]
ds_read_b128 v[28:31], v118 offset:32768
s_add_u32 m0, s27, 61440
v_mfma_f32_16x16x32_bf16 v[132:135], v[56:59], v[36:39], v[132:135]
ds_read_b128 v[40:43], v122 offset:30720
buffer_load_dwordx4 v11, s[16:19], s24 offen offset:0 sc1 lds
v_mfma_f32_16x16x32_bf16 v[136:139], v[60:63], v[32:35], v[136:139]
ds_read_b128 v[44:47], v122 offset:31744
buffer_load_dwordx4 v11, s[16:19], s24 offen offset:1024 sc1 lds
v_mfma_f32_16x16x32_bf16 v[140:143], v[60:63], v[36:39], v[140:143]
ds_read_b128 v[48:51], v122 offset:32768
v_mfma_f32_16x16x32_bf16 v[144:147], v[64:67], v[32:35], v[144:147]
v_mfma_f32_16x16x32_bf16 v[148:151], v[64:67], v[36:39], v[148:151]
s_nop 0
s_waitcnt lgkmcnt(0)
ds_read_b128 v[32:35], v119 offset:30720
v_mfma_f32_16x16x32_bf16 v[128:131], v[40:43], v[24:27], v[128:131]
ds_read_b128 v[36:39], v119 offset:32768
v_mfma_f32_16x16x32_bf16 v[132:135], v[40:43], v[28:31], v[132:135]
ds_read_b128 v[56:59], v122 offset:37888
buffer_load_dwordx4 v11, s[16:19], s24 offen offset:2048 sc1 lds
s_add_u32 s24, s24, 14336
v_mfma_f32_16x16x32_bf16 v[136:139], v[44:47], v[24:27], v[136:139]
ds_read_b128 v[60:63], v122 offset:38912
v_mfma_f32_16x16x32_bf16 v[140:143], v[44:47], v[28:31], v[140:143]
ds_read_b128 v[64:67], v122 offset:39936
v_mfma_f32_16x16x32_bf16 v[144:147], v[48:51], v[24:27], v[144:147]
v_mfma_f32_16x16x32_bf16 v[148:151], v[48:51], v[28:31], v[148:151]
s_waitcnt vmcnt(6) lgkmcnt(0)
s_barrier
ds_read_b128 v[24:27], v116 offset:0
v_mfma_f32_16x16x32_bf16 v[128:131], v[56:59], v[32:35], v[128:131]
ds_read_b128 v[28:31], v116 offset:2048
s_add_u32 m0, s27, 92160
v_mfma_f32_16x16x32_bf16 v[132:135], v[56:59], v[36:39], v[132:135]
ds_read_b128 v[40:43], v121 offset:0
buffer_load_dwordx4 v11, s[16:19], s24 offen offset:0 sc1 lds
v_mfma_f32_16x16x32_bf16 v[136:139], v[60:63], v[32:35], v[136:139]
ds_read_b128 v[44:47], v121 offset:1024
buffer_load_dwordx4 v11, s[16:19], s24 offen offset:1024 sc1 lds
v_mfma_f32_16x16x32_bf16 v[140:143], v[60:63], v[36:39], v[140:143]
ds_read_b128 v[48:51], v121 offset:2048
v_mfma_f32_16x16x32_bf16 v[144:147], v[64:67], v[32:35], v[144:147]
v_mfma_f32_16x16x32_bf16 v[148:151], v[64:67], v[36:39], v[148:151]
s_nop 0
s_waitcnt lgkmcnt(0)
ds_read_b128 v[32:35], v117 offset:0
v_mfma_f32_16x16x32_bf16 v[128:131], v[40:43], v[24:27], v[128:131]
ds_read_b128 v[36:39], v117 offset:2048
v_mfma_f32_16x16x32_bf16 v[132:135], v[40:43], v[28:31], v[132:135]
ds_read_b128 v[56:59], v121 offset:7168
buffer_load_dwordx4 v11, s[16:19], s24 offen offset:2048 sc1 lds
s_add_u32 s24, s24, 14336
v_mfma_f32_16x16x32_bf16 v[136:139], v[44:47], v[24:27], v[136:139]
ds_read_b128 v[60:63], v121 offset:8192
v_mfma_f32_16x16x32_bf16 v[140:143], v[44:47], v[28:31], v[140:143]
ds_read_b128 v[64:67], v121 offset:9216
v_mfma_f32_16x16x32_bf16 v[144:147], v[48:51], v[24:27], v[144:147]
v_mfma_f32_16x16x32_bf16 v[148:151], v[48:51], v[28:31], v[148:151]
s_sub_u32 s29, s29, 1
s_cmp_eq_u32 s29, 4
s_cbranch_scc1 L_side2_4
s_cmp_eq_u32 s29, 3
s_cbranch_scc1 L_side2_3
s_cmp_lg_u32 s29, 0
s_cbranch_scc1 L_loop2_2
v_and_b32 v12, 63, v0
s_lshl_b32 s27, s20, 10
v_add_u32 v224, s27, v11
s_lshr_b32 s38, s20, 1
s_lshl_b32 s39, s38, 11
s_and_b32 s30, s20, 1
s_lshl_b32 s31, s30, 3
s_add_u32 s39, s39, s31
v_add_u32 v225, s39, v11
v_lshrrev_b32_e64 v13, 3, v12
v_bfe_u32 v14, v12, 4, 2
v_lshlrev_b32 v14, 1, v14
v_and_b32 v15, 7, v12
v_xor_b32 v14, v14, v15
v_lshlrev_b32 v14, 4, v14
v_lshl_add_u32 v226, v13, 11, v14
s_lshl_b32 s39, s20, 14
v_add_u32 v226, s39, v226
v_bfe_u32 v13, v12, 2, 3
v_lshrrev_b32 v14, 5, v12
v_lshlrev_b32 v14, 10, v14
v_lshl_add_u32 v14, v13, 7, v14
v_lshrrev_b32_e64 v13, 1, v13
v_lshl_add_u32 v14, v13, 5, v14
v_and_b32_e64 v15, 3, v12
v_lshl_add_u32 v227, v15, 3, v14
v_xor_b32 v228, 32, v227
v_xor_b32 v229, 64, v227
v_xor_b32 v230, 96, v227
v_bfe_u32 v13, v12, 2, 2
v_lshl_add_u32 v13, v13, 3, v15
v_lshlrev_b32_e64 v231, 11, v13
v_bfe_u32 v13, v12, 4, 1
v_lshl_add_u32 v231, v13, 5, v231
v_lshrrev_b32_e64 v13, 5, v12
v_lshl_add_u32 v231, v13, 4, v231
s_lshl_b32 s26, s50, 7
s_lshl_b32 s38, s38, 5
s_add_u32 s26, s26, s38
s_lshl_b32 s30, s30, 2
s_add_u32 s26, s26, s30
s_lshl_b32 s26, s26, 11
s_lshl_b32 s40, s51, 7
s_add_u32 s26, s26, s40
s_mul_i32 s24, s50, 720896
s_add_u32 s24, s24, 25165824
s_mov_b32 s25, s40
s_lshl_b32 s41, s50, 11
s_add_u32 s41, s41, 47218688
s_lshr_b32 s30, s2, 3
s_lshl_b32 s30, s30, 3
s_add_u32 s30, s30, s20
s_lshl_b32 s30, s30, 13
s_and_b32 s31, s51, 8
s_add_u32 s31, s31, 3
s_lshl_b32 s31, s31, 7
s_add_u32 s30, s30, s31
v_lshlrev_b32 v232, 11, v12
v_add_u32 v232, s30, v232
v_cmp_gt_u32 vcc, 4, v12
v_bfrev_b32 v233, 1
v_cndmask_b32 v232, v233, v232, vcc
s_lshl_b32 s30, s21, 8
s_lshl_b32 s31, s23, 6
s_add_u32 s30, s30, s31
buffer_load_ushort v88, v120, s[60:63], s30 offen
buffer_load_ushort v90, v120, s[60:63], s30 offen offset:8
s_lshl_b32 s30, s23, 10
s_add_u32 s30, s30, 139264
v_add_u32 v16, s30, v11
buffer_load_dword v233, v232, s[64:67], 0 offen
s_waitcnt vmcnt(9) lgkmcnt(0)
s_barrier
ds_read_b128 v[24:27], v116 offset:30720
v_mfma_f32_16x16x32_bf16 v[128:131], v[56:59], v[32:35], v[128:131]
ds_read_b128 v[28:31], v116 offset:32768
v_mfma_f32_16x16x32_bf16 v[132:135], v[56:59], v[36:39], v[132:135]
ds_read_b128 v[40:43], v121 offset:30720
v_mfma_f32_16x16x32_bf16 v[136:139], v[60:63], v[32:35], v[136:139]
ds_read_b128 v[44:47], v121 offset:31744
v_mfma_f32_16x16x32_bf16 v[140:143], v[60:63], v[36:39], v[140:143]
ds_read_b128 v[48:51], v121 offset:32768
v_mfma_f32_16x16x32_bf16 v[144:147], v[64:67], v[32:35], v[144:147]
v_mfma_f32_16x16x32_bf16 v[148:151], v[64:67], v[36:39], v[148:151]
s_nop 0
s_waitcnt lgkmcnt(0)
ds_read_b128 v[32:35], v117 offset:30720
v_mfma_f32_16x16x32_bf16 v[128:131], v[40:43], v[24:27], v[128:131]
ds_read_b128 v[36:39], v117 offset:32768
v_mfma_f32_16x16x32_bf16 v[132:135], v[40:43], v[28:31], v[132:135]
ds_read_b128 v[56:59], v121 offset:37888
v_mfma_f32_16x16x32_bf16 v[136:139], v[44:47], v[24:27], v[136:139]
ds_read_b128 v[60:63], v121 offset:38912
v_mfma_f32_16x16x32_bf16 v[140:143], v[44:47], v[28:31], v[140:143]
ds_read_b128 v[64:67], v121 offset:39936
v_mfma_f32_16x16x32_bf16 v[144:147], v[48:51], v[24:27], v[144:147]
v_mfma_f32_16x16x32_bf16 v[148:151], v[48:51], v[28:31], v[148:151]
s_waitcnt vmcnt(6) lgkmcnt(0)
s_barrier
ds_read_b128 v[24:27], v118 offset:0
v_mfma_f32_16x16x32_bf16 v[128:131], v[56:59], v[32:35], v[128:131]
ds_read_b128 v[28:31], v118 offset:2048
v_mfma_f32_16x16x32_bf16 v[132:135], v[56:59], v[36:39], v[132:135]
ds_read_b128 v[40:43], v122 offset:0
v_mfma_f32_16x16x32_bf16 v[136:139], v[60:63], v[32:35], v[136:139]
ds_read_b128 v[44:47], v122 offset:1024
v_mfma_f32_16x16x32_bf16 v[140:143], v[60:63], v[36:39], v[140:143]
ds_read_b128 v[48:51], v122 offset:2048
v_mfma_f32_16x16x32_bf16 v[144:147], v[64:67], v[32:35], v[144:147]
v_mfma_f32_16x16x32_bf16 v[148:151], v[64:67], v[36:39], v[148:151]
s_nop 0
s_waitcnt lgkmcnt(0)
ds_read_b128 v[32:35], v119 offset:0
v_mfma_f32_16x16x32_bf16 v[128:131], v[40:43], v[24:27], v[128:131]
ds_read_b128 v[36:39], v119 offset:2048
v_mfma_f32_16x16x32_bf16 v[132:135], v[40:43], v[28:31], v[132:135]
ds_read_b128 v[56:59], v122 offset:7168
v_mfma_f32_16x16x32_bf16 v[136:139], v[44:47], v[24:27], v[136:139]
ds_read_b128 v[60:63], v122 offset:8192
v_mfma_f32_16x16x32_bf16 v[140:143], v[44:47], v[28:31], v[140:143]
ds_read_b128 v[64:67], v122 offset:9216
v_mfma_f32_16x16x32_bf16 v[144:147], v[48:51], v[24:27], v[144:147]
v_mfma_f32_16x16x32_bf16 v[148:151], v[48:51], v[28:31], v[148:151]
s_waitcnt vmcnt(3) lgkmcnt(0)
s_barrier
ds_read_b128 v[24:27], v118 offset:30720
v_mfma_f32_16x16x32_bf16 v[128:131], v[56:59], v[32:35], v[128:131]
ds_read_b128 v[28:31], v118 offset:32768
s_nop 0
s_add_u32 m0, s27, 0
v_mfma_f32_16x16x32_bf16 v[132:135], v[56:59], v[36:39], v[132:135]
ds_read_b128 v[40:43], v122 offset:30720
buffer_load_dwordx4 v226, s[64:67], s25 offen lds
s_add_u32 s25, s25, 131072
v_mfma_f32_16x16x32_bf16 v[136:139], v[60:63], v[32:35], v[136:139]
ds_read_b128 v[44:47], v122 offset:31744
v_mfma_f32_16x16x32_bf16 v[140:143], v[60:63], v[36:39], v[140:143]
ds_read_b128 v[48:51], v122 offset:32768
buffer_load_dwordx4 v[160:163], v224, s[16:19], s24 offen sc1
s_add_u32 s24, s24, 8192
v_mfma_f32_16x16x32_bf16 v[144:147], v[64:67], v[32:35], v[144:147]
v_mfma_f32_16x16x32_bf16 v[148:151], v[64:67], v[36:39], v[148:151]
buffer_load_dwordx4 v[164:167], v224, s[16:19], s24 offen sc1
s_add_u32 s24, s24, 8192
s_nop 0
s_waitcnt lgkmcnt(0)
ds_read_b128 v[32:35], v119 offset:30720
v_mfma_f32_16x16x32_bf16 v[128:131], v[40:43], v[24:27], v[128:131]
ds_read_b128 v[36:39], v119 offset:32768
s_add_u32 m0, s27, 8192
v_mfma_f32_16x16x32_bf16 v[132:135], v[40:43], v[28:31], v[132:135]
ds_read_b128 v[56:59], v122 offset:37888
buffer_load_dwordx4 v226, s[64:67], s25 offen lds
s_add_u32 s25, s25, 131072
v_mfma_f32_16x16x32_bf16 v[136:139], v[44:47], v[24:27], v[136:139]
ds_read_b128 v[60:63], v122 offset:38912
v_mfma_f32_16x16x32_bf16 v[140:143], v[44:47], v[28:31], v[140:143]
ds_read_b128 v[64:67], v122 offset:39936
buffer_load_dwordx4 v[168:171], v224, s[16:19], s24 offen sc1
s_add_u32 s24, s24, 8192
v_mfma_f32_16x16x32_bf16 v[144:147], v[48:51], v[24:27], v[144:147]
v_mfma_f32_16x16x32_bf16 v[148:151], v[48:51], v[28:31], v[148:151]
buffer_load_dwordx4 v[172:175], v224, s[16:19], s24 offen sc1
s_add_u32 s24, s24, 8192
s_nop 0
s_waitcnt lgkmcnt(0)
v_mfma_f32_16x16x32_bf16 v[128:131], v[56:59], v[32:35], v[128:131]
s_add_u32 m0, s27, 16384
v_mfma_f32_16x16x32_bf16 v[132:135], v[56:59], v[36:39], v[132:135]
buffer_load_dwordx4 v226, s[64:67], s25 offen lds
s_add_u32 s25, s25, 131072
v_mfma_f32_16x16x32_bf16 v[136:139], v[60:63], v[32:35], v[136:139]
v_mfma_f32_16x16x32_bf16 v[140:143], v[60:63], v[36:39], v[140:143]
buffer_load_dwordx4 v[176:179], v224, s[16:19], s24 offen sc1
s_add_u32 s24, s24, 8192
v_mfma_f32_16x16x32_bf16 v[144:147], v[64:67], v[32:35], v[144:147]
v_mfma_f32_16x16x32_bf16 v[148:151], v[64:67], v[36:39], v[148:151]
buffer_load_dwordx4 v[180:183], v224, s[16:19], s24 offen sc1
s_add_u32 s24, s24, 8192
ds_read_b128 v[72:75], v16 offset:0
ds_read_b128 v[76:79], v16 offset:4096
ds_read_b128 v[80:83], v16 offset:8192
s_mov_b32 s33, 0xffff0000
s_mul_i32 s30, s21, 720896
s_lshl_b32 s31, s23, 11
s_add_u32 s30, s30, s31
s_add_u32 s30, s30, 25427968
s_lshr_b32 s32, s22, 1
s_mul_i32 s32, s32, 57344
s_add_u32 s30, s30, s32
s_and_b32 s34, s22, 1
s_lshl_b32 s35, s34, 15
s_add_u32 s35, s35, s30
s_add_u32 s35, s35, 16384
s_lshl_b32 s39, s34, 10
s_add_u32 s39, s39, s30
s_add_u32 s39, s39, 24576
s_waitcnt vmcnt(10)
v_lshlrev_b32 v88, 16, v88
v_lshlrev_b32 v90, 16, v90
v_mov_b32 v89, v88
v_mov_b32 v91, v90
s_waitcnt lgkmcnt(0)
v_lshlrev_b32 v92, 16, v72
v_and_b32 v93, s33, v72
v_lshlrev_b32 v94, 16, v73
v_and_b32_e64 v95, s33, v73
v_pk_add_f32 v[128:129], v[128:129], v[88:89]
v_pk_add_f32 v[130:131], v[130:131], v[88:89]
v_pk_mul_f32 v[128:129], v[128:129], v[92:93]
v_pk_mul_f32 v[130:131], v[130:131], v[94:95]
v_lshlrev_b32 v96, 16, v74
v_and_b32 v97, s33, v74
v_lshlrev_b32 v98, 16, v75
v_and_b32 v99, s33, v75
v_pk_add_f32 v[132:133], v[132:133], v[90:91]
v_pk_add_f32 v[134:135], v[134:135], v[90:91]
v_pk_mul_f32 v[132:133], v[132:133], v[96:97]
v_pk_mul_f32 v[134:135], v[134:135], v[98:99]
v_lshlrev_b32 v92, 16, v76
v_and_b32 v93, s33, v76
v_lshlrev_b32 v94, 16, v77
v_and_b32 v95, s33, v77
v_pk_add_f32 v[136:137], v[136:137], v[88:89]
v_pk_add_f32 v[138:139], v[138:139], v[88:89]
v_pk_mul_f32 v[136:137], v[136:137], v[92:93]
v_pk_mul_f32 v[138:139], v[138:139], v[94:95]
v_lshlrev_b32 v96, 16, v78
v_and_b32 v97, s33, v78
v_lshlrev_b32 v98, 16, v79
v_and_b32 v99, s33, v79
v_pk_add_f32 v[140:141], v[140:141], v[90:91]
v_pk_add_f32 v[142:143], v[142:143], v[90:91]
v_pk_mul_f32 v[140:141], v[140:141], v[96:97]
v_pk_mul_f32 v[142:143], v[142:143], v[98:99]
v_cvt_pk_bf16_f32 v48, v128, v129
v_cvt_pk_bf16_f32 v49, v130, v131
v_cvt_pk_bf16_f32 v50, v136, v137
v_cvt_pk_bf16_f32 v51, v138, v139
buffer_store_dwordx4 v[48:51], v11, s[16:19], s35 offen offset:0 sc1
v_cvt_pk_bf16_f32 v52, v132, v133
v_cvt_pk_bf16_f32 v53, v134, v135
v_cvt_pk_bf16_f32 v54, v140, v141
v_cvt_pk_bf16_f32 v55, v142, v143
buffer_store_dwordx4 v[52:55], v11, s[16:19], s35 offen offset:1024 sc1
v_lshlrev_b32 v92, 16, v80
v_and_b32 v93, s33, v80
v_lshlrev_b32 v94, 16, v81
v_and_b32 v95, s33, v81
v_pk_add_f32 v[144:145], v[144:145], v[88:89]
v_pk_add_f32 v[146:147], v[146:147], v[88:89]
v_pk_mul_f32 v[144:145], v[144:145], v[92:93]
v_pk_mul_f32 v[146:147], v[146:147], v[94:95]
v_lshlrev_b32 v96, 16, v82
v_and_b32 v97, s33, v82
v_lshlrev_b32 v98, 16, v83
v_and_b32 v99, s33, v83
v_pk_add_f32 v[148:149], v[148:149], v[90:91]
v_pk_add_f32 v[150:151], v[150:151], v[90:91]
v_pk_mul_f32 v[148:149], v[148:149], v[96:97]
v_pk_mul_f32 v[150:151], v[150:151], v[98:99]
v_cvt_pk_bf16_f32 v56, v144, v145
v_cvt_pk_bf16_f32 v57, v146, v147
v_cvt_pk_bf16_f32 v58, v148, v149
v_cvt_pk_bf16_f32 v59, v150, v151
buffer_store_dwordx4 v[56:59], v11, s[16:19], s39 offen sc1
s_nop 0
s_branch L_stage3
L_side2_4:
s_lshl_b32 s38, s101, 1
s_add_u32 s38, s38, 1
s_mul_i32 s37, s38, 3072
s_add_u32 s37, s37, 46137344
buffer_load_dwordx4 v[100:103], v11, s[16:19], s37 offen offset:0 sc1
buffer_load_dwordx4 v[104:107], v11, s[16:19], s37 offen offset:1024 sc1
buffer_load_dwordx4 v[108:111], v11, s[16:19], s37 offen offset:2048 sc1
s_branch L_loop2_2
L_side2_3:
s_mov_b32 s36, 0
s_branch L_kvc_27
L_kv_25:
buffer_load_dwordx4 v[100:103], v11, s[16:19], s37 offen offset:0 sc1
buffer_load_dwordx4 v[104:107], v11, s[16:19], s37 offen offset:1024 sc1
buffer_load_dwordx4 v[108:111], v11, s[16:19], s37 offen offset:2048 sc1
s_waitcnt vmcnt(0)
L_kvc_27:
v_max3_u32 v19, v100, v101, v102
v_max3_u32 v19, v19, v103, v104
v_max3_u32 v19, v19, v105, v106
v_max3_u32 v19, v19, v107, v108
v_max3_u32 v19, v19, v109, v110
v_max_u32_e64 v19, v19, v111
v_cmp_eq_u32 vcc, -1, v19
s_add_u32 s36, s36, 1
s_cmp_ge_u32 s36, 6000
s_nop 0
s_cbranch_scc1 L_kvx_26
s_cmp_lg_u64 vcc, 0
s_cbranch_scc1 L_kv_25
L_kvx_26:
v_mfma_f32_16x16x32_bf16 v[160:163], v[100:103], v[240:243], 0
v_mfma_f32_16x16x32_bf16 v[164:167], v[104:107], v[240:243], 0
v_mfma_f32_16x16x32_bf16 v[168:171], v[108:111], v[240:243], 0
v_mfma_f32_16x16x32_bf16 v[172:175], v[100:103], v[244:247], 0
v_mfma_f32_16x16x32_bf16 v[176:179], v[104:107], v[244:247], 0
v_mfma_f32_16x16x32_bf16 v[180:183], v[108:111], v[244:247], 0
v_mfma_f32_16x16x32_bf16 v[184:187], v[100:103], v[248:251], 0
v_mfma_f32_16x16x32_bf16 v[188:191], v[104:107], v[248:251], 0
v_mfma_f32_16x16x32_bf16 v[192:195], v[108:111], v[248:251], 0
v_mfma_f32_16x16x32_bf16 v[196:199], v[100:103], v[252:255], 0
v_mfma_f32_16x16x32_bf16 v[200:203], v[104:107], v[252:255], 0
v_mfma_f32_16x16x32_bf16 v[204:207], v[108:111], v[252:255], 0
s_mul_i32 s30, s21, 720896
s_lshl_b32 s31, s38, 13
s_add_u32 s30, s30, s31
s_and_b32 s31, s20, 1
s_lshl_b32 s31, s31, 12
s_add_u32 s30, s30, s31
s_add_u32 s30, s30, 25165824
s_nop 7
v_add_f32 v168, 0x358637bd, v168
v_add_f32 v180, 0x358637bd, v180
v_add_f32 v192, 0x358637bd, v192
v_add_f32 v204, 0x358637bd, v204
v_rcp_f32 v168, v168
v_rcp_f32 v180, v180
v_rcp_f32 v192, v192
v_rcp_f32 v204, v204
v_mov_b32 v169, v168
v_mov_b32 v181, v180
v_mov_b32 v193, v192
v_mov_b32 v205, v204
v_pk_mul_f32 v[160:161], v[160:161], v[168:169]
v_pk_mul_f32 v[162:163], v[162:163], v[168:169]
v_pk_mul_f32 v[164:165], v[164:165], v[168:169]
v_pk_mul_f32 v[166:167], v[166:167], v[168:169]
v_cvt_pk_bf16_f32 v208, v160, v161
v_cvt_pk_bf16_f32 v209, v162, v163
v_cvt_pk_bf16_f32 v210, v164, v165
v_cvt_pk_bf16_f32 v211, v166, v167
buffer_store_dwordx4 v[208:211], v11, s[16:19], s30 offen offset:0 sc1
v_pk_mul_f32 v[172:173], v[172:173], v[180:181]
v_pk_mul_f32 v[174:175], v[174:175], v[180:181]
v_pk_mul_f32 v[176:177], v[176:177], v[180:181]
v_pk_mul_f32 v[178:179], v[178:179], v[180:181]
v_cvt_pk_bf16_f32 v212, v172, v173
v_cvt_pk_bf16_f32 v213, v174, v175
v_cvt_pk_bf16_f32 v214, v176, v177
v_cvt_pk_bf16_f32 v215, v178, v179
buffer_store_dwordx4 v[212:215], v11, s[16:19], s30 offen offset:1024 sc1
v_pk_mul_f32 v[184:185], v[184:185], v[192:193]
v_pk_mul_f32 v[186:187], v[186:187], v[192:193]
v_pk_mul_f32 v[188:189], v[188:189], v[192:193]
v_pk_mul_f32 v[190:191], v[190:191], v[192:193]
v_cvt_pk_bf16_f32 v216, v184, v185
v_cvt_pk_bf16_f32 v217, v186, v187
v_cvt_pk_bf16_f32 v218, v188, v189
v_cvt_pk_bf16_f32 v219, v190, v191
buffer_store_dwordx4 v[216:219], v11, s[16:19], s30 offen offset:2048 sc1
v_pk_mul_f32 v[196:197], v[196:197], v[204:205]
v_pk_mul_f32 v[198:199], v[198:199], v[204:205]
v_pk_mul_f32 v[200:201], v[200:201], v[204:205]
v_pk_mul_f32 v[202:203], v[202:203], v[204:205]
v_cvt_pk_bf16_f32 v220, v196, v197
v_cvt_pk_bf16_f32 v221, v198, v199
v_cvt_pk_bf16_f32 v222, v200, v201
v_cvt_pk_bf16_f32 v223, v202, v203
buffer_store_dwordx4 v[220:223], v11, s[16:19], s30 offen offset:3072 sc1
s_branch L_loop2_2
L_stage3:
s_add_u32 m0, s27, 24576
s_nop 0
buffer_load_dwordx4 v226, s[64:67], s25 offen lds
s_add_u32 s25, s25, 131072
buffer_load_dwordx4 v[184:187], v224, s[16:19], s24 offen sc1
s_add_u32 s24, s24, 8192
buffer_load_dwordx4 v[188:191], v224, s[16:19], s24 offen sc1
s_add_u32 s24, s24, 8192
s_add_u32 m0, s27, 32768
s_nop 0
s_nop 0
buffer_load_dwordx4 v226, s[64:67], s25 offen lds
s_add_u32 s25, s25, 131072
buffer_load_dwordx4 v[192:195], v224, s[16:19], s24 offen sc1
s_add_u32 s24, s24, 8192
buffer_load_dwordx4 v[196:199], v224, s[16:19], s24 offen sc1
s_add_u32 s24, s24, 8192
s_waitcnt vmcnt(6)
s_barrier
s_cmp_lg_u32 s20, 0
s_cbranch_scc1 L_nou_28
s_lshl_b32 s30, s21, 4
s_add_u32 s30, s30, s22
s_lshl_b32 s30, s30, 7
s_add_u32 s30, s30, 47251456
v_mov_b32 v20, 0
v_mov_b32 v21, 0
v_mov_b32 v22, 0
v_mov_b32_e64 v23, 0
s_mov_b64 exec, 0xff
buffer_store_dwordx4 v[20:23], v11, s[16:19], s30 offen sc1
s_nop 0
s_mov_b64 exec, -1
L_nou_28:
s_add_u32 s41, s41, 32768
ds_read_b64_tr_b16 v[88:89], v227 offset:0
ds_read_b64_tr_b16 v[90:91], v227 offset:2048
ds_read_b64_tr_b16 v[92:93], v228 offset:0
ds_read_b64_tr_b16 v[94:95], v228 offset:2048
ds_read_b64_tr_b16 v[96:97], v229 offset:0
ds_read_b64_tr_b16 v[98:99], v229 offset:2048
ds_read_b64_tr_b16 v[100:101], v230 offset:0
ds_read_b64_tr_b16 v[102:103], v230 offset:2048
s_add_u32 m0, s27, 40960
s_nop 0
s_nop 0
buffer_load_dwordx4 v226, s[64:67], s25 offen lds
s_add_u32 s25, s25, 131072
buffer_load_dwordx4 v[200:203], v224, s[16:19], s24 offen sc1
s_add_u32 s24, s24, 8192
buffer_load_dwordx4 v[204:207], v224, s[16:19], s24 offen sc1
s_add_u32 s24, s24, 8192
s_add_u32 m0, s27, 49152
s_nop 0
s_nop 0
buffer_load_dwordx4 v226, s[64:67], s25 offen lds
s_add_u32 s25, s25, 131072
buffer_load_dwordx4 v[208:211], v224, s[16:19], s24 offen sc1
s_add_u32 s24, s24, 8192
buffer_load_dwordx4 v[212:215], v224, s[16:19], s24 offen sc1
s_add_u32 s24, s24, 8192
s_add_u32 m0, s27, 57344
s_nop 0
s_nop 0
buffer_load_dwordx4 v226, s[64:67], s25 offen lds
s_add_u32 s25, s25, 131072
s_nop 0
s_waitcnt lgkmcnt(0)
ds_read_b64_tr_b16 v[104:105], v227 offset:4096
ds_read_b64_tr_b16 v[106:107], v227 offset:6144
v_mfma_f32_16x16x32_bf16 v[128:131], v[88:91], v[160:163], 0
ds_read_b64_tr_b16 v[108:109], v228 offset:4096
ds_read_b64_tr_b16 v[110:111], v228 offset:6144
v_mfma_f32_16x16x32_bf16 v[132:135], v[92:95], v[160:163], 0
ds_read_b64_tr_b16 v[112:113], v229 offset:4096
ds_read_b64_tr_b16 v[114:115], v229 offset:6144
v_mfma_f32_16x16x32_bf16 v[136:139], v[96:99], v[160:163], 0
ds_read_b64_tr_b16 v[116:117], v230 offset:4096
ds_read_b64_tr_b16 v[118:119], v230 offset:6144
v_mfma_f32_16x16x32_bf16 v[140:143], v[100:103], v[160:163], 0
s_waitcnt vmcnt(19) lgkmcnt(0)
s_barrier
ds_read_b64_tr_b16 v[88:89], v227 offset:8192
ds_read_b64_tr_b16 v[90:91], v227 offset:10240
v_mfma_f32_16x16x32_bf16 v[128:131], v[104:107], v[164:167], v[128:131]
ds_read_b64_tr_b16 v[92:93], v228 offset:8192
ds_read_b64_tr_b16 v[94:95], v228 offset:10240
s_nop 0
s_add_u32 m0, s27, 0
v_mfma_f32_16x16x32_bf16 v[132:135], v[108:111], v[164:167], v[132:135]
ds_read_b64_tr_b16 v[96:97], v229 offset:8192
ds_read_b64_tr_b16 v[98:99], v229 offset:10240
buffer_load_dwordx4 v226, s[64:67], s25 offen lds
s_add_u32 s25, s25, 131072
v_mfma_f32_16x16x32_bf16 v[136:139], v[112:115], v[164:167], v[136:139]
ds_read_b64_tr_b16 v[100:101], v230 offset:8192
ds_read_b64_tr_b16 v[102:103], v230 offset:10240
v_mfma_f32_16x16x32_bf16 v[140:143], v[116:119], v[164:167], v[140:143]
buffer_load_dwordx4 v[216:219], v224, s[16:19], s24 offen sc1
s_add_u32 s24, s24, 8192
s_nop 0
s_waitcnt lgkmcnt(0)
ds_read_b64_tr_b16 v[104:105], v227 offset:12288
ds_read_b64_tr_b16 v[106:107], v227 offset:14336
v_mfma_f32_16x16x32_bf16 v[128:131], v[88:91], v[168:171], v[128:131]
ds_read_b64_tr_b16 v[108:109], v228 offset:12288
ds_read_b64_tr_b16 v[110:111], v228 offset:14336
v_mfma_f32_16x16x32_bf16 v[132:135], v[92:95], v[168:171], v[132:135]
ds_read_b64_tr_b16 v[112:113], v229 offset:12288
ds_read_b64_tr_b16 v[114:115], v229 offset:14336
v_mfma_f32_16x16x32_bf16 v[136:139], v[96:99], v[168:171], v[136:139]
ds_read_b64_tr_b16 v[116:117], v230 offset:12288
ds_read_b64_tr_b16 v[118:119], v230 offset:14336
buffer_load_dwordx4 v[220:223], v224, s[16:19], s24 offen sc1
s_add_u32 s24, s24, 8192
v_mfma_f32_16x16x32_bf16 v[140:143], v[100:103], v[168:171], v[140:143]
s_waitcnt vmcnt(19) lgkmcnt(0)
s_barrier
ds_read_b64_tr_b16 v[88:89], v227 offset:16384
ds_read_b64_tr_b16 v[90:91], v227 offset:18432
v_mfma_f32_16x16x32_bf16 v[128:131], v[104:107], v[172:175], v[128:131]
ds_read_b64_tr_b16 v[92:93], v228 offset:16384
ds_read_b64_tr_b16 v[94:95], v228 offset:18432
s_add_u32 m0, s27, 8192
v_mfma_f32_16x16x32_bf16 v[132:135], v[108:111], v[172:175], v[132:135]
ds_read_b64_tr_b16 v[96:97], v229 offset:16384
ds_read_b64_tr_b16 v[98:99], v229 offset:18432
buffer_load_dwordx4 v226, s[64:67], s25 offen lds
s_add_u32 s25, s25, 131072
v_mfma_f32_16x16x32_bf16 v[136:139], v[112:115], v[172:175], v[136:139]
ds_read_b64_tr_b16 v[100:101], v230 offset:16384
ds_read_b64_tr_b16 v[102:103], v230 offset:18432
v_mfma_f32_16x16x32_bf16 v[140:143], v[116:119], v[172:175], v[140:143]
buffer_load_dwordx4 v[160:163], v224, s[16:19], s24 offen sc1
s_add_u32 s24, s24, 8192
s_nop 0
s_waitcnt lgkmcnt(0)
ds_read_b64_tr_b16 v[104:105], v227 offset:20480
ds_read_b64_tr_b16 v[106:107], v227 offset:22528
v_mfma_f32_16x16x32_bf16 v[128:131], v[88:91], v[176:179], v[128:131]
ds_read_b64_tr_b16 v[108:109], v228 offset:20480
ds_read_b64_tr_b16 v[110:111], v228 offset:22528
v_mfma_f32_16x16x32_bf16 v[132:135], v[92:95], v[176:179], v[132:135]
ds_read_b64_tr_b16 v[112:113], v229 offset:20480
ds_read_b64_tr_b16 v[114:115], v229 offset:22528
v_mfma_f32_16x16x32_bf16 v[136:139], v[96:99], v[176:179], v[136:139]
ds_read_b64_tr_b16 v[116:117], v230 offset:20480
ds_read_b64_tr_b16 v[118:119], v230 offset:22528
buffer_load_dwordx4 v[164:167], v224, s[16:19], s24 offen sc1
s_add_u32 s24, s24, 8192
v_mfma_f32_16x16x32_bf16 v[140:143], v[100:103], v[176:179], v[140:143]
s_waitcnt vmcnt(16) lgkmcnt(0)
s_barrier
ds_read_b64_tr_b16 v[88:89], v227 offset:24576
ds_read_b64_tr_b16 v[90:91], v227 offset:26624
v_mfma_f32_16x16x32_bf16 v[128:131], v[104:107], v[180:183], v[128:131]
ds_read_b64_tr_b16 v[92:93], v228 offset:24576
ds_read_b64_tr_b16 v[94:95], v228 offset:26624
s_add_u32 m0, s27, 16384
v_mfma_f32_16x16x32_bf16 v[132:135], v[108:111], v[180:183], v[132:135]
ds_read_b64_tr_b16 v[96:97], v229 offset:24576
ds_read_b64_tr_b16 v[98:99], v229 offset:26624
buffer_load_dwordx4 v226, s[64:67], s25 offen lds
s_add_u32 s25, s25, 131072
v_mfma_f32_16x16x32_bf16 v[136:139], v[112:115], v[180:183], v[136:139]
ds_read_b64_tr_b16 v[100:101], v230 offset:24576
ds_read_b64_tr_b16 v[102:103], v230 offset:26624
v_mfma_f32_16x16x32_bf16 v[140:143], v[116:119], v[180:183], v[140:143]
buffer_load_dwordx4 v[168:171], v224, s[16:19], s24 offen sc1
s_add_u32 s24, s24, 8192
s_nop 0
s_waitcnt lgkmcnt(0)
ds_read_b64_tr_b16 v[104:105], v227 offset:28672
ds_read_b64_tr_b16 v[106:107], v227 offset:30720
v_mfma_f32_16x16x32_bf16 v[128:131], v[88:91], v[184:187], v[128:131]
ds_read_b64_tr_b16 v[108:109], v228 offset:28672
ds_read_b64_tr_b16 v[110:111], v228 offset:30720
v_mfma_f32_16x16x32_bf16 v[132:135], v[92:95], v[184:187], v[132:135]
ds_read_b64_tr_b16 v[112:113], v229 offset:28672
ds_read_b64_tr_b16 v[114:115], v229 offset:30720
v_mfma_f32_16x16x32_bf16 v[136:139], v[96:99], v[184:187], v[136:139]
ds_read_b64_tr_b16 v[116:117], v230 offset:28672
ds_read_b64_tr_b16 v[118:119], v230 offset:30720
buffer_load_dwordx4 v[172:175], v224, s[16:19], s24 offen sc1
s_add_u32 s24, s24, 8192
v_mfma_f32_16x16x32_bf16 v[140:143], v[100:103], v[184:187], v[140:143]
buffer_load_dword v233, v232, s[68:71], 0 offen
v_add_u32 v232, 2097152, v232
s_waitcnt vmcnt(17) lgkmcnt(0)
s_barrier
ds_read_b64_tr_b16 v[88:89], v227 offset:32768
ds_read_b64_tr_b16 v[90:91], v227 offset:34816
v_mfma_f32_16x16x32_bf16 v[128:131], v[104:107], v[188:191], v[128:131]
ds_read_b64_tr_b16 v[92:93], v228 offset:32768
ds_read_b64_tr_b16 v[94:95], v228 offset:34816
s_add_u32 m0, s27, 24576
v_mfma_f32_16x16x32_bf16 v[132:135], v[108:111], v[188:191], v[132:135]
ds_read_b64_tr_b16 v[96:97], v229 offset:32768
ds_read_b64_tr_b16 v[98:99], v229 offset:34816
buffer_load_dwordx4 v226, s[64:67], s25 offen lds
s_add_u32 s25, s25, 131072
v_mfma_f32_16x16x32_bf16 v[136:139], v[112:115], v[188:191], v[136:139]
ds_read_b64_tr_b16 v[100:101], v230 offset:32768
ds_read_b64_tr_b16 v[102:103], v230 offset:34816
v_mfma_f32_16x16x32_bf16 v[140:143], v[116:119], v[188:191], v[140:143]
buffer_load_dwordx4 v[176:179], v224, s[16:19], s24 offen sc1
s_add_u32 s24, s24, 8192
s_nop 0
s_waitcnt lgkmcnt(0)
ds_read_b64_tr_b16 v[104:105], v227 offset:36864
ds_read_b64_tr_b16 v[106:107], v227 offset:38912
v_mfma_f32_16x16x32_bf16 v[128:131], v[88:91], v[192:195], v[128:131]
ds_read_b64_tr_b16 v[108:109], v228 offset:36864
ds_read_b64_tr_b16 v[110:111], v228 offset:38912
v_mfma_f32_16x16x32_bf16 v[132:135], v[92:95], v[192:195], v[132:135]
ds_read_b64_tr_b16 v[112:113], v229 offset:36864
ds_read_b64_tr_b16 v[114:115], v229 offset:38912
v_mfma_f32_16x16x32_bf16 v[136:139], v[96:99], v[192:195], v[136:139]
ds_read_b64_tr_b16 v[116:117], v230 offset:36864
ds_read_b64_tr_b16 v[118:119], v230 offset:38912
buffer_load_dwordx4 v[180:183], v224, s[16:19], s24 offen sc1
s_add_u32 s24, s24, 8192
v_mfma_f32_16x16x32_bf16 v[140:143], v[100:103], v[192:195], v[140:143]
s_waitcnt vmcnt(17) lgkmcnt(0)
s_barrier
ds_read_b64_tr_b16 v[88:89], v227 offset:40960
ds_read_b64_tr_b16 v[90:91], v227 offset:43008
v_mfma_f32_16x16x32_bf16 v[128:131], v[104:107], v[196:199], v[128:131]
ds_read_b64_tr_b16 v[92:93], v228 offset:40960
ds_read_b64_tr_b16 v[94:95], v228 offset:43008
s_add_u32 m0, s27, 32768
v_mfma_f32_16x16x32_bf16 v[132:135], v[108:111], v[196:199], v[132:135]
ds_read_b64_tr_b16 v[96:97], v229 offset:40960
ds_read_b64_tr_b16 v[98:99], v229 offset:43008
buffer_load_dwordx4 v226, s[64:67], s25 offen lds
s_add_u32 s25, s25, 131072
v_mfma_f32_16x16x32_bf16 v[136:139], v[112:115], v[196:199], v[136:139]
ds_read_b64_tr_b16 v[100:101], v230 offset:40960
ds_read_b64_tr_b16 v[102:103], v230 offset:43008
v_mfma_f32_16x16x32_bf16 v[140:143], v[116:119], v[196:199], v[140:143]
buffer_load_dwordx4 v[184:187], v224, s[16:19], s24 offen sc1
s_add_u32 s24, s24, 8192
s_nop 0
s_waitcnt lgkmcnt(0)
ds_read_b64_tr_b16 v[104:105], v227 offset:45056
ds_read_b64_tr_b16 v[106:107], v227 offset:47104
v_mfma_f32_16x16x32_bf16 v[128:131], v[88:91], v[200:203], v[128:131]
ds_read_b64_tr_b16 v[108:109], v228 offset:45056
ds_read_b64_tr_b16 v[110:111], v228 offset:47104
v_mfma_f32_16x16x32_bf16 v[132:135], v[92:95], v[200:203], v[132:135]
ds_read_b64_tr_b16 v[112:113], v229 offset:45056
ds_read_b64_tr_b16 v[114:115], v229 offset:47104
v_mfma_f32_16x16x32_bf16 v[136:139], v[96:99], v[200:203], v[136:139]
ds_read_b64_tr_b16 v[116:117], v230 offset:45056
ds_read_b64_tr_b16 v[118:119], v230 offset:47104
buffer_load_dwordx4 v[188:191], v224, s[16:19], s24 offen sc1
s_add_u32 s24, s24, 8192
v_mfma_f32_16x16x32_bf16 v[140:143], v[100:103], v[200:203], v[140:143]
s_waitcnt vmcnt(17) lgkmcnt(0)
s_barrier
ds_read_b64_tr_b16 v[88:89], v227 offset:49152
ds_read_b64_tr_b16 v[90:91], v227 offset:51200
v_mfma_f32_16x16x32_bf16 v[128:131], v[104:107], v[204:207], v[128:131]
ds_read_b64_tr_b16 v[92:93], v228 offset:49152
ds_read_b64_tr_b16 v[94:95], v228 offset:51200
s_add_u32 m0, s27, 40960
v_mfma_f32_16x16x32_bf16 v[132:135], v[108:111], v[204:207], v[132:135]
ds_read_b64_tr_b16 v[96:97], v229 offset:49152
ds_read_b64_tr_b16 v[98:99], v229 offset:51200
buffer_load_dwordx4 v226, s[64:67], s25 offen lds
s_add_u32 s25, s25, 131072
v_mfma_f32_16x16x32_bf16 v[136:139], v[112:115], v[204:207], v[136:139]
ds_read_b64_tr_b16 v[100:101], v230 offset:49152
ds_read_b64_tr_b16 v[102:103], v230 offset:51200
v_mfma_f32_16x16x32_bf16 v[140:143], v[116:119], v[204:207], v[140:143]
buffer_load_dwordx4 v[192:195], v224, s[16:19], s24 offen sc1
s_add_u32 s24, s24, 8192
s_nop 0
s_waitcnt lgkmcnt(0)
ds_read_b64_tr_b16 v[104:105], v227 offset:53248
ds_read_b64_tr_b16 v[106:107], v227 offset:55296
v_mfma_f32_16x16x32_bf16 v[128:131], v[88:91], v[208:211], v[128:131]
ds_read_b64_tr_b16 v[108:109], v228 offset:53248
ds_read_b64_tr_b16 v[110:111], v228 offset:55296
v_mfma_f32_16x16x32_bf16 v[132:135], v[92:95], v[208:211], v[132:135]
ds_read_b64_tr_b16 v[112:113], v229 offset:53248
ds_read_b64_tr_b16 v[114:115], v229 offset:55296
v_mfma_f32_16x16x32_bf16 v[136:139], v[96:99], v[208:211], v[136:139]
ds_read_b64_tr_b16 v[116:117], v230 offset:53248
ds_read_b64_tr_b16 v[118:119], v230 offset:55296
buffer_load_dwordx4 v[196:199], v224, s[16:19], s24 offen sc1
s_add_u32 s24, s24, 8192
v_mfma_f32_16x16x32_bf16 v[140:143], v[100:103], v[208:211], v[140:143]
s_waitcnt vmcnt(16) lgkmcnt(0)
s_barrier
ds_read_b64_tr_b16 v[88:89], v227 offset:57344
ds_read_b64_tr_b16 v[90:91], v227 offset:59392
v_mfma_f32_16x16x32_bf16 v[128:131], v[104:107], v[212:215], v[128:131]
ds_read_b64_tr_b16 v[92:93], v228 offset:57344
ds_read_b64_tr_b16 v[94:95], v228 offset:59392
s_add_u32 m0, s27, 49152
v_mfma_f32_16x16x32_bf16 v[132:135], v[108:111], v[212:215], v[132:135]
ds_read_b64_tr_b16 v[96:97], v229 offset:57344
ds_read_b64_tr_b16 v[98:99], v229 offset:59392
buffer_load_dwordx4 v226, s[64:67], s25 offen lds
s_add_u32 s25, s25, 131072
v_mfma_f32_16x16x32_bf16 v[136:139], v[112:115], v[212:215], v[136:139]
ds_read_b64_tr_b16 v[100:101], v230 offset:57344
ds_read_b64_tr_b16 v[102:103], v230 offset:59392
v_mfma_f32_16x16x32_bf16 v[140:143], v[116:119], v[212:215], v[140:143]
buffer_load_dwordx4 v[200:203], v224, s[16:19], s24 offen sc1
s_add_u32 s24, s24, 8192
s_nop 0
s_waitcnt lgkmcnt(0)
ds_read_b64_tr_b16 v[104:105], v227 offset:61440
ds_read_b64_tr_b16 v[106:107], v227 offset:63488
v_mfma_f32_16x16x32_bf16 v[128:131], v[88:91], v[216:219], v[128:131]
ds_read_b64_tr_b16 v[108:109], v228 offset:61440
ds_read_b64_tr_b16 v[110:111], v228 offset:63488
v_mfma_f32_16x16x32_bf16 v[132:135], v[92:95], v[216:219], v[132:135]
ds_read_b64_tr_b16 v[112:113], v229 offset:61440
ds_read_b64_tr_b16 v[114:115], v229 offset:63488
v_mfma_f32_16x16x32_bf16 v[136:139], v[96:99], v[216:219], v[136:139]
ds_read_b64_tr_b16 v[116:117], v230 offset:61440
ds_read_b64_tr_b16 v[118:119], v230 offset:63488
buffer_load_dwordx4 v[204:207], v224, s[16:19], s24 offen sc1
s_add_u32 s24, s24, 8192
v_mfma_f32_16x16x32_bf16 v[140:143], v[100:103], v[216:219], v[140:143]
s_waitcnt vmcnt(16) lgkmcnt(0)
s_barrier
s_cmp_lg_u32 s20, 0
s_cbranch_scc1 L_nop_29
v_mov_b32 v20, 0
v_lshlrev_b32 v21, 3, v11
s_mov_b64 exec, 0xffff
buffer_load_dword v20, v21, s[16:19], s41 offen sc1
s_nop 0
s_mov_b64 exec, -1
L_nop_29:
ds_read_b64_tr_b16 v[88:89], v227 offset:0
ds_read_b64_tr_b16 v[90:91], v227 offset:2048
v_mfma_f32_16x16x32_bf16 v[128:131], v[104:107], v[220:223], v[128:131]
ds_read_b64_tr_b16 v[92:93], v228 offset:0
ds_read_b64_tr_b16 v[94:95], v228 offset:2048
s_add_u32 m0, s27, 57344
v_mfma_f32_16x16x32_bf16 v[132:135], v[108:111], v[220:223], v[132:135]
ds_read_b64_tr_b16 v[96:97], v229 offset:0
ds_read_b64_tr_b16 v[98:99], v229 offset:2048
buffer_load_dwordx4 v226, s[64:67], s25 offen lds
s_nop 0
s_mov_b32 s25, s40
v_mfma_f32_16x16x32_bf16 v[136:139], v[112:115], v[220:223], v[136:139]
ds_read_b64_tr_b16 v[100:101], v230 offset:0
ds_read_b64_tr_b16 v[102:103], v230 offset:2048
v_mfma_f32_16x16x32_bf16 v[140:143], v[116:119], v[220:223], v[140:143]
buffer_load_dwordx4 v[208:211], v224, s[16:19], s24 offen sc1
s_add_u32 s24, s24, 8192
s_nop 0
s_waitcnt lgkmcnt(0)
ds_read_b64_tr_b16 v[104:105], v227 offset:4096
ds_read_b64_tr_b16 v[106:107], v227 offset:6144
v_mfma_f32_16x16x32_bf16 v[128:131], v[88:91], v[160:163], v[128:131]
ds_read_b64_tr_b16 v[108:109], v228 offset:4096
ds_read_b64_tr_b16 v[110:111], v228 offset:6144
v_mfma_f32_16x16x32_bf16 v[132:135], v[92:95], v[160:163], v[132:135]
ds_read_b64_tr_b16 v[112:113], v229 offset:4096
ds_read_b64_tr_b16 v[114:115], v229 offset:6144
v_mfma_f32_16x16x32_bf16 v[136:139], v[96:99], v[160:163], v[136:139]
ds_read_b64_tr_b16 v[116:117], v230 offset:4096
ds_read_b64_tr_b16 v[118:119], v230 offset:6144
buffer_load_dwordx4 v[212:215], v224, s[16:19], s24 offen sc1
s_add_u32 s24, s24, 8192
v_mfma_f32_16x16x32_bf16 v[140:143], v[100:103], v[160:163], v[140:143]
s_waitcnt vmcnt(16) lgkmcnt(0)
s_barrier
ds_read_b64_tr_b16 v[88:89], v227 offset:8192
ds_read_b64_tr_b16 v[90:91], v227 offset:10240
v_mfma_f32_16x16x32_bf16 v[128:131], v[104:107], v[164:167], v[128:131]
ds_read_b64_tr_b16 v[92:93], v228 offset:8192
ds_read_b64_tr_b16 v[94:95], v228 offset:10240
s_nop 0
s_add_u32 m0, s27, 0
v_mfma_f32_16x16x32_bf16 v[132:135], v[108:111], v[164:167], v[132:135]
ds_read_b64_tr_b16 v[96:97], v229 offset:8192
ds_read_b64_tr_b16 v[98:99], v229 offset:10240
buffer_load_dwordx4 v226, s[68:71], s25 offen lds
s_add_u32 s25, s25, 131072
v_mfma_f32_16x16x32_bf16 v[136:139], v[112:115], v[164:167], v[136:139]
ds_read_b64_tr_b16 v[100:101], v230 offset:8192
ds_read_b64_tr_b16 v[102:103], v230 offset:10240
v_mfma_f32_16x16x32_bf16 v[140:143], v[116:119], v[164:167], v[140:143]
buffer_load_dwordx4 v[216:219], v224, s[16:19], s24 offen sc1
s_add_u32 s24, s24, 8192
s_nop 0
s_waitcnt lgkmcnt(0)
ds_read_b64_tr_b16 v[104:105], v227 offset:12288
ds_read_b64_tr_b16 v[106:107], v227 offset:14336
v_mfma_f32_16x16x32_bf16 v[128:131], v[88:91], v[168:171], v[128:131]
ds_read_b64_tr_b16 v[108:109], v228 offset:12288
ds_read_b64_tr_b16 v[110:111], v228 offset:14336
v_mfma_f32_16x16x32_bf16 v[132:135], v[92:95], v[168:171], v[132:135]
ds_read_b64_tr_b16 v[112:113], v229 offset:12288
ds_read_b64_tr_b16 v[114:115], v229 offset:14336
v_mfma_f32_16x16x32_bf16 v[136:139], v[96:99], v[168:171], v[136:139]
ds_read_b64_tr_b16 v[116:117], v230 offset:12288
ds_read_b64_tr_b16 v[118:119], v230 offset:14336
buffer_load_dwordx4 v[220:223], v224, s[16:19], s24 offen sc1
s_add_u32 s24, s24, 8192
v_mfma_f32_16x16x32_bf16 v[140:143], v[100:103], v[168:171], v[140:143]
s_cmp_lg_u32 s20, 0
s_cbranch_scc1 L_noc_30
s_waitcnt vmcnt(6)
s_mov_b32 s36, 0
s_branch L_pollc_33
L_poll_31:
v_mov_b32 v20, 0
v_lshlrev_b32_e64 v21, 3, v11
s_mov_b64 exec, 0xffff
buffer_load_dword v20, v21, s[16:19], s41 offen sc1
s_mov_b64 exec, -1
s_waitcnt vmcnt(0)
L_pollc_33:
v_cmp_eq_u32 vcc, -1, v20
s_add_u32 s36, s36, 1
s_cmp_ge_u32 s36, 6000
s_nop 0
s_cbranch_scc1 L_pollx_32
s_cmp_lg_u64 vcc, 0
s_cbranch_scc1 L_poll_31
L_pollx_32:
L_noc_30:
s_waitcnt vmcnt(15) lgkmcnt(0)
s_barrier
ds_read_b64_tr_b16 v[88:89], v227 offset:16384
ds_read_b64_tr_b16 v[90:91], v227 offset:18432
v_mfma_f32_16x16x32_bf16 v[128:131], v[104:107], v[172:175], v[128:131]
ds_read_b64_tr_b16 v[92:93], v228 offset:16384
ds_read_b64_tr_b16 v[94:95], v228 offset:18432
s_add_u32 m0, s27, 8192
v_mfma_f32_16x16x32_bf16 v[132:135], v[108:111], v[172:175], v[132:135]
ds_read_b64_tr_b16 v[96:97], v229 offset:16384
ds_read_b64_tr_b16 v[98:99], v229 offset:18432
buffer_load_dwordx4 v226, s[68:71], s25 offen lds
s_add_u32 s25, s25, 131072
v_mfma_f32_16x16x32_bf16 v[136:139], v[112:115], v[172:175], v[136:139]
ds_read_b64_tr_b16 v[100:101], v230 offset:16384
ds_read_b64_tr_b16 v[102:103], v230 offset:18432
v_mfma_f32_16x16x32_bf16 v[140:143], v[116:119], v[172:175], v[140:143]
buffer_load_dwordx4 v[160:163], v224, s[16:19], s24 offen sc1
s_add_u32 s24, s24, 8192
s_nop 0
s_waitcnt lgkmcnt(0)
ds_read_b64_tr_b16 v[104:105], v227 offset:20480
ds_read_b64_tr_b16 v[106:107], v227 offset:22528
v_mfma_f32_16x16x32_bf16 v[128:131], v[88:91], v[176:179], v[128:131]
ds_read_b64_tr_b16 v[108:109], v228 offset:20480
ds_read_b64_tr_b16 v[110:111], v228 offset:22528
v_mfma_f32_16x16x32_bf16 v[132:135], v[92:95], v[176:179], v[132:135]
ds_read_b64_tr_b16 v[112:113], v229 offset:20480
ds_read_b64_tr_b16 v[114:115], v229 offset:22528
v_mfma_f32_16x16x32_bf16 v[136:139], v[96:99], v[176:179], v[136:139]
ds_read_b64_tr_b16 v[116:117], v230 offset:20480
ds_read_b64_tr_b16 v[118:119], v230 offset:22528
buffer_load_dwordx4 v[164:167], v224, s[16:19], s24 offen sc1
s_add_u32 s24, s24, 8192
v_mfma_f32_16x16x32_bf16 v[140:143], v[100:103], v[176:179], v[140:143]
s_waitcnt vmcnt(15) lgkmcnt(0)
s_barrier
ds_read_b64_tr_b16 v[88:89], v227 offset:24576
ds_read_b64_tr_b16 v[90:91], v227 offset:26624
v_mfma_f32_16x16x32_bf16 v[128:131], v[104:107], v[180:183], v[128:131]
ds_read_b64_tr_b16 v[92:93], v228 offset:24576
ds_read_b64_tr_b16 v[94:95], v228 offset:26624
s_add_u32 m0, s27, 16384
v_mfma_f32_16x16x32_bf16 v[132:135], v[108:111], v[180:183], v[132:135]
ds_read_b64_tr_b16 v[96:97], v229 offset:24576
ds_read_b64_tr_b16 v[98:99], v229 offset:26624
buffer_load_dwordx4 v226, s[68:71], s25 offen lds
s_add_u32 s25, s25, 131072
v_mfma_f32_16x16x32_bf16 v[136:139], v[112:115], v[180:183], v[136:139]
ds_read_b64_tr_b16 v[100:101], v230 offset:24576
ds_read_b64_tr_b16 v[102:103], v230 offset:26624
v_mfma_f32_16x16x32_bf16 v[140:143], v[116:119], v[180:183], v[140:143]
buffer_load_dwordx4 v[168:171], v224, s[16:19], s24 offen sc1
s_add_u32 s24, s24, 8192
s_nop 0
s_waitcnt lgkmcnt(0)
ds_read_b64_tr_b16 v[104:105], v227 offset:28672
ds_read_b64_tr_b16 v[106:107], v227 offset:30720
v_mfma_f32_16x16x32_bf16 v[128:131], v[88:91], v[184:187], v[128:131]
ds_read_b64_tr_b16 v[108:109], v228 offset:28672
ds_read_b64_tr_b16 v[110:111], v228 offset:30720
v_mfma_f32_16x16x32_bf16 v[132:135], v[92:95], v[184:187], v[132:135]
ds_read_b64_tr_b16 v[112:113], v229 offset:28672
ds_read_b64_tr_b16 v[114:115], v229 offset:30720
v_mfma_f32_16x16x32_bf16 v[136:139], v[96:99], v[184:187], v[136:139]
ds_read_b64_tr_b16 v[116:117], v230 offset:28672
ds_read_b64_tr_b16 v[118:119], v230 offset:30720
buffer_load_dwordx2 v[172:173], v225, s[16:19], s24 offen sc1
buffer_load_dwordx2 v[174:175], v225, s[16:19], s24 offen offset:1024 sc1
s_add_u32 s24, s24, 8192
v_mfma_f32_16x16x32_bf16 v[140:143], v[100:103], v[184:187], v[140:143]
s_waitcnt vmcnt(16) lgkmcnt(0)
s_barrier
ds_read_b64_tr_b16 v[88:89], v227 offset:32768
ds_read_b64_tr_b16 v[90:91], v227 offset:34816
v_mfma_f32_16x16x32_bf16 v[128:131], v[104:107], v[188:191], v[128:131]
ds_read_b64_tr_b16 v[92:93], v228 offset:32768
ds_read_b64_tr_b16 v[94:95], v228 offset:34816
s_add_u32 m0, s27, 24576
v_mfma_f32_16x16x32_bf16 v[132:135], v[108:111], v[188:191], v[132:135]
ds_read_b64_tr_b16 v[96:97], v229 offset:32768
ds_read_b64_tr_b16 v[98:99], v229 offset:34816
buffer_load_dwordx4 v226, s[68:71], s25 offen lds
s_add_u32 s25, s25, 131072
v_mfma_f32_16x16x32_bf16 v[136:139], v[112:115], v[188:191], v[136:139]
ds_read_b64_tr_b16 v[100:101], v230 offset:32768
ds_read_b64_tr_b16 v[102:103], v230 offset:34816
v_mfma_f32_16x16x32_bf16 v[140:143], v[116:119], v[188:191], v[140:143]
buffer_load_dwordx4 v[176:179], v224, s[16:19], s24 offen sc1
s_add_u32 s24, s24, 8192
s_nop 0
s_waitcnt lgkmcnt(0)
ds_read_b64_tr_b16 v[104:105], v227 offset:36864
ds_read_b64_tr_b16 v[106:107], v227 offset:38912
v_mfma_f32_16x16x32_bf16 v[128:131], v[88:91], v[192:195], v[128:131]
ds_read_b64_tr_b16 v[108:109], v228 offset:36864
ds_read_b64_tr_b16 v[110:111], v228 offset:38912
v_mfma_f32_16x16x32_bf16 v[132:135], v[92:95], v[192:195], v[132:135]
ds_read_b64_tr_b16 v[112:113], v229 offset:36864
ds_read_b64_tr_b16 v[114:115], v229 offset:38912
v_mfma_f32_16x16x32_bf16 v[136:139], v[96:99], v[192:195], v[136:139]
ds_read_b64_tr_b16 v[116:117], v230 offset:36864
ds_read_b64_tr_b16 v[118:119], v230 offset:38912
buffer_load_dwordx4 v[180:183], v224, s[16:19], s24 offen sc1
s_add_u32 s24, s24, 8192
v_mfma_f32_16x16x32_bf16 v[140:143], v[100:103], v[192:195], v[140:143]
s_waitcnt vmcnt(16) lgkmcnt(0)
s_barrier
ds_read_b64_tr_b16 v[88:89], v227 offset:40960
ds_read_b64_tr_b16 v[90:91], v227 offset:43008
v_mfma_f32_16x16x32_bf16 v[128:131], v[104:107], v[196:199], v[128:131]
ds_read_b64_tr_b16 v[92:93], v228 offset:40960
ds_read_b64_tr_b16 v[94:95], v228 offset:43008
s_add_u32 m0, s27, 32768
v_mfma_f32_16x16x32_bf16 v[132:135], v[108:111], v[196:199], v[132:135]
ds_read_b64_tr_b16 v[96:97], v229 offset:40960
ds_read_b64_tr_b16 v[98:99], v229 offset:43008
buffer_load_dwordx4 v226, s[68:71], s25 offen lds
s_add_u32 s25, s25, 131072
v_mfma_f32_16x16x32_bf16 v[136:139], v[112:115], v[196:199], v[136:139]
ds_read_b64_tr_b16 v[100:101], v230 offset:40960
ds_read_b64_tr_b16 v[102:103], v230 offset:43008
v_mfma_f32_16x16x32_bf16 v[140:143], v[116:119], v[196:199], v[140:143]
buffer_load_dwordx4 v[184:187], v224, s[16:19], s24 offen sc1
s_add_u32 s24, s24, 8192
s_nop 0
s_waitcnt lgkmcnt(0)
ds_read_b64_tr_b16 v[104:105], v227 offset:45056
ds_read_b64_tr_b16 v[106:107], v227 offset:47104
v_mfma_f32_16x16x32_bf16 v[128:131], v[88:91], v[200:203], v[128:131]
ds_read_b64_tr_b16 v[108:109], v228 offset:45056
ds_read_b64_tr_b16 v[110:111], v228 offset:47104
v_mfma_f32_16x16x32_bf16 v[132:135], v[92:95], v[200:203], v[132:135]
ds_read_b64_tr_b16 v[112:113], v229 offset:45056
ds_read_b64_tr_b16 v[114:115], v229 offset:47104
v_mfma_f32_16x16x32_bf16 v[136:139], v[96:99], v[200:203], v[136:139]
ds_read_b64_tr_b16 v[116:117], v230 offset:45056
ds_read_b64_tr_b16 v[118:119], v230 offset:47104
buffer_load_dwordx4 v[188:191], v224, s[16:19], s24 offen sc1
s_add_u32 s24, s24, 8192
v_mfma_f32_16x16x32_bf16 v[140:143], v[100:103], v[200:203], v[140:143]
s_waitcnt vmcnt(16) lgkmcnt(0)
s_barrier
ds_read_b64_tr_b16 v[88:89], v227 offset:49152
ds_read_b64_tr_b16 v[90:91], v227 offset:51200
v_mfma_f32_16x16x32_bf16 v[128:131], v[104:107], v[204:207], v[128:131]
ds_read_b64_tr_b16 v[92:93], v228 offset:49152
ds_read_b64_tr_b16 v[94:95], v228 offset:51200
s_add_u32 m0, s27, 40960
v_mfma_f32_16x16x32_bf16 v[132:135], v[108:111], v[204:207], v[132:135]
ds_read_b64_tr_b16 v[96:97], v229 offset:49152
ds_read_b64_tr_b16 v[98:99], v229 offset:51200
buffer_load_dwordx4 v226, s[68:71], s25 offen lds
s_add_u32 s25, s25, 131072
v_mfma_f32_16x16x32_bf16 v[136:139], v[112:115], v[204:207], v[136:139]
ds_read_b64_tr_b16 v[100:101], v230 offset:49152
ds_read_b64_tr_b16 v[102:103], v230 offset:51200
v_mfma_f32_16x16x32_bf16 v[140:143], v[116:119], v[204:207], v[140:143]
buffer_load_dwordx4 v[192:195], v224, s[16:19], s24 offen sc1
s_add_u32 s24, s24, 8192
s_nop 0
s_waitcnt lgkmcnt(0)
ds_read_b64_tr_b16 v[104:105], v227 offset:53248
ds_read_b64_tr_b16 v[106:107], v227 offset:55296
v_mfma_f32_16x16x32_bf16 v[128:131], v[88:91], v[208:211], v[128:131]
ds_read_b64_tr_b16 v[108:109], v228 offset:53248
ds_read_b64_tr_b16 v[110:111], v228 offset:55296
v_mfma_f32_16x16x32_bf16 v[132:135], v[92:95], v[208:211], v[132:135]
ds_read_b64_tr_b16 v[112:113], v229 offset:53248
ds_read_b64_tr_b16 v[114:115], v229 offset:55296
v_mfma_f32_16x16x32_bf16 v[136:139], v[96:99], v[208:211], v[136:139]
ds_read_b64_tr_b16 v[116:117], v230 offset:53248
ds_read_b64_tr_b16 v[118:119], v230 offset:55296
buffer_load_dwordx4 v[196:199], v224, s[16:19], s24 offen sc1
s_add_u32 s24, s24, 8192
v_mfma_f32_16x16x32_bf16 v[140:143], v[100:103], v[208:211], v[140:143]
s_waitcnt vmcnt(16) lgkmcnt(0)
s_barrier
ds_read_b64_tr_b16 v[88:89], v227 offset:57344
ds_read_b64_tr_b16 v[90:91], v227 offset:59392
v_mfma_f32_16x16x32_bf16 v[128:131], v[104:107], v[212:215], v[128:131]
ds_read_b64_tr_b16 v[92:93], v228 offset:57344
ds_read_b64_tr_b16 v[94:95], v228 offset:59392
s_add_u32 m0, s27, 49152
v_mfma_f32_16x16x32_bf16 v[132:135], v[108:111], v[212:215], v[132:135]
ds_read_b64_tr_b16 v[96:97], v229 offset:57344
ds_read_b64_tr_b16 v[98:99], v229 offset:59392
buffer_load_dwordx4 v226, s[68:71], s25 offen lds
s_add_u32 s25, s25, 131072
v_mfma_f32_16x16x32_bf16 v[136:139], v[112:115], v[212:215], v[136:139]
ds_read_b64_tr_b16 v[100:101], v230 offset:57344
ds_read_b64_tr_b16 v[102:103], v230 offset:59392
v_mfma_f32_16x16x32_bf16 v[140:143], v[116:119], v[212:215], v[140:143]
buffer_load_dwordx2 v[200:201], v225, s[16:19], s24 offen sc1
buffer_load_dwordx2 v[202:203], v225, s[16:19], s24 offen offset:1024 sc1
s_add_u32 s24, s24, 8192
s_nop 0
s_waitcnt lgkmcnt(0)
ds_read_b64_tr_b16 v[104:105], v227 offset:61440
ds_read_b64_tr_b16 v[106:107], v227 offset:63488
v_mfma_f32_16x16x32_bf16 v[128:131], v[88:91], v[216:219], v[128:131]
ds_read_b64_tr_b16 v[108:109], v228 offset:61440
ds_read_b64_tr_b16 v[110:111], v228 offset:63488
v_mfma_f32_16x16x32_bf16 v[132:135], v[92:95], v[216:219], v[132:135]
ds_read_b64_tr_b16 v[112:113], v229 offset:61440
ds_read_b64_tr_b16 v[114:115], v229 offset:63488
v_mfma_f32_16x16x32_bf16 v[136:139], v[96:99], v[216:219], v[136:139]
ds_read_b64_tr_b16 v[116:117], v230 offset:61440
ds_read_b64_tr_b16 v[118:119], v230 offset:63488
buffer_load_dwordx4 v[204:207], v224, s[16:19], s24 offen sc1
s_add_u32 s24, s24, 8192
v_mfma_f32_16x16x32_bf16 v[140:143], v[100:103], v[216:219], v[140:143]
s_waitcnt vmcnt(17) lgkmcnt(0)
s_barrier
ds_read_b64_tr_b16 v[88:89], v227 offset:0
ds_read_b64_tr_b16 v[90:91], v227 offset:2048
v_mfma_f32_16x16x32_bf16 v[128:131], v[104:107], v[220:223], v[128:131]
ds_read_b64_tr_b16 v[92:93], v228 offset:0
ds_read_b64_tr_b16 v[94:95], v228 offset:2048
s_add_u32 m0, s27, 57344
v_mfma_f32_16x16x32_bf16 v[132:135], v[108:111], v[220:223], v[132:135]
ds_read_b64_tr_b16 v[96:97], v229 offset:0
ds_read_b64_tr_b16 v[98:99], v229 offset:2048
buffer_load_dwordx4 v226, s[68:71], s25 offen lds
s_add_u32 s25, s25, 131072
v_mfma_f32_16x16x32_bf16 v[136:139], v[112:115], v[220:223], v[136:139]
ds_read_b64_tr_b16 v[100:101], v230 offset:0
ds_read_b64_tr_b16 v[102:103], v230 offset:2048
v_mfma_f32_16x16x32_bf16 v[140:143], v[116:119], v[220:223], v[140:143]
buffer_load_dwordx4 v[208:211], v224, s[16:19], s24 offen sc1
s_add_u32 s24, s24, 8192
s_nop 0
s_waitcnt lgkmcnt(0)
ds_read_b64_tr_b16 v[104:105], v227 offset:4096
ds_read_b64_tr_b16 v[106:107], v227 offset:6144
v_mfma_f32_16x16x32_bf16 v[144:147], v[88:91], v[160:163], 0
ds_read_b64_tr_b16 v[108:109], v228 offset:4096
ds_read_b64_tr_b16 v[110:111], v228 offset:6144
v_mfma_f32_16x16x32_bf16 v[148:151], v[92:95], v[160:163], 0
ds_read_b64_tr_b16 v[112:113], v229 offset:4096
ds_read_b64_tr_b16 v[114:115], v229 offset:6144
v_mfma_f32_16x16x32_bf16 v[152:155], v[96:99], v[160:163], 0
ds_read_b64_tr_b16 v[116:117], v230 offset:4096
ds_read_b64_tr_b16 v[118:119], v230 offset:6144
buffer_load_dwordx4 v[212:215], v224, s[16:19], s24 offen sc1
s_add_u32 s24, s24, 8192
v_mfma_f32_16x16x32_bf16 v[156:159], v[100:103], v[160:163], 0
s_waitcnt vmcnt(16) lgkmcnt(0)
s_barrier
ds_read_b64_tr_b16 v[88:89], v227 offset:8192
ds_read_b64_tr_b16 v[90:91], v227 offset:10240
v_mfma_f32_16x16x32_bf16 v[144:147], v[104:107], v[164:167], v[144:147]
ds_read_b64_tr_b16 v[92:93], v228 offset:8192
ds_read_b64_tr_b16 v[94:95], v228 offset:10240
s_nop 0
s_add_u32 m0, s27, 0
v_mfma_f32_16x16x32_bf16 v[148:151], v[108:111], v[164:167], v[148:151]
ds_read_b64_tr_b16 v[96:97], v229 offset:8192
ds_read_b64_tr_b16 v[98:99], v229 offset:10240
buffer_load_dwordx4 v226, s[68:71], s25 offen lds
s_add_u32 s25, s25, 131072
v_mfma_f32_16x16x32_bf16 v[152:155], v[112:115], v[164:167], v[152:155]
ds_read_b64_tr_b16 v[100:101], v230 offset:8192
ds_read_b64_tr_b16 v[102:103], v230 offset:10240
v_mfma_f32_16x16x32_bf16 v[156:159], v[116:119], v[164:167], v[156:159]
buffer_load_dwordx4 v[216:219], v224, s[16:19], s24 offen sc1
s_add_u32 s24, s24, 8192
s_nop 0
s_waitcnt lgkmcnt(0)
ds_read_b64_tr_b16 v[104:105], v227 offset:12288
ds_read_b64_tr_b16 v[106:107], v227 offset:14336
v_mfma_f32_16x16x32_bf16 v[144:147], v[88:91], v[168:171], v[144:147]
ds_read_b64_tr_b16 v[108:109], v228 offset:12288
ds_read_b64_tr_b16 v[110:111], v228 offset:14336
v_mfma_f32_16x16x32_bf16 v[148:151], v[92:95], v[168:171], v[148:151]
ds_read_b64_tr_b16 v[112:113], v229 offset:12288
ds_read_b64_tr_b16 v[114:115], v229 offset:14336
v_mfma_f32_16x16x32_bf16 v[152:155], v[96:99], v[168:171], v[152:155]
ds_read_b64_tr_b16 v[116:117], v230 offset:12288
ds_read_b64_tr_b16 v[118:119], v230 offset:14336
buffer_load_dwordx4 v[220:223], v224, s[16:19], s24 offen sc1
s_add_u32 s24, s24, 8192
v_mfma_f32_16x16x32_bf16 v[156:159], v[100:103], v[168:171], v[156:159]
buffer_load_dword v233, v232, s[68:71], 0 offen
v_add_u32 v232, 2097152, v232
s_waitcnt vmcnt(17) lgkmcnt(0)
s_barrier
ds_read_b64_tr_b16 v[88:89], v227 offset:16384
ds_read_b64_tr_b16 v[90:91], v227 offset:18432
v_mfma_f32_16x16x32_bf16 v[144:147], v[104:107], v[172:175], v[144:147]
ds_read_b64_tr_b16 v[92:93], v228 offset:16384
ds_read_b64_tr_b16 v[94:95], v228 offset:18432
s_add_u32 m0, s27, 8192
v_mfma_f32_16x16x32_bf16 v[148:151], v[108:111], v[172:175], v[148:151]
ds_read_b64_tr_b16 v[96:97], v229 offset:16384
ds_read_b64_tr_b16 v[98:99], v229 offset:18432
buffer_load_dwordx4 v226, s[68:71], s25 offen lds
s_add_u32 s25, s25, 131072
v_mfma_f32_16x16x32_bf16 v[152:155], v[112:115], v[172:175], v[152:155]
ds_read_b64_tr_b16 v[100:101], v230 offset:16384
ds_read_b64_tr_b16 v[102:103], v230 offset:18432
v_mfma_f32_16x16x32_bf16 v[156:159], v[116:119], v[172:175], v[156:159]
buffer_load_dwordx4 v[160:163], v224, s[16:19], s24 offen sc1
s_add_u32 s24, s24, 8192
s_nop 0
s_waitcnt lgkmcnt(0)
ds_read_b64_tr_b16 v[104:105], v227 offset:20480
ds_read_b64_tr_b16 v[106:107], v227 offset:22528
v_mfma_f32_16x16x32_bf16 v[144:147], v[88:91], v[176:179], v[144:147]
ds_read_b64_tr_b16 v[108:109], v228 offset:20480
ds_read_b64_tr_b16 v[110:111], v228 offset:22528
v_mfma_f32_16x16x32_bf16 v[148:151], v[92:95], v[176:179], v[148:151]
ds_read_b64_tr_b16 v[112:113], v229 offset:20480
ds_read_b64_tr_b16 v[114:115], v229 offset:22528
v_mfma_f32_16x16x32_bf16 v[152:155], v[96:99], v[176:179], v[152:155]
ds_read_b64_tr_b16 v[116:117], v230 offset:20480
ds_read_b64_tr_b16 v[118:119], v230 offset:22528
buffer_load_dwordx2 v[164:165], v225, s[16:19], s24 offen sc1
buffer_load_dwordx2 v[166:167], v225, s[16:19], s24 offen offset:1024 sc1
s_add_u32 s24, s24, 8192
v_mfma_f32_16x16x32_bf16 v[156:159], v[100:103], v[176:179], v[156:159]
s_waitcnt vmcnt(18) lgkmcnt(0)
s_barrier
ds_read_b64_tr_b16 v[88:89], v227 offset:24576
ds_read_b64_tr_b16 v[90:91], v227 offset:26624
v_mfma_f32_16x16x32_bf16 v[144:147], v[104:107], v[180:183], v[144:147]
ds_read_b64_tr_b16 v[92:93], v228 offset:24576
ds_read_b64_tr_b16 v[94:95], v228 offset:26624
s_add_u32 m0, s27, 16384
v_mfma_f32_16x16x32_bf16 v[148:151], v[108:111], v[180:183], v[148:151]
ds_read_b64_tr_b16 v[96:97], v229 offset:24576
ds_read_b64_tr_b16 v[98:99], v229 offset:26624
buffer_load_dwordx4 v226, s[68:71], s25 offen lds
s_add_u32 s25, s25, 131072
v_mfma_f32_16x16x32_bf16 v[152:155], v[112:115], v[180:183], v[152:155]
ds_read_b64_tr_b16 v[100:101], v230 offset:24576
ds_read_b64_tr_b16 v[102:103], v230 offset:26624
v_mfma_f32_16x16x32_bf16 v[156:159], v[116:119], v[180:183], v[156:159]
buffer_load_dwordx4 v[168:171], v224, s[16:19], s24 offen sc1
s_add_u32 s24, s24, 8192
s_nop 0
s_waitcnt lgkmcnt(0)
ds_read_b64_tr_b16 v[104:105], v227 offset:28672
ds_read_b64_tr_b16 v[106:107], v227 offset:30720
v_mfma_f32_16x16x32_bf16 v[144:147], v[88:91], v[184:187], v[144:147]
ds_read_b64_tr_b16 v[108:109], v228 offset:28672
ds_read_b64_tr_b16 v[110:111], v228 offset:30720
v_mfma_f32_16x16x32_bf16 v[148:151], v[92:95], v[184:187], v[148:151]
ds_read_b64_tr_b16 v[112:113], v229 offset:28672
ds_read_b64_tr_b16 v[114:115], v229 offset:30720
v_mfma_f32_16x16x32_bf16 v[152:155], v[96:99], v[184:187], v[152:155]
ds_read_b64_tr_b16 v[116:117], v230 offset:28672
ds_read_b64_tr_b16 v[118:119], v230 offset:30720
buffer_load_dwordx4 v[172:175], v224, s[16:19], s24 offen sc1
s_add_u32 s24, s24, 8192
v_mfma_f32_16x16x32_bf16 v[156:159], v[100:103], v[184:187], v[156:159]
s_waitcnt vmcnt(18) lgkmcnt(0)
s_barrier
ds_read_b64_tr_b16 v[88:89], v227 offset:32768
ds_read_b64_tr_b16 v[90:91], v227 offset:34816
v_mfma_f32_16x16x32_bf16 v[144:147], v[104:107], v[188:191], v[144:147]
ds_read_b64_tr_b16 v[92:93], v228 offset:32768
ds_read_b64_tr_b16 v[94:95], v228 offset:34816
s_add_u32 m0, s27, 24576
v_mfma_f32_16x16x32_bf16 v[148:151], v[108:111], v[188:191], v[148:151]
ds_read_b64_tr_b16 v[96:97], v229 offset:32768
ds_read_b64_tr_b16 v[98:99], v229 offset:34816
buffer_load_dwordx4 v226, s[68:71], s25 offen lds
s_add_u32 s25, s25, 131072
v_mfma_f32_16x16x32_bf16 v[152:155], v[112:115], v[188:191], v[152:155]
ds_read_b64_tr_b16 v[100:101], v230 offset:32768
ds_read_b64_tr_b16 v[102:103], v230 offset:34816
v_mfma_f32_16x16x32_bf16 v[156:159], v[116:119], v[188:191], v[156:159]
buffer_load_dwordx4 v[176:179], v224, s[16:19], s24 offen sc1
s_add_u32 s24, s24, 8192
s_nop 0
s_waitcnt lgkmcnt(0)
ds_read_b64_tr_b16 v[104:105], v227 offset:36864
ds_read_b64_tr_b16 v[106:107], v227 offset:38912
v_mfma_f32_16x16x32_bf16 v[144:147], v[88:91], v[192:195], v[144:147]
ds_read_b64_tr_b16 v[108:109], v228 offset:36864
ds_read_b64_tr_b16 v[110:111], v228 offset:38912
v_mfma_f32_16x16x32_bf16 v[148:151], v[92:95], v[192:195], v[148:151]
ds_read_b64_tr_b16 v[112:113], v229 offset:36864
ds_read_b64_tr_b16 v[114:115], v229 offset:38912
v_mfma_f32_16x16x32_bf16 v[152:155], v[96:99], v[192:195], v[152:155]
ds_read_b64_tr_b16 v[116:117], v230 offset:36864
ds_read_b64_tr_b16 v[118:119], v230 offset:38912
buffer_load_dwordx4 v[180:183], v224, s[16:19], s24 offen sc1
s_add_u32 s24, s24, 8192
v_mfma_f32_16x16x32_bf16 v[156:159], v[100:103], v[192:195], v[156:159]
s_waitcnt vmcnt(17) lgkmcnt(0)
s_barrier
ds_read_b64_tr_b16 v[88:89], v227 offset:40960
ds_read_b64_tr_b16 v[90:91], v227 offset:43008
v_mfma_f32_16x16x32_bf16 v[144:147], v[104:107], v[196:199], v[144:147]
ds_read_b64_tr_b16 v[92:93], v228 offset:40960
ds_read_b64_tr_b16 v[94:95], v228 offset:43008
s_add_u32 m0, s27, 32768
v_mfma_f32_16x16x32_bf16 v[148:151], v[108:111], v[196:199], v[148:151]
ds_read_b64_tr_b16 v[96:97], v229 offset:40960
ds_read_b64_tr_b16 v[98:99], v229 offset:43008
buffer_load_dwordx4 v226, s[68:71], s25 offen lds
s_add_u32 s25, s25, 131072
v_mfma_f32_16x16x32_bf16 v[152:155], v[112:115], v[196:199], v[152:155]
ds_read_b64_tr_b16 v[100:101], v230 offset:40960
ds_read_b64_tr_b16 v[102:103], v230 offset:43008
v_mfma_f32_16x16x32_bf16 v[156:159], v[116:119], v[196:199], v[156:159]
buffer_load_dwordx4 v[184:187], v224, s[16:19], s24 offen sc1
s_add_u32 s24, s24, 8192
s_nop 0
s_waitcnt lgkmcnt(0)
ds_read_b64_tr_b16 v[104:105], v227 offset:45056
ds_read_b64_tr_b16 v[106:107], v227 offset:47104
v_mfma_f32_16x16x32_bf16 v[144:147], v[88:91], v[200:203], v[144:147]
ds_read_b64_tr_b16 v[108:109], v228 offset:45056
ds_read_b64_tr_b16 v[110:111], v228 offset:47104
v_mfma_f32_16x16x32_bf16 v[148:151], v[92:95], v[200:203], v[148:151]
ds_read_b64_tr_b16 v[112:113], v229 offset:45056
ds_read_b64_tr_b16 v[114:115], v229 offset:47104
v_mfma_f32_16x16x32_bf16 v[152:155], v[96:99], v[200:203], v[152:155]
ds_read_b64_tr_b16 v[116:117], v230 offset:45056
ds_read_b64_tr_b16 v[118:119], v230 offset:47104
buffer_load_dwordx4 v[188:191], v224, s[16:19], s24 offen sc1
s_add_u32 s24, s24, 8192
v_mfma_f32_16x16x32_bf16 v[156:159], v[100:103], v[200:203], v[156:159]
s_waitcnt vmcnt(17) lgkmcnt(0)
s_barrier
ds_read_b64_tr_b16 v[88:89], v227 offset:49152
ds_read_b64_tr_b16 v[90:91], v227 offset:51200
v_mfma_f32_16x16x32_bf16 v[144:147], v[104:107], v[204:207], v[144:147]
ds_read_b64_tr_b16 v[92:93], v228 offset:49152
ds_read_b64_tr_b16 v[94:95], v228 offset:51200
s_add_u32 m0, s27, 40960
v_mfma_f32_16x16x32_bf16 v[148:151], v[108:111], v[204:207], v[148:151]
ds_read_b64_tr_b16 v[96:97], v229 offset:49152
ds_read_b64_tr_b16 v[98:99], v229 offset:51200
buffer_load_dwordx4 v226, s[68:71], s25 offen lds
s_add_u32 s25, s25, 131072
v_mfma_f32_16x16x32_bf16 v[152:155], v[112:115], v[204:207], v[152:155]
ds_read_b64_tr_b16 v[100:101], v230 offset:49152
ds_read_b64_tr_b16 v[102:103], v230 offset:51200
v_mfma_f32_16x16x32_bf16 v[156:159], v[116:119], v[204:207], v[156:159]
buffer_load_dwordx2 v[192:193], v225, s[16:19], s24 offen sc1
buffer_load_dwordx2 v[194:195], v225, s[16:19], s24 offen offset:1024 sc1
s_add_u32 s24, s24, 8192
s_nop 0
s_waitcnt lgkmcnt(0)
ds_read_b64_tr_b16 v[104:105], v227 offset:53248
ds_read_b64_tr_b16 v[106:107], v227 offset:55296
v_mfma_f32_16x16x32_bf16 v[144:147], v[88:91], v[208:211], v[144:147]
ds_read_b64_tr_b16 v[108:109], v228 offset:53248
ds_read_b64_tr_b16 v[110:111], v228 offset:55296
v_mfma_f32_16x16x32_bf16 v[148:151], v[92:95], v[208:211], v[148:151]
ds_read_b64_tr_b16 v[112:113], v229 offset:53248
ds_read_b64_tr_b16 v[114:115], v229 offset:55296
v_mfma_f32_16x16x32_bf16 v[152:155], v[96:99], v[208:211], v[152:155]
ds_read_b64_tr_b16 v[116:117], v230 offset:53248
ds_read_b64_tr_b16 v[118:119], v230 offset:55296
buffer_load_dwordx4 v[196:199], v224, s[16:19], s24 offen sc1
s_add_u32 s24, s24, 8192
v_mfma_f32_16x16x32_bf16 v[156:159], v[100:103], v[208:211], v[156:159]
s_waitcnt vmcnt(18) lgkmcnt(0)
s_barrier
ds_read_b64_tr_b16 v[88:89], v227 offset:57344
ds_read_b64_tr_b16 v[90:91], v227 offset:59392
v_mfma_f32_16x16x32_bf16 v[144:147], v[104:107], v[212:215], v[144:147]
ds_read_b64_tr_b16 v[92:93], v228 offset:57344
ds_read_b64_tr_b16 v[94:95], v228 offset:59392
s_add_u32 m0, s27, 49152
v_mfma_f32_16x16x32_bf16 v[148:151], v[108:111], v[212:215], v[148:151]
ds_read_b64_tr_b16 v[96:97], v229 offset:57344
ds_read_b64_tr_b16 v[98:99], v229 offset:59392
buffer_load_dwordx4 v226, s[68:71], s25 offen lds
s_add_u32 s25, s25, 131072
v_mfma_f32_16x16x32_bf16 v[152:155], v[112:115], v[212:215], v[152:155]
ds_read_b64_tr_b16 v[100:101], v230 offset:57344
ds_read_b64_tr_b16 v[102:103], v230 offset:59392
v_mfma_f32_16x16x32_bf16 v[156:159], v[116:119], v[212:215], v[156:159]
buffer_load_dwordx4 v[200:203], v224, s[16:19], s24 offen sc1
s_add_u32 s24, s24, 8192
s_nop 0
s_waitcnt lgkmcnt(0)
ds_read_b64_tr_b16 v[104:105], v227 offset:61440
ds_read_b64_tr_b16 v[106:107], v227 offset:63488
v_mfma_f32_16x16x32_bf16 v[144:147], v[88:91], v[216:219], v[144:147]
ds_read_b64_tr_b16 v[108:109], v228 offset:61440
ds_read_b64_tr_b16 v[110:111], v228 offset:63488
v_mfma_f32_16x16x32_bf16 v[148:151], v[92:95], v[216:219], v[148:151]
ds_read_b64_tr_b16 v[112:113], v229 offset:61440
ds_read_b64_tr_b16 v[114:115], v229 offset:63488
v_mfma_f32_16x16x32_bf16 v[152:155], v[96:99], v[216:219], v[152:155]
ds_read_b64_tr_b16 v[116:117], v230 offset:61440
ds_read_b64_tr_b16 v[118:119], v230 offset:63488
buffer_load_dwordx4 v[204:207], v224, s[16:19], s24 offen sc1
s_add_u32 s24, s24, 8192
v_mfma_f32_16x16x32_bf16 v[156:159], v[100:103], v[216:219], v[156:159]
s_waitcnt vmcnt(16) lgkmcnt(0)
s_barrier
ds_read_b64_tr_b16 v[88:89], v227 offset:0
ds_read_b64_tr_b16 v[90:91], v227 offset:2048
v_mfma_f32_16x16x32_bf16 v[144:147], v[104:107], v[220:223], v[144:147]
ds_read_b64_tr_b16 v[92:93], v228 offset:0
ds_read_b64_tr_b16 v[94:95], v228 offset:2048
s_add_u32 m0, s27, 57344
v_mfma_f32_16x16x32_bf16 v[148:151], v[108:111], v[220:223], v[148:151]
ds_read_b64_tr_b16 v[96:97], v229 offset:0
ds_read_b64_tr_b16 v[98:99], v229 offset:2048
buffer_load_dwordx4 v226, s[68:71], s25 offen lds
s_add_u32 s25, s25, 131072
v_mfma_f32_16x16x32_bf16 v[152:155], v[112:115], v[220:223], v[152:155]
ds_read_b64_tr_b16 v[100:101], v230 offset:0
ds_read_b64_tr_b16 v[102:103], v230 offset:2048
v_mfma_f32_16x16x32_bf16 v[156:159], v[116:119], v[220:223], v[156:159]
buffer_load_dwordx4 v[208:211], v224, s[16:19], s24 offen sc1
s_add_u32 s24, s24, 8192
s_nop 0
s_waitcnt lgkmcnt(0)
ds_read_b64_tr_b16 v[104:105], v227 offset:4096
ds_read_b64_tr_b16 v[106:107], v227 offset:6144
v_mfma_f32_16x16x32_bf16 v[144:147], v[88:91], v[160:163], v[144:147]
ds_read_b64_tr_b16 v[108:109], v228 offset:4096
ds_read_b64_tr_b16 v[110:111], v228 offset:6144
v_mfma_f32_16x16x32_bf16 v[148:151], v[92:95], v[160:163], v[148:151]
ds_read_b64_tr_b16 v[112:113], v229 offset:4096
ds_read_b64_tr_b16 v[114:115], v229 offset:6144
v_mfma_f32_16x16x32_bf16 v[152:155], v[96:99], v[160:163], v[152:155]
ds_read_b64_tr_b16 v[116:117], v230 offset:4096
ds_read_b64_tr_b16 v[118:119], v230 offset:6144
buffer_load_dwordx4 v[212:215], v224, s[16:19], s24 offen sc1
s_add_u32 s24, s24, 8192
v_mfma_f32_16x16x32_bf16 v[156:159], v[100:103], v[160:163], v[156:159]
s_waitcnt vmcnt(16) lgkmcnt(0)
s_barrier
ds_read_b64_tr_b16 v[88:89], v227 offset:8192
ds_read_b64_tr_b16 v[90:91], v227 offset:10240
v_mfma_f32_16x16x32_bf16 v[144:147], v[104:107], v[164:167], v[144:147]
ds_read_b64_tr_b16 v[92:93], v228 offset:8192
ds_read_b64_tr_b16 v[94:95], v228 offset:10240
s_nop 0
s_add_u32 m0, s27, 0
v_mfma_f32_16x16x32_bf16 v[148:151], v[108:111], v[164:167], v[148:151]
ds_read_b64_tr_b16 v[96:97], v229 offset:8192
ds_read_b64_tr_b16 v[98:99], v229 offset:10240
buffer_load_dwordx4 v226, s[68:71], s25 offen lds
s_add_u32 s25, s25, 131072
v_mfma_f32_16x16x32_bf16 v[152:155], v[112:115], v[164:167], v[152:155]
ds_read_b64_tr_b16 v[100:101], v230 offset:8192
ds_read_b64_tr_b16 v[102:103], v230 offset:10240
v_mfma_f32_16x16x32_bf16 v[156:159], v[116:119], v[164:167], v[156:159]
buffer_load_dwordx4 v[216:219], v224, s[16:19], s24 offen sc1
s_add_u32 s24, s24, 8192
s_nop 0
s_waitcnt lgkmcnt(0)
ds_read_b64_tr_b16 v[104:105], v227 offset:12288
ds_read_b64_tr_b16 v[106:107], v227 offset:14336
v_mfma_f32_16x16x32_bf16 v[144:147], v[88:91], v[168:171], v[144:147]
ds_read_b64_tr_b16 v[108:109], v228 offset:12288
ds_read_b64_tr_b16 v[110:111], v228 offset:14336
v_mfma_f32_16x16x32_bf16 v[148:151], v[92:95], v[168:171], v[148:151]
ds_read_b64_tr_b16 v[112:113], v229 offset:12288
ds_read_b64_tr_b16 v[114:115], v229 offset:14336
v_mfma_f32_16x16x32_bf16 v[152:155], v[96:99], v[168:171], v[152:155]
ds_read_b64_tr_b16 v[116:117], v230 offset:12288
ds_read_b64_tr_b16 v[118:119], v230 offset:14336
buffer_load_dwordx2 v[220:221], v225, s[16:19], s24 offen sc1
buffer_load_dwordx2 v[222:223], v225, s[16:19], s24 offen offset:1024 sc1
s_add_u32 s24, s24, 8192
v_mfma_f32_16x16x32_bf16 v[156:159], v[100:103], v[168:171], v[156:159]
s_waitcnt vmcnt(17) lgkmcnt(0)
s_barrier
ds_read_b64_tr_b16 v[88:89], v227 offset:16384
ds_read_b64_tr_b16 v[90:91], v227 offset:18432
v_mfma_f32_16x16x32_bf16 v[144:147], v[104:107], v[172:175], v[144:147]
ds_read_b64_tr_b16 v[92:93], v228 offset:16384
ds_read_b64_tr_b16 v[94:95], v228 offset:18432
s_add_u32 m0, s27, 8192
v_mfma_f32_16x16x32_bf16 v[148:151], v[108:111], v[172:175], v[148:151]
ds_read_b64_tr_b16 v[96:97], v229 offset:16384
ds_read_b64_tr_b16 v[98:99], v229 offset:18432
buffer_load_dwordx4 v226, s[68:71], s25 offen lds
s_add_u32 s25, s25, 131072
v_mfma_f32_16x16x32_bf16 v[152:155], v[112:115], v[172:175], v[152:155]
ds_read_b64_tr_b16 v[100:101], v230 offset:16384
ds_read_b64_tr_b16 v[102:103], v230 offset:18432
v_mfma_f32_16x16x32_bf16 v[156:159], v[116:119], v[172:175], v[156:159]
buffer_load_dwordx4 v[160:163], v224, s[16:19], s24 offen sc1
s_add_u32 s24, s24, 8192
s_nop 0
s_waitcnt lgkmcnt(0)
ds_read_b64_tr_b16 v[104:105], v227 offset:20480
ds_read_b64_tr_b16 v[106:107], v227 offset:22528
v_mfma_f32_16x16x32_bf16 v[144:147], v[88:91], v[176:179], v[144:147]
ds_read_b64_tr_b16 v[108:109], v228 offset:20480
ds_read_b64_tr_b16 v[110:111], v228 offset:22528
v_mfma_f32_16x16x32_bf16 v[148:151], v[92:95], v[176:179], v[148:151]
ds_read_b64_tr_b16 v[112:113], v229 offset:20480
ds_read_b64_tr_b16 v[114:115], v229 offset:22528
v_mfma_f32_16x16x32_bf16 v[152:155], v[96:99], v[176:179], v[152:155]
ds_read_b64_tr_b16 v[116:117], v230 offset:20480
ds_read_b64_tr_b16 v[118:119], v230 offset:22528
buffer_load_dwordx4 v[164:167], v224, s[16:19], s24 offen sc1
s_add_u32 s24, s24, 8192
v_mfma_f32_16x16x32_bf16 v[156:159], v[100:103], v[176:179], v[156:159]
s_waitcnt vmcnt(17) lgkmcnt(0)
s_barrier
ds_read_b64_tr_b16 v[88:89], v227 offset:24576
ds_read_b64_tr_b16 v[90:91], v227 offset:26624
v_mfma_f32_16x16x32_bf16 v[144:147], v[104:107], v[180:183], v[144:147]
ds_read_b64_tr_b16 v[92:93], v228 offset:24576
ds_read_b64_tr_b16 v[94:95], v228 offset:26624
s_add_u32 m0, s27, 16384
v_mfma_f32_16x16x32_bf16 v[148:151], v[108:111], v[180:183], v[148:151]
ds_read_b64_tr_b16 v[96:97], v229 offset:24576
ds_read_b64_tr_b16 v[98:99], v229 offset:26624
buffer_load_dwordx4 v226, s[68:71], s25 offen lds
s_add_u32 s25, s25, 131072
v_mfma_f32_16x16x32_bf16 v[152:155], v[112:115], v[180:183], v[152:155]
ds_read_b64_tr_b16 v[100:101], v230 offset:24576
ds_read_b64_tr_b16 v[102:103], v230 offset:26624
v_mfma_f32_16x16x32_bf16 v[156:159], v[116:119], v[180:183], v[156:159]
buffer_load_dwordx4 v[168:171], v224, s[16:19], s24 offen sc1
s_add_u32 s24, s24, 8192
s_nop 0
s_waitcnt lgkmcnt(0)
ds_read_b64_tr_b16 v[104:105], v227 offset:28672
ds_read_b64_tr_b16 v[106:107], v227 offset:30720
v_mfma_f32_16x16x32_bf16 v[144:147], v[88:91], v[184:187], v[144:147]
ds_read_b64_tr_b16 v[108:109], v228 offset:28672
ds_read_b64_tr_b16 v[110:111], v228 offset:30720
v_mfma_f32_16x16x32_bf16 v[148:151], v[92:95], v[184:187], v[148:151]
ds_read_b64_tr_b16 v[112:113], v229 offset:28672
ds_read_b64_tr_b16 v[114:115], v229 offset:30720
v_mfma_f32_16x16x32_bf16 v[152:155], v[96:99], v[184:187], v[152:155]
ds_read_b64_tr_b16 v[116:117], v230 offset:28672
ds_read_b64_tr_b16 v[118:119], v230 offset:30720
buffer_load_dwordx4 v[172:175], v224, s[16:19], s24 offen sc1
s_add_u32 s24, s24, 8192
v_mfma_f32_16x16x32_bf16 v[156:159], v[100:103], v[184:187], v[156:159]
s_waitcnt vmcnt(16) lgkmcnt(0)
s_barrier
ds_read_b64_tr_b16 v[88:89], v227 offset:32768
ds_read_b64_tr_b16 v[90:91], v227 offset:34816
v_mfma_f32_16x16x32_bf16 v[144:147], v[104:107], v[188:191], v[144:147]
ds_read_b64_tr_b16 v[92:93], v228 offset:32768
ds_read_b64_tr_b16 v[94:95], v228 offset:34816
s_add_u32 m0, s27, 24576
v_mfma_f32_16x16x32_bf16 v[148:151], v[108:111], v[188:191], v[148:151]
ds_read_b64_tr_b16 v[96:97], v229 offset:32768
ds_read_b64_tr_b16 v[98:99], v229 offset:34816
buffer_load_dwordx4 v226, s[68:71], s25 offen lds
s_add_u32 s25, s25, 131072
v_mfma_f32_16x16x32_bf16 v[152:155], v[112:115], v[188:191], v[152:155]
ds_read_b64_tr_b16 v[100:101], v230 offset:32768
ds_read_b64_tr_b16 v[102:103], v230 offset:34816
v_mfma_f32_16x16x32_bf16 v[156:159], v[116:119], v[188:191], v[156:159]
buffer_load_dwordx4 v[176:179], v224, s[16:19], s24 offen sc1
s_add_u32 s24, s24, 8192
s_nop 0
s_waitcnt lgkmcnt(0)
ds_read_b64_tr_b16 v[104:105], v227 offset:36864
ds_read_b64_tr_b16 v[106:107], v227 offset:38912
v_mfma_f32_16x16x32_bf16 v[144:147], v[88:91], v[192:195], v[144:147]
ds_read_b64_tr_b16 v[108:109], v228 offset:36864
ds_read_b64_tr_b16 v[110:111], v228 offset:38912
v_mfma_f32_16x16x32_bf16 v[148:151], v[92:95], v[192:195], v[148:151]
ds_read_b64_tr_b16 v[112:113], v229 offset:36864
ds_read_b64_tr_b16 v[114:115], v229 offset:38912
v_mfma_f32_16x16x32_bf16 v[152:155], v[96:99], v[192:195], v[152:155]
ds_read_b64_tr_b16 v[116:117], v230 offset:36864
ds_read_b64_tr_b16 v[118:119], v230 offset:38912
buffer_load_dwordx4 v[180:183], v224, s[16:19], s24 offen sc1
s_add_u32 s24, s24, 8192
v_mfma_f32_16x16x32_bf16 v[156:159], v[100:103], v[192:195], v[156:159]
s_waitcnt vmcnt(16) lgkmcnt(0)
s_barrier
ds_read_b64_tr_b16 v[88:89], v227 offset:40960
ds_read_b64_tr_b16 v[90:91], v227 offset:43008
v_mfma_f32_16x16x32_bf16 v[144:147], v[104:107], v[196:199], v[144:147]
ds_read_b64_tr_b16 v[92:93], v228 offset:40960
ds_read_b64_tr_b16 v[94:95], v228 offset:43008
s_add_u32 m0, s27, 32768
v_mfma_f32_16x16x32_bf16 v[148:151], v[108:111], v[196:199], v[148:151]
ds_read_b64_tr_b16 v[96:97], v229 offset:40960
ds_read_b64_tr_b16 v[98:99], v229 offset:43008
buffer_load_dwordx4 v226, s[68:71], s25 offen lds
s_add_u32 s25, s25, 131072
v_mfma_f32_16x16x32_bf16 v[152:155], v[112:115], v[196:199], v[152:155]
ds_read_b64_tr_b16 v[100:101], v230 offset:40960
ds_read_b64_tr_b16 v[102:103], v230 offset:43008
v_mfma_f32_16x16x32_bf16 v[156:159], v[116:119], v[196:199], v[156:159]
buffer_load_dwordx2 v[184:185], v225, s[16:19], s24 offen sc1
buffer_load_dwordx2 v[186:187], v225, s[16:19], s24 offen offset:1024 sc1
s_add_u32 s24, s24, 8192
s_nop 0
s_waitcnt lgkmcnt(0)
ds_read_b64_tr_b16 v[104:105], v227 offset:45056
ds_read_b64_tr_b16 v[106:107], v227 offset:47104
v_mfma_f32_16x16x32_bf16 v[144:147], v[88:91], v[200:203], v[144:147]
ds_read_b64_tr_b16 v[108:109], v228 offset:45056
ds_read_b64_tr_b16 v[110:111], v228 offset:47104
v_mfma_f32_16x16x32_bf16 v[148:151], v[92:95], v[200:203], v[148:151]
ds_read_b64_tr_b16 v[112:113], v229 offset:45056
ds_read_b64_tr_b16 v[114:115], v229 offset:47104
v_mfma_f32_16x16x32_bf16 v[152:155], v[96:99], v[200:203], v[152:155]
ds_read_b64_tr_b16 v[116:117], v230 offset:45056
ds_read_b64_tr_b16 v[118:119], v230 offset:47104
buffer_load_dwordx4 v[188:191], v224, s[16:19], s24 offen sc1
s_add_u32 s24, s24, 8192
v_mfma_f32_16x16x32_bf16 v[156:159], v[100:103], v[200:203], v[156:159]
s_waitcnt vmcnt(17) lgkmcnt(0)
s_barrier
ds_read_b64_tr_b16 v[88:89], v227 offset:49152
ds_read_b64_tr_b16 v[90:91], v227 offset:51200
v_mfma_f32_16x16x32_bf16 v[144:147], v[104:107], v[204:207], v[144:147]
ds_read_b64_tr_b16 v[92:93], v228 offset:49152
ds_read_b64_tr_b16 v[94:95], v228 offset:51200
s_add_u32 m0, s27, 40960
v_mfma_f32_16x16x32_bf16 v[148:151], v[108:111], v[204:207], v[148:151]
ds_read_b64_tr_b16 v[96:97], v229 offset:49152
ds_read_b64_tr_b16 v[98:99], v229 offset:51200
buffer_load_dwordx4 v226, s[68:71], s25 offen lds
s_add_u32 s25, s25, 131072
v_mfma_f32_16x16x32_bf16 v[152:155], v[112:115], v[204:207], v[152:155]
ds_read_b64_tr_b16 v[100:101], v230 offset:49152
ds_read_b64_tr_b16 v[102:103], v230 offset:51200
v_mfma_f32_16x16x32_bf16 v[156:159], v[116:119], v[204:207], v[156:159]
buffer_load_dwordx4 v[192:195], v224, s[16:19], s24 offen sc1
s_add_u32 s24, s24, 8192
s_nop 0
s_waitcnt lgkmcnt(0)
ds_read_b64_tr_b16 v[104:105], v227 offset:53248
ds_read_b64_tr_b16 v[106:107], v227 offset:55296
v_mfma_f32_16x16x32_bf16 v[144:147], v[88:91], v[208:211], v[144:147]
ds_read_b64_tr_b16 v[108:109], v228 offset:53248
ds_read_b64_tr_b16 v[110:111], v228 offset:55296
v_mfma_f32_16x16x32_bf16 v[148:151], v[92:95], v[208:211], v[148:151]
ds_read_b64_tr_b16 v[112:113], v229 offset:53248
ds_read_b64_tr_b16 v[114:115], v229 offset:55296
v_mfma_f32_16x16x32_bf16 v[152:155], v[96:99], v[208:211], v[152:155]
ds_read_b64_tr_b16 v[116:117], v230 offset:53248
ds_read_b64_tr_b16 v[118:119], v230 offset:55296
buffer_load_dwordx4 v[196:199], v224, s[16:19], s24 offen sc1
s_add_u32 s24, s24, 8192
v_mfma_f32_16x16x32_bf16 v[156:159], v[100:103], v[208:211], v[156:159]
s_waitcnt vmcnt(16) lgkmcnt(0)
s_barrier
ds_read_b64_tr_b16 v[88:89], v227 offset:57344
ds_read_b64_tr_b16 v[90:91], v227 offset:59392
v_mfma_f32_16x16x32_bf16 v[144:147], v[104:107], v[212:215], v[144:147]
ds_read_b64_tr_b16 v[92:93], v228 offset:57344
ds_read_b64_tr_b16 v[94:95], v228 offset:59392
s_add_u32 m0, s27, 49152
v_mfma_f32_16x16x32_bf16 v[148:151], v[108:111], v[212:215], v[148:151]
ds_read_b64_tr_b16 v[96:97], v229 offset:57344
ds_read_b64_tr_b16 v[98:99], v229 offset:59392
buffer_load_dwordx4 v226, s[68:71], s25 offen lds
s_add_u32 s25, s25, 131072
v_mfma_f32_16x16x32_bf16 v[152:155], v[112:115], v[212:215], v[152:155]
ds_read_b64_tr_b16 v[100:101], v230 offset:57344
ds_read_b64_tr_b16 v[102:103], v230 offset:59392
v_mfma_f32_16x16x32_bf16 v[156:159], v[116:119], v[212:215], v[156:159]
buffer_load_dwordx4 v[200:203], v224, s[16:19], s24 offen sc1
s_add_u32 s24, s24, 8192
s_nop 0
s_waitcnt lgkmcnt(0)
ds_read_b64_tr_b16 v[104:105], v227 offset:61440
ds_read_b64_tr_b16 v[106:107], v227 offset:63488
v_mfma_f32_16x16x32_bf16 v[144:147], v[88:91], v[216:219], v[144:147]
ds_read_b64_tr_b16 v[108:109], v228 offset:61440
ds_read_b64_tr_b16 v[110:111], v228 offset:63488
v_mfma_f32_16x16x32_bf16 v[148:151], v[92:95], v[216:219], v[148:151]
ds_read_b64_tr_b16 v[112:113], v229 offset:61440
ds_read_b64_tr_b16 v[114:115], v229 offset:63488
v_mfma_f32_16x16x32_bf16 v[152:155], v[96:99], v[216:219], v[152:155]
ds_read_b64_tr_b16 v[116:117], v230 offset:61440
ds_read_b64_tr_b16 v[118:119], v230 offset:63488
buffer_load_dwordx4 v[204:207], v224, s[16:19], s24 offen sc1
s_add_u32 s24, s24, 8192
v_mfma_f32_16x16x32_bf16 v[156:159], v[100:103], v[216:219], v[156:159]
s_waitcnt vmcnt(16) lgkmcnt(0)
s_barrier
ds_read_b64_tr_b16 v[88:89], v227 offset:0
ds_read_b64_tr_b16 v[90:91], v227 offset:2048
v_mfma_f32_16x16x32_bf16 v[144:147], v[104:107], v[220:223], v[144:147]
ds_read_b64_tr_b16 v[92:93], v228 offset:0
ds_read_b64_tr_b16 v[94:95], v228 offset:2048
s_add_u32 m0, s27, 57344
v_mfma_f32_16x16x32_bf16 v[148:151], v[108:111], v[220:223], v[148:151]
ds_read_b64_tr_b16 v[96:97], v229 offset:0
ds_read_b64_tr_b16 v[98:99], v229 offset:2048
buffer_load_dwordx4 v226, s[68:71], s25 offen lds
s_add_u32 s25, s25, 131072
v_mfma_f32_16x16x32_bf16 v[152:155], v[112:115], v[220:223], v[152:155]
ds_read_b64_tr_b16 v[100:101], v230 offset:0
ds_read_b64_tr_b16 v[102:103], v230 offset:2048
v_mfma_f32_16x16x32_bf16 v[156:159], v[116:119], v[220:223], v[156:159]
buffer_load_dwordx4 v[208:211], v224, s[16:19], s24 offen sc1
s_add_u32 s24, s24, 8192
s_nop 0
s_waitcnt lgkmcnt(0)
ds_read_b64_tr_b16 v[104:105], v227 offset:4096
ds_read_b64_tr_b16 v[106:107], v227 offset:6144
v_mfma_f32_16x16x32_bf16 v[144:147], v[88:91], v[160:163], v[144:147]
ds_read_b64_tr_b16 v[108:109], v228 offset:4096
ds_read_b64_tr_b16 v[110:111], v228 offset:6144
v_mfma_f32_16x16x32_bf16 v[148:151], v[92:95], v[160:163], v[148:151]
ds_read_b64_tr_b16 v[112:113], v229 offset:4096
ds_read_b64_tr_b16 v[114:115], v229 offset:6144
v_mfma_f32_16x16x32_bf16 v[152:155], v[96:99], v[160:163], v[152:155]
ds_read_b64_tr_b16 v[116:117], v230 offset:4096
ds_read_b64_tr_b16 v[118:119], v230 offset:6144
buffer_load_dwordx2 v[212:213], v225, s[16:19], s24 offen sc1
buffer_load_dwordx2 v[214:215], v225, s[16:19], s24 offen offset:1024 sc1
s_add_u32 s24, s24, 8192
v_mfma_f32_16x16x32_bf16 v[156:159], v[100:103], v[160:163], v[156:159]
s_waitcnt vmcnt(17) lgkmcnt(0)
s_barrier
ds_read_b64_tr_b16 v[88:89], v227 offset:8192
ds_read_b64_tr_b16 v[90:91], v227 offset:10240
v_mfma_f32_16x16x32_bf16 v[144:147], v[104:107], v[164:167], v[144:147]
ds_read_b64_tr_b16 v[92:93], v228 offset:8192
ds_read_b64_tr_b16 v[94:95], v228 offset:10240
s_nop 0
s_add_u32 m0, s27, 0
v_mfma_f32_16x16x32_bf16 v[148:151], v[108:111], v[164:167], v[148:151]
ds_read_b64_tr_b16 v[96:97], v229 offset:8192
ds_read_b64_tr_b16 v[98:99], v229 offset:10240
buffer_load_dwordx4 v226, s[68:71], s25 offen lds
s_add_u32 s25, s25, 131072
v_mfma_f32_16x16x32_bf16 v[152:155], v[112:115], v[164:167], v[152:155]
ds_read_b64_tr_b16 v[100:101], v230 offset:8192
ds_read_b64_tr_b16 v[102:103], v230 offset:10240
v_mfma_f32_16x16x32_bf16 v[156:159], v[116:119], v[164:167], v[156:159]
buffer_load_dwordx4 v[216:219], v224, s[16:19], s24 offen sc1
s_add_u32 s24, s24, 8192
s_nop 0
s_waitcnt lgkmcnt(0)
ds_read_b64_tr_b16 v[104:105], v227 offset:12288
ds_read_b64_tr_b16 v[106:107], v227 offset:14336
v_mfma_f32_16x16x32_bf16 v[144:147], v[88:91], v[168:171], v[144:147]
ds_read_b64_tr_b16 v[108:109], v228 offset:12288
ds_read_b64_tr_b16 v[110:111], v228 offset:14336
v_mfma_f32_16x16x32_bf16 v[148:151], v[92:95], v[168:171], v[148:151]
ds_read_b64_tr_b16 v[112:113], v229 offset:12288
ds_read_b64_tr_b16 v[114:115], v229 offset:14336
v_mfma_f32_16x16x32_bf16 v[152:155], v[96:99], v[168:171], v[152:155]
ds_read_b64_tr_b16 v[116:117], v230 offset:12288
ds_read_b64_tr_b16 v[118:119], v230 offset:14336
buffer_load_dwordx4 v[220:223], v224, s[16:19], s24 offen sc1
s_add_u32 s24, s24, 8192
v_mfma_f32_16x16x32_bf16 v[156:159], v[100:103], v[168:171], v[156:159]
s_waitcnt vmcnt(17) lgkmcnt(0)
s_barrier
ds_read_b64_tr_b16 v[88:89], v227 offset:16384
ds_read_b64_tr_b16 v[90:91], v227 offset:18432
v_mfma_f32_16x16x32_bf16 v[144:147], v[104:107], v[172:175], v[144:147]
ds_read_b64_tr_b16 v[92:93], v228 offset:16384
ds_read_b64_tr_b16 v[94:95], v228 offset:18432
s_add_u32 m0, s27, 8192
v_mfma_f32_16x16x32_bf16 v[148:151], v[108:111], v[172:175], v[148:151]
ds_read_b64_tr_b16 v[96:97], v229 offset:16384
ds_read_b64_tr_b16 v[98:99], v229 offset:18432
buffer_load_dwordx4 v226, s[68:71], s25 offen lds
s_add_u32 s25, s25, 131072
v_mfma_f32_16x16x32_bf16 v[152:155], v[112:115], v[172:175], v[152:155]
ds_read_b64_tr_b16 v[100:101], v230 offset:16384
ds_read_b64_tr_b16 v[102:103], v230 offset:18432
v_mfma_f32_16x16x32_bf16 v[156:159], v[116:119], v[172:175], v[156:159]
buffer_load_dwordx4 v[160:163], v224, s[16:19], s24 offen sc1
s_add_u32 s24, s24, 8192
s_nop 0
s_waitcnt lgkmcnt(0)
ds_read_b64_tr_b16 v[104:105], v227 offset:20480
ds_read_b64_tr_b16 v[106:107], v227 offset:22528
v_mfma_f32_16x16x32_bf16 v[144:147], v[88:91], v[176:179], v[144:147]
ds_read_b64_tr_b16 v[108:109], v228 offset:20480
ds_read_b64_tr_b16 v[110:111], v228 offset:22528
v_mfma_f32_16x16x32_bf16 v[148:151], v[92:95], v[176:179], v[148:151]
ds_read_b64_tr_b16 v[112:113], v229 offset:20480
ds_read_b64_tr_b16 v[114:115], v229 offset:22528
v_mfma_f32_16x16x32_bf16 v[152:155], v[96:99], v[176:179], v[152:155]
ds_read_b64_tr_b16 v[116:117], v230 offset:20480
ds_read_b64_tr_b16 v[118:119], v230 offset:22528
buffer_load_dwordx4 v[164:167], v224, s[16:19], s24 offen sc1
s_add_u32 s24, s24, 8192
v_mfma_f32_16x16x32_bf16 v[156:159], v[100:103], v[176:179], v[156:159]
s_waitcnt vmcnt(16) lgkmcnt(0)
s_barrier
ds_read_b64_tr_b16 v[88:89], v227 offset:24576
ds_read_b64_tr_b16 v[90:91], v227 offset:26624
v_mfma_f32_16x16x32_bf16 v[144:147], v[104:107], v[180:183], v[144:147]
ds_read_b64_tr_b16 v[92:93], v228 offset:24576
ds_read_b64_tr_b16 v[94:95], v228 offset:26624
s_add_u32 m0, s27, 16384
v_mfma_f32_16x16x32_bf16 v[148:151], v[108:111], v[180:183], v[148:151]
ds_read_b64_tr_b16 v[96:97], v229 offset:24576
ds_read_b64_tr_b16 v[98:99], v229 offset:26624
buffer_load_dwordx4 v226, s[68:71], s25 offen lds
s_add_u32 s25, s25, 131072
v_mfma_f32_16x16x32_bf16 v[152:155], v[112:115], v[180:183], v[152:155]
ds_read_b64_tr_b16 v[100:101], v230 offset:24576
ds_read_b64_tr_b16 v[102:103], v230 offset:26624
v_mfma_f32_16x16x32_bf16 v[156:159], v[116:119], v[180:183], v[156:159]
buffer_load_dwordx4 v[168:171], v224, s[16:19], s24 offen sc1
s_add_u32 s24, s24, 8192
s_nop 0
s_waitcnt lgkmcnt(0)
ds_read_b64_tr_b16 v[104:105], v227 offset:28672
ds_read_b64_tr_b16 v[106:107], v227 offset:30720
v_mfma_f32_16x16x32_bf16 v[144:147], v[88:91], v[184:187], v[144:147]
ds_read_b64_tr_b16 v[108:109], v228 offset:28672
ds_read_b64_tr_b16 v[110:111], v228 offset:30720
v_mfma_f32_16x16x32_bf16 v[148:151], v[92:95], v[184:187], v[148:151]
ds_read_b64_tr_b16 v[112:113], v229 offset:28672
ds_read_b64_tr_b16 v[114:115], v229 offset:30720
v_mfma_f32_16x16x32_bf16 v[152:155], v[96:99], v[184:187], v[152:155]
ds_read_b64_tr_b16 v[116:117], v230 offset:28672
ds_read_b64_tr_b16 v[118:119], v230 offset:30720
buffer_load_dwordx4 v[172:175], v224, s[16:19], s24 offen sc1
s_add_u32 s24, s24, 8192
v_mfma_f32_16x16x32_bf16 v[156:159], v[100:103], v[184:187], v[156:159]
s_waitcnt vmcnt(16) lgkmcnt(0)
s_barrier
ds_read_b64_tr_b16 v[88:89], v227 offset:32768
ds_read_b64_tr_b16 v[90:91], v227 offset:34816
v_mfma_f32_16x16x32_bf16 v[144:147], v[104:107], v[188:191], v[144:147]
ds_read_b64_tr_b16 v[92:93], v228 offset:32768
ds_read_b64_tr_b16 v[94:95], v228 offset:34816
s_add_u32 m0, s27, 24576
v_mfma_f32_16x16x32_bf16 v[148:151], v[108:111], v[188:191], v[148:151]
ds_read_b64_tr_b16 v[96:97], v229 offset:32768
ds_read_b64_tr_b16 v[98:99], v229 offset:34816
buffer_load_dwordx4 v226, s[68:71], s25 offen lds
s_add_u32 s25, s25, 131072
v_mfma_f32_16x16x32_bf16 v[152:155], v[112:115], v[188:191], v[152:155]
ds_read_b64_tr_b16 v[100:101], v230 offset:32768
ds_read_b64_tr_b16 v[102:103], v230 offset:34816
v_mfma_f32_16x16x32_bf16 v[156:159], v[116:119], v[188:191], v[156:159]
buffer_load_dwordx2 v[176:177], v225, s[16:19], s24 offen sc1
buffer_load_dwordx2 v[178:179], v225, s[16:19], s24 offen offset:1024 sc1
s_add_u32 s24, s24, 8192
s_nop 0
s_waitcnt lgkmcnt(0)
ds_read_b64_tr_b16 v[104:105], v227 offset:36864
ds_read_b64_tr_b16 v[106:107], v227 offset:38912
v_mfma_f32_16x16x32_bf16 v[144:147], v[88:91], v[192:195], v[144:147]
ds_read_b64_tr_b16 v[108:109], v228 offset:36864
ds_read_b64_tr_b16 v[110:111], v228 offset:38912
v_mfma_f32_16x16x32_bf16 v[148:151], v[92:95], v[192:195], v[148:151]
ds_read_b64_tr_b16 v[112:113], v229 offset:36864
ds_read_b64_tr_b16 v[114:115], v229 offset:38912
v_mfma_f32_16x16x32_bf16 v[152:155], v[96:99], v[192:195], v[152:155]
ds_read_b64_tr_b16 v[116:117], v230 offset:36864
ds_read_b64_tr_b16 v[118:119], v230 offset:38912
buffer_load_dwordx4 v[180:183], v224, s[16:19], s24 offen sc1
s_add_u32 s24, s24, 8192
v_mfma_f32_16x16x32_bf16 v[156:159], v[100:103], v[192:195], v[156:159]
s_waitcnt vmcnt(17) lgkmcnt(0)
s_barrier
ds_read_b64_tr_b16 v[88:89], v227 offset:40960
ds_read_b64_tr_b16 v[90:91], v227 offset:43008
v_mfma_f32_16x16x32_bf16 v[144:147], v[104:107], v[196:199], v[144:147]
ds_read_b64_tr_b16 v[92:93], v228 offset:40960
ds_read_b64_tr_b16 v[94:95], v228 offset:43008
v_mfma_f32_16x16x32_bf16 v[148:151], v[108:111], v[196:199], v[148:151]
ds_read_b64_tr_b16 v[96:97], v229 offset:40960
ds_read_b64_tr_b16 v[98:99], v229 offset:43008
v_mfma_f32_16x16x32_bf16 v[152:155], v[112:115], v[196:199], v[152:155]
ds_read_b64_tr_b16 v[100:101], v230 offset:40960
ds_read_b64_tr_b16 v[102:103], v230 offset:43008
v_mfma_f32_16x16x32_bf16 v[156:159], v[116:119], v[196:199], v[156:159]
buffer_load_dwordx4 v[184:187], v224, s[16:19], s24 offen sc1
s_add_u32 s24, s24, 8192
s_nop 0
s_waitcnt lgkmcnt(0)
ds_read_b64_tr_b16 v[104:105], v227 offset:45056
ds_read_b64_tr_b16 v[106:107], v227 offset:47104
v_mfma_f32_16x16x32_bf16 v[144:147], v[88:91], v[200:203], v[144:147]
ds_read_b64_tr_b16 v[108:109], v228 offset:45056
ds_read_b64_tr_b16 v[110:111], v228 offset:47104
v_mfma_f32_16x16x32_bf16 v[148:151], v[92:95], v[200:203], v[148:151]
ds_read_b64_tr_b16 v[112:113], v229 offset:45056
ds_read_b64_tr_b16 v[114:115], v229 offset:47104
v_mfma_f32_16x16x32_bf16 v[152:155], v[96:99], v[200:203], v[152:155]
ds_read_b64_tr_b16 v[116:117], v230 offset:45056
ds_read_b64_tr_b16 v[118:119], v230 offset:47104
buffer_load_dwordx4 v[188:191], v224, s[16:19], s24 offen sc1
s_add_u32 s24, s24, 8192
v_mfma_f32_16x16x32_bf16 v[156:159], v[100:103], v[200:203], v[156:159]
s_waitcnt vmcnt(15) lgkmcnt(0)
s_barrier
ds_read_b64_tr_b16 v[88:89], v227 offset:49152
ds_read_b64_tr_b16 v[90:91], v227 offset:51200
v_mfma_f32_16x16x32_bf16 v[144:147], v[104:107], v[204:207], v[144:147]
ds_read_b64_tr_b16 v[92:93], v228 offset:49152
ds_read_b64_tr_b16 v[94:95], v228 offset:51200
v_mfma_f32_16x16x32_bf16 v[148:151], v[108:111], v[204:207], v[148:151]
ds_read_b64_tr_b16 v[96:97], v229 offset:49152
ds_read_b64_tr_b16 v[98:99], v229 offset:51200
v_mfma_f32_16x16x32_bf16 v[152:155], v[112:115], v[204:207], v[152:155]
ds_read_b64_tr_b16 v[100:101], v230 offset:49152
ds_read_b64_tr_b16 v[102:103], v230 offset:51200
v_mfma_f32_16x16x32_bf16 v[156:159], v[116:119], v[204:207], v[156:159]
s_nop 0
s_waitcnt lgkmcnt(0)
ds_read_b64_tr_b16 v[104:105], v227 offset:53248
ds_read_b64_tr_b16 v[106:107], v227 offset:55296
v_mfma_f32_16x16x32_bf16 v[144:147], v[88:91], v[208:211], v[144:147]
ds_read_b64_tr_b16 v[108:109], v228 offset:53248
ds_read_b64_tr_b16 v[110:111], v228 offset:55296
v_mfma_f32_16x16x32_bf16 v[148:151], v[92:95], v[208:211], v[148:151]
ds_read_b64_tr_b16 v[112:113], v229 offset:53248
ds_read_b64_tr_b16 v[114:115], v229 offset:55296
v_mfma_f32_16x16x32_bf16 v[152:155], v[96:99], v[208:211], v[152:155]
ds_read_b64_tr_b16 v[116:117], v230 offset:53248
ds_read_b64_tr_b16 v[118:119], v230 offset:55296
buffer_load_dwordx4 v[16:19], v231, s[52:55], s26 offen offset:0
buffer_load_dwordx4 v[20:23], v231, s[52:55], s26 offen offset:64
v_mfma_f32_16x16x32_bf16 v[156:159], v[100:103], v[208:211], v[156:159]
s_waitcnt vmcnt(14) lgkmcnt(0)
s_barrier
ds_read_b64_tr_b16 v[88:89], v227 offset:57344
ds_read_b64_tr_b16 v[90:91], v227 offset:59392
v_mfma_f32_16x16x32_bf16 v[144:147], v[104:107], v[212:215], v[144:147]
ds_read_b64_tr_b16 v[92:93], v228 offset:57344
ds_read_b64_tr_b16 v[94:95], v228 offset:59392
v_mfma_f32_16x16x32_bf16 v[148:151], v[108:111], v[212:215], v[148:151]
ds_read_b64_tr_b16 v[96:97], v229 offset:57344
ds_read_b64_tr_b16 v[98:99], v229 offset:59392
v_mfma_f32_16x16x32_bf16 v[152:155], v[112:115], v[212:215], v[152:155]
ds_read_b64_tr_b16 v[100:101], v230 offset:57344
ds_read_b64_tr_b16 v[102:103], v230 offset:59392
v_mfma_f32_16x16x32_bf16 v[156:159], v[116:119], v[212:215], v[156:159]
s_nop 0
s_waitcnt lgkmcnt(0)
ds_read_b64_tr_b16 v[104:105], v227 offset:61440
ds_read_b64_tr_b16 v[106:107], v227 offset:63488
v_mfma_f32_16x16x32_bf16 v[144:147], v[88:91], v[216:219], v[144:147]
ds_read_b64_tr_b16 v[108:109], v228 offset:61440
ds_read_b64_tr_b16 v[110:111], v228 offset:63488
v_mfma_f32_16x16x32_bf16 v[148:151], v[92:95], v[216:219], v[148:151]
ds_read_b64_tr_b16 v[112:113], v229 offset:61440
ds_read_b64_tr_b16 v[114:115], v229 offset:63488
v_mfma_f32_16x16x32_bf16 v[152:155], v[96:99], v[216:219], v[152:155]
ds_read_b64_tr_b16 v[116:117], v230 offset:61440
ds_read_b64_tr_b16 v[118:119], v230 offset:63488
v_mfma_f32_16x16x32_bf16 v[156:159], v[100:103], v[216:219], v[156:159]
s_waitcnt vmcnt(11) lgkmcnt(0)
s_barrier
ds_read_b64_tr_b16 v[88:89], v227 offset:0
ds_read_b64_tr_b16 v[90:91], v227 offset:2048
v_mfma_f32_16x16x32_bf16 v[144:147], v[104:107], v[220:223], v[144:147]
ds_read_b64_tr_b16 v[92:93], v228 offset:0
ds_read_b64_tr_b16 v[94:95], v228 offset:2048
v_mfma_f32_16x16x32_bf16 v[148:151], v[108:111], v[220:223], v[148:151]
ds_read_b64_tr_b16 v[96:97], v229 offset:0
ds_read_b64_tr_b16 v[98:99], v229 offset:2048
v_mfma_f32_16x16x32_bf16 v[152:155], v[112:115], v[220:223], v[152:155]
ds_read_b64_tr_b16 v[100:101], v230 offset:0
ds_read_b64_tr_b16 v[102:103], v230 offset:2048
v_mfma_f32_16x16x32_bf16 v[156:159], v[116:119], v[220:223], v[156:159]
s_nop 0
s_waitcnt lgkmcnt(0)
ds_read_b64_tr_b16 v[104:105], v227 offset:4096
ds_read_b64_tr_b16 v[106:107], v227 offset:6144
v_mfma_f32_16x16x32_bf16 v[144:147], v[88:91], v[160:163], v[144:147]
ds_read_b64_tr_b16 v[108:109], v228 offset:4096
ds_read_b64_tr_b16 v[110:111], v228 offset:6144
v_mfma_f32_16x16x32_bf16 v[148:151], v[92:95], v[160:163], v[148:151]
ds_read_b64_tr_b16 v[112:113], v229 offset:4096
ds_read_b64_tr_b16 v[114:115], v229 offset:6144
v_mfma_f32_16x16x32_bf16 v[152:155], v[96:99], v[160:163], v[152:155]
ds_read_b64_tr_b16 v[116:117], v230 offset:4096
ds_read_b64_tr_b16 v[118:119], v230 offset:6144
v_mfma_f32_16x16x32_bf16 v[156:159], v[100:103], v[160:163], v[156:159]
s_waitcnt vmcnt(8) lgkmcnt(0)
s_barrier
ds_read_b64_tr_b16 v[88:89], v227 offset:8192
ds_read_b64_tr_b16 v[90:91], v227 offset:10240
v_mfma_f32_16x16x32_bf16 v[144:147], v[104:107], v[164:167], v[144:147]
ds_read_b64_tr_b16 v[92:93], v228 offset:8192
ds_read_b64_tr_b16 v[94:95], v228 offset:10240
v_mfma_f32_16x16x32_bf16 v[148:151], v[108:111], v[164:167], v[148:151]
ds_read_b64_tr_b16 v[96:97], v229 offset:8192
ds_read_b64_tr_b16 v[98:99], v229 offset:10240
v_mfma_f32_16x16x32_bf16 v[152:155], v[112:115], v[164:167], v[152:155]
ds_read_b64_tr_b16 v[100:101], v230 offset:8192
ds_read_b64_tr_b16 v[102:103], v230 offset:10240
v_mfma_f32_16x16x32_bf16 v[156:159], v[116:119], v[164:167], v[156:159]
s_nop 0
s_waitcnt lgkmcnt(0)
ds_read_b64_tr_b16 v[104:105], v227 offset:12288
ds_read_b64_tr_b16 v[106:107], v227 offset:14336
v_mfma_f32_16x16x32_bf16 v[144:147], v[88:91], v[168:171], v[144:147]
ds_read_b64_tr_b16 v[108:109], v228 offset:12288
ds_read_b64_tr_b16 v[110:111], v228 offset:14336
v_mfma_f32_16x16x32_bf16 v[148:151], v[92:95], v[168:171], v[148:151]
ds_read_b64_tr_b16 v[112:113], v229 offset:12288
ds_read_b64_tr_b16 v[114:115], v229 offset:14336
v_mfma_f32_16x16x32_bf16 v[152:155], v[96:99], v[168:171], v[152:155]
ds_read_b64_tr_b16 v[116:117], v230 offset:12288
ds_read_b64_tr_b16 v[118:119], v230 offset:14336
v_mfma_f32_16x16x32_bf16 v[156:159], v[100:103], v[168:171], v[156:159]
s_waitcnt vmcnt(4) lgkmcnt(0)
s_barrier
ds_read_b64_tr_b16 v[88:89], v227 offset:16384
ds_read_b64_tr_b16 v[90:91], v227 offset:18432
v_mfma_f32_16x16x32_bf16 v[144:147], v[104:107], v[172:175], v[144:147]
ds_read_b64_tr_b16 v[92:93], v228 offset:16384
ds_read_b64_tr_b16 v[94:95], v228 offset:18432
v_mfma_f32_16x16x32_bf16 v[148:151], v[108:111], v[172:175], v[148:151]
ds_read_b64_tr_b16 v[96:97], v229 offset:16384
ds_read_b64_tr_b16 v[98:99], v229 offset:18432
v_mfma_f32_16x16x32_bf16 v[152:155], v[112:115], v[172:175], v[152:155]
ds_read_b64_tr_b16 v[100:101], v230 offset:16384
ds_read_b64_tr_b16 v[102:103], v230 offset:18432
v_mfma_f32_16x16x32_bf16 v[156:159], v[116:119], v[172:175], v[156:159]
s_nop 0
s_waitcnt lgkmcnt(0)
ds_read_b64_tr_b16 v[104:105], v227 offset:20480
ds_read_b64_tr_b16 v[106:107], v227 offset:22528
v_mfma_f32_16x16x32_bf16 v[144:147], v[88:91], v[176:179], v[144:147]
ds_read_b64_tr_b16 v[108:109], v228 offset:20480
ds_read_b64_tr_b16 v[110:111], v228 offset:22528
v_mfma_f32_16x16x32_bf16 v[148:151], v[92:95], v[176:179], v[148:151]
ds_read_b64_tr_b16 v[112:113], v229 offset:20480
ds_read_b64_tr_b16 v[114:115], v229 offset:22528
v_mfma_f32_16x16x32_bf16 v[152:155], v[96:99], v[176:179], v[152:155]
ds_read_b64_tr_b16 v[116:117], v230 offset:20480
ds_read_b64_tr_b16 v[118:119], v230 offset:22528
v_mfma_f32_16x16x32_bf16 v[156:159], v[100:103], v[176:179], v[156:159]
s_waitcnt vmcnt(2) lgkmcnt(0)
s_barrier
ds_read_b64_tr_b16 v[88:89], v227 offset:24576
ds_read_b64_tr_b16 v[90:91], v227 offset:26624
v_mfma_f32_16x16x32_bf16 v[144:147], v[104:107], v[180:183], v[144:147]
ds_read_b64_tr_b16 v[92:93], v228 offset:24576
ds_read_b64_tr_b16 v[94:95], v228 offset:26624
v_mfma_f32_16x16x32_bf16 v[148:151], v[108:111], v[180:183], v[148:151]
ds_read_b64_tr_b16 v[96:97], v229 offset:24576
ds_read_b64_tr_b16 v[98:99], v229 offset:26624
v_mfma_f32_16x16x32_bf16 v[152:155], v[112:115], v[180:183], v[152:155]
ds_read_b64_tr_b16 v[100:101], v230 offset:24576
ds_read_b64_tr_b16 v[102:103], v230 offset:26624
v_mfma_f32_16x16x32_bf16 v[156:159], v[116:119], v[180:183], v[156:159]
s_nop 0
s_waitcnt lgkmcnt(0)
ds_read_b64_tr_b16 v[104:105], v227 offset:28672
ds_read_b64_tr_b16 v[106:107], v227 offset:30720
v_mfma_f32_16x16x32_bf16 v[144:147], v[88:91], v[184:187], v[144:147]
ds_read_b64_tr_b16 v[108:109], v228 offset:28672
ds_read_b64_tr_b16 v[110:111], v228 offset:30720
v_mfma_f32_16x16x32_bf16 v[148:151], v[92:95], v[184:187], v[148:151]
ds_read_b64_tr_b16 v[112:113], v229 offset:28672
ds_read_b64_tr_b16 v[114:115], v229 offset:30720
v_mfma_f32_16x16x32_bf16 v[152:155], v[96:99], v[184:187], v[152:155]
ds_read_b64_tr_b16 v[116:117], v230 offset:28672
ds_read_b64_tr_b16 v[118:119], v230 offset:30720
v_mfma_f32_16x16x32_bf16 v[156:159], v[100:103], v[184:187], v[156:159]
s_nop 0
s_waitcnt lgkmcnt(0)
v_mfma_f32_16x16x32_bf16 v[144:147], v[104:107], v[188:191], v[144:147]
v_mfma_f32_16x16x32_bf16 v[148:151], v[108:111], v[188:191], v[148:151]
v_mfma_f32_16x16x32_bf16 v[152:155], v[112:115], v[188:191], v[152:155]
v_mfma_f32_16x16x32_bf16 v[156:159], v[116:119], v[188:191], v[156:159]
s_mov_b32 s30, 0xbfb8aa3b
s_mov_b32 s31, 0xbfb8aa3b
s_mov_b32 s32, 1.0
s_mov_b32 s33, 1.0
s_mov_b32 s34, 0xffff0000
s_waitcnt vmcnt(0)
v_permlane16_swap_b32 v16, v18
v_permlane16_swap_b32 v17, v19
v_permlane16_swap_b32 v20, v22
v_permlane16_swap_b32 v21, v23
s_nop 4
v_pk_mul_f32 v[24:25], v[144:145], s[30:31]
v_pk_mul_f32 v[26:27], v[146:147], s[30:31]
v_pk_mul_f32 v[28:29], v[148:149], s[30:31]
v_pk_mul_f32 v[30:31], v[150:151], s[30:31]
v_pk_mul_f32 v[32:33], v[152:153], s[30:31]
v_pk_mul_f32 v[34:35], v[154:155], s[30:31]
v_pk_mul_f32 v[36:37], v[156:157], s[30:31]
v_pk_mul_f32 v[38:39], v[158:159], s[30:31]
v_exp_f32 v24, v24
v_exp_f32 v25, v25
v_exp_f32 v26, v26
v_exp_f32 v27, v27
v_exp_f32 v28, v28
v_exp_f32 v29, v29
v_exp_f32 v30, v30
v_exp_f32 v31, v31
v_exp_f32 v32, v32
v_exp_f32 v33, v33
v_exp_f32 v34, v34
v_exp_f32 v35, v35
v_exp_f32 v36, v36
v_exp_f32 v37, v37
v_exp_f32 v38, v38
v_exp_f32 v39, v39
v_lshlrev_b32 v40, 16, v16
v_and_b32 v41, s34, v16
v_lshlrev_b32 v42, 16, v17
v_and_b32 v43, s34, v17
v_lshlrev_b32 v44, 16, v18
v_and_b32 v45, s34, v18
v_lshlrev_b32 v46, 16, v19
v_and_b32 v47, s34, v19
v_lshlrev_b32 v48, 16, v20
v_and_b32 v49, s34, v20
v_lshlrev_b32 v50, 16, v21
v_and_b32 v51, s34, v21
v_lshlrev_b32 v52, 16, v22
v_and_b32 v53, s34, v22
v_lshlrev_b32 v54, 16, v23
v_and_b32 v55, s34, v23
v_pk_add_f32 v[24:25], v[24:25], s[32:33]
v_pk_add_f32 v[26:27], v[26:27], s[32:33]
v_pk_add_f32 v[28:29], v[28:29], s[32:33]
v_pk_add_f32 v[30:31], v[30:31], s[32:33]
v_pk_add_f32 v[32:33], v[32:33], s[32:33]
v_pk_add_f32 v[34:35], v[34:35], s[32:33]
v_pk_add_f32 v[36:37], v[36:37], s[32:33]
v_pk_add_f32 v[38:39], v[38:39], s[32:33]
v_rcp_f32 v24, v24
v_rcp_f32 v25, v25
v_rcp_f32 v26, v26
v_rcp_f32 v27, v27
v_rcp_f32 v28, v28
v_rcp_f32 v29, v29
v_rcp_f32 v30, v30
v_rcp_f32 v31, v31
v_rcp_f32 v32, v32
v_rcp_f32 v33, v33
v_rcp_f32 v34, v34
v_rcp_f32 v35, v35
v_rcp_f32 v36, v36
v_rcp_f32 v37, v37
v_rcp_f32 v38, v38
v_rcp_f32 v39, v39
v_pk_mul_f32 v[144:145], v[144:145], v[128:129]
v_pk_mul_f32 v[146:147], v[146:147], v[130:131]
v_pk_mul_f32 v[148:149], v[148:149], v[132:133]
v_pk_mul_f32 v[150:151], v[150:151], v[134:135]
v_pk_mul_f32 v[152:153], v[152:153], v[136:137]
v_pk_mul_f32 v[154:155], v[154:155], v[138:139]
v_pk_mul_f32 v[156:157], v[156:157], v[140:141]
v_pk_mul_f32 v[158:159], v[158:159], v[142:143]
v_pk_fma_f32 v[40:41], v[144:145], v[24:25], v[40:41]
v_pk_fma_f32 v[42:43], v[146:147], v[26:27], v[42:43]
v_pk_fma_f32 v[44:45], v[148:149], v[28:29], v[44:45]
v_pk_fma_f32 v[46:47], v[150:151], v[30:31], v[46:47]
v_pk_fma_f32 v[48:49], v[152:153], v[32:33], v[48:49]
v_pk_fma_f32 v[50:51], v[154:155], v[34:35], v[50:51]
v_pk_fma_f32 v[52:53], v[156:157], v[36:37], v[52:53]
v_pk_fma_f32 v[54:55], v[158:159], v[38:39], v[54:55]
v_cvt_pk_bf16_f32 v16, v40, v41
v_cvt_pk_bf16_f32 v17, v42, v43
v_cvt_pk_bf16_f32 v18, v44, v45
v_cvt_pk_bf16_f32 v19, v46, v47
v_cvt_pk_bf16_f32 v20, v48, v49
v_cvt_pk_bf16_f32 v21, v50, v51
v_cvt_pk_bf16_f32 v22, v52, v53
v_cvt_pk_bf16_f32 v23, v54, v55
s_nop 1
v_permlane16_swap_b32 v16, v18
v_permlane16_swap_b32 v17, v19
v_permlane16_swap_b32 v20, v22
v_permlane16_swap_b32 v21, v23
s_nop 1
buffer_store_dwordx4 v[16:19], v231, s[72:75], s26 offen offset:0
buffer_store_dwordx4 v[20:23], v231, s[72:75], s26 offen offset:64
L_end:
s_endpgm
.section .rodata,"a"
.p2align 6
.amdhsa_kernel recurrent_scan__linear_attn_block__mixer_gmlp__prompt_kernel
  .amdhsa_next_free_vgpr 256
  .amdhsa_next_free_sgpr 102
  .amdhsa_accum_offset 256
  .amdhsa_group_segment_fixed_size 0
  .amdhsa_kernarg_size 88
  .amdhsa_user_sgpr_count 2
  .amdhsa_user_sgpr_kernarg_segment_ptr 1
  .amdhsa_system_sgpr_workgroup_id_x 1
.end_amdhsa_kernel
```
